```python
import torch

def _softmax(x, axis=-1):
    return torch.softmax(x, dim=axis)
def _gelu(x):
    return torch.nn.functional.gelu(x, approximate="tanh")
def _silu(x):
    return torch.nn.functional.silu(x)
def _sigmoid(x):
    return torch.sigmoid(x)
def _layernorm(x, axis=-1, eps=1e-5):
    m = x.mean(dim=axis, keepdim=True)
    v = x.var(dim=axis, keepdim=True, unbiased=False)
    return (x - m) / torch.sqrt(v + eps)
def _scatter_add(tgt, idx, src, axis=0):
    return tgt.clone().index_add_(axis, idx, src)
def _segment_sum(src, seg, n):
    out = torch.zeros((n,) + src.shape[1:], dtype=src.dtype)
    return out.index_add_(0, seg, src)
def _pad(x, pw):
    flat = tuple(v for pair in reversed(pw) for v in pair)
    return torch.nn.functional.pad(x, flat)

kernel_name = 'recurrent_scan__softmax_full_mha__geglu_ffn__prompt'

def setup_inputs():

    _w = (lambda a: (lambda t: t.to(torch.bfloat16) if t.is_floating_point() else t)(torch.as_tensor(a)))
    def _A_setup():
        B, S, D = 1, 2048, 640
        return {
            "x": _w((lambda *s: torch.randn(*s, dtype=torch.bfloat16) * 0.05)(B, S, D)),
            "wqkv": _w((lambda *s: torch.randn(*s, dtype=torch.bfloat16) * 0.05)(D, 3 * D)),
            "wo": _w((lambda *s: torch.randn(*s, dtype=torch.bfloat16) * 0.05)(D, D)),
        }
    _A_in = _A_setup()

    def _B_setup():
        B, S, D, F = 1, 2048, 640, 1728
        return {
            "x": _w((lambda *s: torch.randn(*s, dtype=torch.bfloat16) * 0.05)(B, S, D)),
            "w_gate": _w((lambda *s: torch.randn(*s, dtype=torch.bfloat16) * 0.05)(D, F)),
            "w_up": _w((lambda *s: torch.randn(*s, dtype=torch.bfloat16) * 0.05)(D, F)),
            "w_down": _w((lambda *s: torch.randn(*s, dtype=torch.bfloat16) * 0.05)(F, D)),
        }
    _B_in = _B_setup()

    return {
        "A_x": _A_in["x"],
        "A_wqkv": _A_in["wqkv"],
        "A_wo": _A_in["wo"],
        "B_x": _B_in["x"],
        "B_w_gate": _B_in["w_gate"],
        "B_w_up": _B_in["w_up"],
        "B_w_down": _B_in["w_down"],
    }

def reference(A_x, A_wqkv, A_wo, B_x, B_w_gate, B_w_up, B_w_down):
    def _A_ref(x, wqkv, wo):
        B, S, D = x.shape
        H = 32; Dh = D // H
        qkv = (lambda x, *d: x.permute(*d))((x @ wqkv).reshape(B, S, 3, H, Dh), 2, 0, 3, 1, 4)
        q, k, v = qkv[0], qkv[1], qkv[2]
        scale = Dh ** -0.5
        scores = torch.einsum("bhqd,bhkd->bhqk", q, k) * scale
        p = _softmax(scores, axis=-1)
        o = torch.einsum("bhqk,bhkd->bhqd", p, v)
        return (lambda x, *d: x.permute(*d))(o, 0, 2, 1, 3).reshape(B, S, D) @ wo

    def _B_ref(x, w_gate, w_up, w_down):
        return (_gelu(x @ w_gate) * (x @ w_up)) @ w_down

    x = A_x
    xn = _layernorm(x, axis=-1)
    s = _A_ref(xn, A_wqkv, A_wo)
    g = _silu(_B_ref(xn, B_w_gate, B_w_up, B_w_down))
    return x + s * g
```

```asm
; @launch grid=(512,1,1) block=(256,1,1) lds=81920
.amdgcn_target "amdgcn-amd-amdhsa--gfx950"
.text
.globl recurrent_scan__softmax_full_mha__geglu_ffn__prompt_kernel
.p2align 8
.type recurrent_scan__softmax_full_mha__geglu_ffn__prompt_kernel,@function
recurrent_scan__softmax_full_mha__geglu_ffn__prompt_kernel:
    s_cmp_ge_u32 s2, 512
    s_cbranch_scc1 recurrent_scan__softmax_full_mha__geglu_ffn__prompt_kernel_end
    s_load_dwordx16 s[4:19], s[0:1], 0
    s_load_dwordx4 s[20:23], s[0:1], 64
    s_getpc_b64 s[54:55]
L_pc:
    s_and_b32 s56, s2, 0x1f8
    v_lshrrev_b32 v2, 5, v0
    v_and_b32 v3, 1, v0
    v_add3_u32 v2, v2, v3, s56
    v_lshlrev_b32 v2, 7, v2
    v_min_u32 v2, recurrent_scan__softmax_full_mha__geglu_ffn__prompt_kernel_end-L_pc, v2
    s_mov_b64 exec, 3
    global_load_dword v255, v2, s[54:55]
    s_mov_b64 exec, -1
    s_cmp_ge_u32 s2, 256
    s_cbranch_scc1 L_att
    v_and_b32 v1, 63, v0
    v_lshrrev_b32 v66, 6, v0
    s_and_b32 s54, s2, 7
    v_readfirstlane_b32 s40, v66
    s_lshr_b32 s55, s2, 3
    s_lshr_b32 s41, s54, 1
    s_lshl_b32 s41, s41, 2
    s_and_b32 s96, s55, 3
    s_add_u32 s41, s41, s96
    s_lshr_b32 s56, s55, 2
    s_add_u32 s96, s96, s56
    s_lshr_b32 s57, s54, 1
    s_add_u32 s96, s96, s57
    s_lshl_b32 s43, s41, 2
    s_add_u32 s43, s43, s40
    s_mul_i32 s57, s96, 52
    s_lshr_b32 s57, s57, 8
    s_mul_i32 s57, s57, 5
    s_sub_u32 s96, s96, s57
    v_lshrrev_b32 v64, 4, v1
    v_mul_u32_u24 v32, 1280, v64
    v_and_b32 v65, 15, v1
    v_xor_b32 v33, v64, v65
    v_lshl_add_u32 v32, v33, 4, v32
    v_xor_b32 v33, 64, v32
    v_xor_b32 v34, 128, v32
    v_xor_b32 v35, 192, v32
    s_lshl_b32 s44, s40, 12
    s_mul_i32 s97, s43, 40960
    s_lshl_b32 s98, s96, 8
    s_movk_i32 s57, 288
    s_waitcnt lgkmcnt(0)
    s_mov_b32 s28, s4
    s_mov_b32 s29, s5
    s_mov_b32 s30, 2621440
    s_mov_b32 s31, 0x00020000
    s_add_u32 m0, s44, 0
    s_add_u32 s101, s97, s98
    buffer_load_dwordx4 v32, s[28:31], s101 offen offset:0 lds
    s_add_u32 s101, s101, 4096
    buffer_load_dwordx4 v33, s[28:31], s101 offen offset:1024 lds
    s_add_u32 s101, s101, 4096
    buffer_load_dwordx4 v34, s[28:31], s101 offen offset:2048 lds
    s_add_u32 s101, s101, 4096
    buffer_load_dwordx4 v35, s[28:31], s101 offen offset:3072 lds
    s_add_u32 s98, s98, 256
    s_cmp_ge_u32 s98, 1280
    s_cselect_b32 s98, 0, s98
    s_add_u32 m0, s44, 16384
    s_add_u32 s101, s97, s98
    buffer_load_dwordx4 v32, s[28:31], s101 offen offset:0 lds
    s_add_u32 s101, s101, 4096
    s_and_b32 s42, s54, 1
    s_lshl_b32 s42, s42, 3
    s_add_u32 s42, s42, s56
    s_mul_i32 s36, s42, 52
    s_lshr_b32 s36, s36, 8
    s_mul_i32 s36, s36, 5
    s_add_u32 s36, s42, s36
    s_mov_b32 s24, s22
    s_mov_b32 s25, s23
    buffer_load_dwordx4 v33, s[28:31], s101 offen offset:1024 lds
    s_add_u32 s101, s101, 4096
    s_mov_b32 s26, 21970944
    s_mov_b32 s27, 0x00020000
    s_cmp_lt_u32 s42, 15
    s_cselect_b32 s47, 2, 0
    s_cselect_b32 s59, 1, -1
    s_cmp_lt_u32 s42, 12
    s_cselect_b32 s46, 6, 4
    s_cselect_b32 s48, 17, 1
    s_sub_u32 s54, s42, 7
    s_lshr_b32 s55, s54, 1
    s_sub_u32 s54, s42, 8
    s_cmp_lt_u32 s54, 4
    s_cselect_b32 s55, s55, 0
    s_sub_u32 s48, s48, s55
    s_mov_b32 s35, 0x00020000
    buffer_load_dwordx4 v34, s[28:31], s101 offen offset:2048 lds
    s_add_u32 s101, s101, 4096
    s_mov_b32 s45, -1
    v_xor_b32 v36, v64, v65
    v_lshlrev_b32 v36, 4, v36
    v_lshl_add_u32 v36, v65, 8, v36
    v_add_u32 v36, s44, v36
    v_xor_b32 v37, 64, v36
    v_xor_b32 v38, 128, v36
    v_xor_b32 v39, 192, v36
    v_add_u32 v40, 0x10000, v36
    buffer_load_dwordx4 v35, s[28:31], s101 offen offset:3072 lds
    s_add_u32 s98, s98, 256
    s_cmp_ge_u32 s98, 1280
    s_cselect_b32 s98, 0, s98
    v_add_u32 v41, 0x10000, v37
    v_add_u32 v42, 0x10000, v38
    v_add_u32 v43, 0x10000, v39
    v_mov_b32 v60, 0x3f803f80
    v_mov_b32 v61, 0x3f803f80
    v_mov_b32 v62, 0x3f803f80
    v_mov_b32 v63, 0x3f803f80
    v_mov_b32 v70, 0
    v_mov_b32 v71, 0
    s_add_u32 m0, s44, 32768
    s_add_u32 s101, s97, s98
    buffer_load_dwordx4 v32, s[28:31], s101 offen offset:0 lds
    s_add_u32 s101, s101, 4096
    v_mov_b32 v74, 0
    v_mov_b32 v75, 0
    s_mov_b32 s60, 0xaaaaaaaa
    s_mov_b32 s61, 0xaaaaaaaa
    s_mov_b32 s38, 0xcccccccc
    s_mov_b32 s39, 0xcccccccc
    v_and_b32 v69, 1, v1
    v_lshlrev_b32 v69, 4, v69
    v_mov_b32 v72, 0x3f80
    buffer_load_dwordx4 v33, s[28:31], s101 offen offset:1024 lds
    s_add_u32 s101, s101, 4096
    v_lshlrev_b32 v72, v69, v72
    v_bfe_u32 v69, v1, 2, 2
    v_cmp_eq_u32 vcc, v69, v64
    v_lshl_add_u32 v69, v69, 4, v65
    v_lshlrev_b32 v69, 2, v69
    v_cndmask_b32 v72, 0, v72, vcc
    v_cndmask_b32 v73, 0, v72, s[38:39]
    v_cndmask_b32 v72, v72, 0, s[38:39]
    v_bfe_u32 v67, v1, 4, 1
    buffer_load_dwordx4 v34, s[28:31], s101 offen offset:2048 lds
    s_add_u32 s101, s101, 4096
    v_bfe_u32 v68, v1, 2, 2
    v_lshl_add_u32 v7, v67, 3, v68
    v_lshl_add_u32 v7, v66, 5, v7
    v_lshlrev_b32 v8, 1, v67
    v_and_b32 v6, 3, v1
    v_xor_b32 v8, v8, v6
    v_lshlrev_b32 v8, 4, v8
    v_lshrrev_b32 v66, 5, v1
    v_lshl_add_u32 v8, v66, 6, v8
    buffer_load_dwordx4 v35, s[28:31], s101 offen offset:3072 lds
    s_add_u32 s98, s98, 256
    s_cmp_ge_u32 s98, 1280
    s_cselect_b32 s98, 0, s98
    v_lshlrev_b32 v2, 11, v66
    v_mad_u32_u24 v2, v67, s57, v2
    v_lshl_add_u32 v2, v68, 6, v2
    v_lshl_add_u32 v2, v6, 3, v2
    v_xor_b32 v3, 32, v2
    v_add_u32 v4, 0x10000, v2
    v_add_u32 v5, 0x10000, v3
    v_lshl_add_u32 v9, v67, 1, v66
    v_lshlrev_b32 v9, 15, v9
    s_add_u32 m0, s44, 49152
    s_add_u32 s101, s97, s98
    buffer_load_dwordx4 v32, s[28:31], s101 offen offset:0 lds
    s_add_u32 s101, s101, 4096
    v_lshl_add_u32 v9, v65, 4, v9
    s_lshl_b32 s55, s36, 6
    s_sub_u32 s55, s55, 1280
    s_and_b32 s55, s55, 1023
    s_mov_b32 s56, 81600
    v_mul_u32_u24 v64, 320, v64
    v_add_u32 v65, s55, v65
    v_mul_u32_u24 v66, 3277, v65
    v_lshrrev_b32 v66, 16, v66
    buffer_load_dwordx4 v33, s[28:31], s101 offen offset:1024 lds
    s_add_u32 s101, s101, 4096
    v_lshl_add_u32 v88, v65, 4, v64
    v_mad_u32_u24 v88, v66, s56, v88
    v_add_u32 v65, 16, v65
    v_mul_u32_u24 v66, 3277, v65
    v_lshrrev_b32 v66, 16, v66
    v_lshl_add_u32 v89, v65, 4, v64
    v_mad_u32_u24 v89, v66, s56, v89
    v_add_u32 v65, 16, v65
    v_mul_u32_u24 v66, 3277, v65
    buffer_load_dwordx4 v34, s[28:31], s101 offen offset:2048 lds
    s_add_u32 s101, s101, 4096
    v_lshrrev_b32 v66, 16, v66
    v_lshl_add_u32 v90, v65, 4, v64
    v_mad_u32_u24 v90, v66, s56, v90
    v_add_u32 v65, 16, v65
    v_mul_u32_u24 v66, 3277, v65
    v_lshrrev_b32 v66, 16, v66
    v_lshl_add_u32 v91, v65, 4, v64
    v_mad_u32_u24 v91, v66, s56, v91
    v_add_u32 v65, 272, v65
    buffer_load_dwordx4 v35, s[28:31], s101 offen offset:3072 lds
    s_add_u32 s98, s98, 256
    s_cmp_ge_u32 s98, 1280
    s_cselect_b32 s98, 0, s98
    v_mul_u32_u24 v66, 3277, v65
    v_lshrrev_b32 v66, 16, v66
    v_lshl_add_u32 v92, v65, 4, v64
    v_mad_u32_u24 v92, v66, s56, v92
    v_add_u32 v65, 16, v65
    v_mul_u32_u24 v66, 3277, v65
    v_lshrrev_b32 v66, 16, v66
    v_lshl_add_u32 v93, v65, 4, v64
    v_mad_u32_u24 v93, v66, s56, v93
    s_add_u32 m0, s44, 65536
    s_add_u32 s101, s97, s98
    buffer_load_dwordx4 v32, s[28:31], s101 offen offset:0 lds
    s_add_u32 s101, s101, 4096
    v_add_u32 v65, 16, v65
    v_mul_u32_u24 v66, 3277, v65
    v_lshrrev_b32 v66, 16, v66
    v_lshl_add_u32 v94, v65, 4, v64
    v_mad_u32_u24 v94, v66, s56, v94
    v_add_u32 v65, 16, v65
    v_mul_u32_u24 v66, 3277, v65
    v_lshrrev_b32 v66, 16, v66
    v_lshl_add_u32 v95, v65, 4, v64
    buffer_load_dwordx4 v33, s[28:31], s101 offen offset:1024 lds
    s_add_u32 s101, s101, 4096
    v_mad_u32_u24 v95, v66, s56, v95
    s_add_u32 s54, s45, 1
    s_sub_u32 s55, s54, s47
    s_lshr_b32 s55, s55, 1
    s_mul_i32 s55, s55, s48
    s_add_u32 s55, s55, s42
    s_mul_i32 s56, s54, 5
    s_add_u32 s56, s56, s36
    s_movk_i32 s53, 3456
    buffer_load_dwordx4 v34, s[28:31], s101 offen offset:2048 lds
    s_add_u32 s101, s101, 4096
    s_cmp_lt_u32 s54, s47
    s_cselect_b32 s55, s56, s55
    s_cselect_b32 s53, 3840, s53
    s_mul_i32 s56, s96, s53
    s_add_u32 s55, s55, s56
    s_bitcmp1_b32 s54, 0
    s_cselect_b32 s32, s14, s12
    s_cselect_b32 s33, s15, s13
    s_cmp_lt_u32 s54, s47
    s_cselect_b32 s32, s6, s32
    s_cselect_b32 s33, s7, s33
    s_mul_i32 s34, s53, 640
    s_cmp_lt_u32 s54, s46
    s_cselect_b32 s34, s34, 0
    s_lshl_b32 s49, s55, 7
    s_lshl_b32 s50, s53, 2
    buffer_load_dwordx4 v35, s[28:31], s101 offen offset:3072 lds
    s_add_u32 s98, s98, 256
    s_cmp_ge_u32 s98, 1280
    s_cselect_b32 s98, 0, s98
    s_add_u32 s97, s97, 20480
    s_mul_i32 s51, s53, 12
    s_mul_i32 s52, s53, 108
    s_sub_u32 s50, s50, 1024
    s_sub_u32 s51, s51, 1024
    s_add_u32 s52, s52, 3072
    v_mad_u32_u24 v6, v7, s53, v8
    s_mov_b32 s45, 0
    s_cmp_lt_u32 s42, 5
    s_cselect_b32 s57, 0x3ea52b5c, 1.0
    s_waitcnt vmcnt(16)
    ds_read_b128 v[96:99], v36 offset:0
    ds_read_b128 v[100:103], v37 offset:0
    ds_read_b128 v[104:107], v38 offset:0
    ds_read_b128 v[108:111], v39 offset:0
    s_waitcnt vmcnt(12)
    ds_read_b128 v[112:115], v36 offset:16384
    ds_read_b128 v[116:119], v37 offset:16384
    ds_read_b128 v[120:123], v38 offset:16384
    ds_read_b128 v[124:127], v39 offset:16384
    s_waitcnt lgkmcnt(4)
    v_mfma_f32_16x16x32_bf16 v[44:47], v[60:63], v[96:99], 0
    s_add_u32 m0, s44, 0
    s_add_u32 s101, s97, s98
    buffer_load_dwordx4 v32, s[28:31], s101 offen offset:0 lds
    s_add_u32 s101, s101, 4096
    v_mfma_f32_16x16x32_bf16 v[48:51], v[96:99], v[96:99], 0
    v_mfma_f32_16x16x32_bf16 v[44:47], v[60:63], v[100:103], v[44:47]
    v_mfma_f32_16x16x32_bf16 v[48:51], v[100:103], v[100:103], v[48:51]
    v_mfma_f32_16x16x32_bf16 v[44:47], v[60:63], v[104:107], v[44:47]
    buffer_load_dwordx4 v33, s[28:31], s101 offen offset:1024 lds
    s_add_u32 s101, s101, 4096
    v_mfma_f32_16x16x32_bf16 v[48:51], v[104:107], v[104:107], v[48:51]
    v_mfma_f32_16x16x32_bf16 v[44:47], v[60:63], v[108:111], v[44:47]
    v_mfma_f32_16x16x32_bf16 v[48:51], v[108:111], v[108:111], v[48:51]
    s_waitcnt vmcnt(10)
    ds_read_b128 v[128:131], v36 offset:32768
    ds_read_b128 v[132:135], v37 offset:32768
    ds_read_b128 v[136:139], v38 offset:32768
    ds_read_b128 v[140:143], v39 offset:32768
    s_waitcnt lgkmcnt(4)
    v_mfma_f32_16x16x32_bf16 v[44:47], v[60:63], v[112:115], v[44:47]
    buffer_load_dwordx4 v34, s[28:31], s101 offen offset:2048 lds
    s_add_u32 s101, s101, 4096
    v_mfma_f32_16x16x32_bf16 v[48:51], v[112:115], v[112:115], v[48:51]
    v_mfma_f32_16x16x32_bf16 v[44:47], v[60:63], v[116:119], v[44:47]
    v_mfma_f32_16x16x32_bf16 v[48:51], v[116:119], v[116:119], v[48:51]
    v_mfma_f32_16x16x32_bf16 v[44:47], v[60:63], v[120:123], v[44:47]
    buffer_load_dwordx4 v35, s[28:31], s101 offen offset:3072 lds
    s_add_u32 s98, s98, 256
    s_cmp_ge_u32 s98, 1280
    s_cselect_b32 s98, 0, s98
    v_mfma_f32_16x16x32_bf16 v[48:51], v[120:123], v[120:123], v[48:51]
    v_mfma_f32_16x16x32_bf16 v[44:47], v[60:63], v[124:127], v[44:47]
    v_mfma_f32_16x16x32_bf16 v[48:51], v[124:127], v[124:127], v[48:51]
    s_waitcnt vmcnt(8)
    ds_read_b128 v[144:147], v36 offset:49152
    ds_read_b128 v[148:151], v37 offset:49152
    ds_read_b128 v[152:155], v38 offset:49152
    ds_read_b128 v[156:159], v39 offset:49152
    s_waitcnt lgkmcnt(4)
    v_mfma_f32_16x16x32_bf16 v[44:47], v[60:63], v[128:131], v[44:47]
    s_add_u32 m0, s44, 16384
    s_add_u32 s101, s97, s98
    buffer_load_dwordx4 v32, s[28:31], s101 offen offset:0 lds
    s_add_u32 s101, s101, 4096
    v_mfma_f32_16x16x32_bf16 v[48:51], v[128:131], v[128:131], v[48:51]
    v_mfma_f32_16x16x32_bf16 v[44:47], v[60:63], v[132:135], v[44:47]
    v_mfma_f32_16x16x32_bf16 v[48:51], v[132:135], v[132:135], v[48:51]
    v_mfma_f32_16x16x32_bf16 v[44:47], v[60:63], v[136:139], v[44:47]
    buffer_load_dwordx4 v33, s[28:31], s101 offen offset:1024 lds
    s_add_u32 s101, s101, 4096
    v_mfma_f32_16x16x32_bf16 v[48:51], v[136:139], v[136:139], v[48:51]
    v_mfma_f32_16x16x32_bf16 v[44:47], v[60:63], v[140:143], v[44:47]
    v_mfma_f32_16x16x32_bf16 v[48:51], v[140:143], v[140:143], v[48:51]
    s_waitcnt vmcnt(6)
    ds_read_b128 v[160:163], v40 offset:0
    ds_read_b128 v[164:167], v41 offset:0
    ds_read_b128 v[168:171], v42 offset:0
    ds_read_b128 v[172:175], v43 offset:0
    s_waitcnt lgkmcnt(4)
    v_mfma_f32_16x16x32_bf16 v[44:47], v[60:63], v[144:147], v[44:47]
    buffer_load_dwordx4 v34, s[28:31], s101 offen offset:2048 lds
    s_add_u32 s101, s101, 4096
    v_mfma_f32_16x16x32_bf16 v[48:51], v[144:147], v[144:147], v[48:51]
    v_mfma_f32_16x16x32_bf16 v[44:47], v[60:63], v[148:151], v[44:47]
    v_mfma_f32_16x16x32_bf16 v[48:51], v[148:151], v[148:151], v[48:51]
    v_mfma_f32_16x16x32_bf16 v[44:47], v[60:63], v[152:155], v[44:47]
    buffer_load_dwordx4 v35, s[28:31], s101 offen offset:3072 lds
    s_add_u32 s98, s98, 256
    s_cmp_ge_u32 s98, 1280
    s_cselect_b32 s98, 0, s98
    v_mfma_f32_16x16x32_bf16 v[48:51], v[152:155], v[152:155], v[48:51]
    v_mfma_f32_16x16x32_bf16 v[44:47], v[60:63], v[156:159], v[44:47]
    v_mfma_f32_16x16x32_bf16 v[48:51], v[156:159], v[156:159], v[48:51]
    s_waitcnt lgkmcnt(0)
    v_mfma_f32_16x16x32_bf16 v[44:47], v[60:63], v[160:163], v[44:47]
    s_add_u32 m0, s44, 32768
    s_add_u32 s101, s97, s98
    buffer_load_dwordx4 v32, s[28:31], s101 offen offset:0 lds
    s_add_u32 s101, s101, 4096
    v_mfma_f32_16x16x32_bf16 v[48:51], v[160:163], v[160:163], v[48:51]
    v_mfma_f32_16x16x32_bf16 v[44:47], v[60:63], v[164:167], v[44:47]
    v_mfma_f32_16x16x32_bf16 v[48:51], v[164:167], v[164:167], v[48:51]
    v_mfma_f32_16x16x32_bf16 v[44:47], v[60:63], v[168:171], v[44:47]
    buffer_load_dwordx4 v33, s[28:31], s101 offen offset:1024 lds
    s_add_u32 s101, s101, 4096
    v_mfma_f32_16x16x32_bf16 v[48:51], v[168:171], v[168:171], v[48:51]
    v_mfma_f32_16x16x32_bf16 v[44:47], v[60:63], v[172:175], v[44:47]
    v_mfma_f32_16x16x32_bf16 v[48:51], v[172:175], v[172:175], v[48:51]
    buffer_load_dwordx4 v34, s[28:31], s101 offen offset:2048 lds
    s_add_u32 s101, s101, 4096
    s_nop 4
    v_mul_f32 v76, 0xbacccccd, v44
    v_cvt_pk_bf16_f32 v56, v76, v76
    v_lshlrev_b32 v56, 16, v56
    v_mov_b32 v57, v56
    v_mov_b32 v58, v56
    v_mov_b32 v59, v56
    s_nop 1
    v_mfma_f32_16x16x32_bf16 v[16:19], v[72:75], v[96:99], v[56:59]
    v_mfma_f32_16x16x32_bf16 v[20:23], v[70:73], v[96:99], v[56:59]
    s_nop 2
    v_mfma_f32_16x16x32_bf16 v[24:27], v[72:75], v[100:103], v[56:59]
    buffer_load_dwordx4 v35, s[28:31], s101 offen offset:3072 lds
    s_add_u32 s98, s98, 256
    s_cmp_ge_u32 s98, 1280
    s_cselect_b32 s98, 0, s98
    v_mfma_f32_16x16x32_bf16 v[28:31], v[70:73], v[100:103], v[56:59]
    s_nop 2
    v_mfma_f32_16x16x32_bf16 v[80:83], v[72:75], v[104:107], v[56:59]
    v_cvt_pk_bf16_f32 v96, v16, v17
    v_cvt_pk_bf16_f32 v97, v18, v19
    v_mfma_f32_16x16x32_bf16 v[84:87], v[70:73], v[104:107], v[56:59]
    v_cvt_pk_bf16_f32 v98, v20, v21
    v_cvt_pk_bf16_f32 v99, v22, v23
    v_mfma_f32_16x16x32_bf16 v[16:19], v[72:75], v[108:111], v[56:59]
    s_add_u32 m0, s44, 49152
    s_add_u32 s101, s97, s98
    buffer_load_dwordx4 v32, s[28:31], s101 offen offset:0 lds
    s_add_u32 s101, s101, 4096
    v_cvt_pk_bf16_f32 v100, v24, v25
    v_cvt_pk_bf16_f32 v101, v26, v27
    v_mfma_f32_16x16x32_bf16 v[20:23], v[70:73], v[108:111], v[56:59]
    v_cvt_pk_bf16_f32 v102, v28, v29
    v_cvt_pk_bf16_f32 v103, v30, v31
    v_cndmask_b32 v48, v48, v49, s[60:61]
    v_cndmask_b32 v50, v50, v51, s[60:61]
    v_cndmask_b32 v48, v48, v50, s[38:39]
    ds_bpermute_b32 v13, v69, v48
    v_mfma_f32_16x16x32_bf16 v[24:27], v[72:75], v[112:115], v[56:59]
    v_cvt_pk_bf16_f32 v104, v80, v81
    v_cvt_pk_bf16_f32 v105, v82, v83
    v_mfma_f32_16x16x32_bf16 v[28:31], v[70:73], v[112:115], v[56:59]
    v_cvt_pk_bf16_f32 v106, v84, v85
    v_cvt_pk_bf16_f32 v107, v86, v87
    v_mfma_f32_16x16x32_bf16 v[80:83], v[72:75], v[116:119], v[56:59]
    buffer_load_dwordx4 v33, s[28:31], s101 offen offset:1024 lds
    s_add_u32 s101, s101, 4096
    v_cvt_pk_bf16_f32 v108, v16, v17
    v_cvt_pk_bf16_f32 v109, v18, v19
    v_mfma_f32_16x16x32_bf16 v[84:87], v[70:73], v[116:119], v[56:59]
    v_cvt_pk_bf16_f32 v110, v20, v21
    v_cvt_pk_bf16_f32 v111, v22, v23
    v_mfma_f32_16x16x32_bf16 v[16:19], v[72:75], v[120:123], v[56:59]
    v_cvt_pk_bf16_f32 v112, v24, v25
    v_cvt_pk_bf16_f32 v113, v26, v27
    v_mfma_f32_16x16x32_bf16 v[20:23], v[70:73], v[120:123], v[56:59]
    v_cvt_pk_bf16_f32 v114, v28, v29
    v_cvt_pk_bf16_f32 v115, v30, v31
    v_mfma_f32_16x16x32_bf16 v[24:27], v[72:75], v[124:127], v[56:59]
    buffer_load_dwordx4 v34, s[28:31], s101 offen offset:2048 lds
    s_add_u32 s101, s101, 4096
    v_cvt_pk_bf16_f32 v116, v80, v81
    v_cvt_pk_bf16_f32 v117, v82, v83
    v_mfma_f32_16x16x32_bf16 v[28:31], v[70:73], v[124:127], v[56:59]
    v_cvt_pk_bf16_f32 v118, v84, v85
    v_cvt_pk_bf16_f32 v119, v86, v87
    v_mfma_f32_16x16x32_bf16 v[80:83], v[72:75], v[128:131], v[56:59]
    v_cvt_pk_bf16_f32 v120, v16, v17
    v_cvt_pk_bf16_f32 v121, v18, v19
    v_mfma_f32_16x16x32_bf16 v[84:87], v[70:73], v[128:131], v[56:59]
    v_cvt_pk_bf16_f32 v122, v20, v21
    v_cvt_pk_bf16_f32 v123, v22, v23
    v_mfma_f32_16x16x32_bf16 v[16:19], v[72:75], v[132:135], v[56:59]
    buffer_load_dwordx4 v35, s[28:31], s101 offen offset:3072 lds
    s_add_u32 s98, s98, 256
    s_cmp_ge_u32 s98, 1280
    s_cselect_b32 s98, 0, s98
    v_cvt_pk_bf16_f32 v124, v24, v25
    v_cvt_pk_bf16_f32 v125, v26, v27
    v_mfma_f32_16x16x32_bf16 v[20:23], v[70:73], v[132:135], v[56:59]
    v_cvt_pk_bf16_f32 v126, v28, v29
    v_cvt_pk_bf16_f32 v127, v30, v31
    v_mfma_f32_16x16x32_bf16 v[24:27], v[72:75], v[136:139], v[56:59]
    v_cvt_pk_bf16_f32 v128, v80, v81
    v_cvt_pk_bf16_f32 v129, v82, v83
    v_mfma_f32_16x16x32_bf16 v[28:31], v[70:73], v[136:139], v[56:59]
    v_cvt_pk_bf16_f32 v130, v84, v85
    v_cvt_pk_bf16_f32 v131, v86, v87
    v_mfma_f32_16x16x32_bf16 v[80:83], v[72:75], v[140:143], v[56:59]
    s_add_u32 m0, s44, 65536
    s_add_u32 s101, s97, s98
    buffer_load_dwordx4 v32, s[28:31], s101 offen offset:0 lds
    s_add_u32 s101, s101, 4096
    v_cvt_pk_bf16_f32 v132, v16, v17
    v_cvt_pk_bf16_f32 v133, v18, v19
    v_mfma_f32_16x16x32_bf16 v[84:87], v[70:73], v[140:143], v[56:59]
    v_cvt_pk_bf16_f32 v134, v20, v21
    v_cvt_pk_bf16_f32 v135, v22, v23
    v_mfma_f32_16x16x32_bf16 v[16:19], v[72:75], v[144:147], v[56:59]
    v_cvt_pk_bf16_f32 v136, v24, v25
    v_cvt_pk_bf16_f32 v137, v26, v27
    v_mfma_f32_16x16x32_bf16 v[20:23], v[70:73], v[144:147], v[56:59]
    v_cvt_pk_bf16_f32 v138, v28, v29
    v_cvt_pk_bf16_f32 v139, v30, v31
    v_mfma_f32_16x16x32_bf16 v[24:27], v[72:75], v[148:151], v[56:59]
    buffer_load_dwordx4 v33, s[28:31], s101 offen offset:1024 lds
    s_add_u32 s101, s101, 4096
    v_cvt_pk_bf16_f32 v140, v80, v81
    v_cvt_pk_bf16_f32 v141, v82, v83
    v_mfma_f32_16x16x32_bf16 v[28:31], v[70:73], v[148:151], v[56:59]
    v_cvt_pk_bf16_f32 v142, v84, v85
    v_cvt_pk_bf16_f32 v143, v86, v87
    v_mfma_f32_16x16x32_bf16 v[80:83], v[72:75], v[152:155], v[56:59]
    v_cvt_pk_bf16_f32 v144, v16, v17
    v_cvt_pk_bf16_f32 v145, v18, v19
    v_mfma_f32_16x16x32_bf16 v[84:87], v[70:73], v[152:155], v[56:59]
    v_cvt_pk_bf16_f32 v146, v20, v21
    v_cvt_pk_bf16_f32 v147, v22, v23
    v_mfma_f32_16x16x32_bf16 v[16:19], v[72:75], v[156:159], v[56:59]
    buffer_load_dwordx4 v34, s[28:31], s101 offen offset:2048 lds
    s_add_u32 s101, s101, 4096
    v_cvt_pk_bf16_f32 v148, v24, v25
    v_cvt_pk_bf16_f32 v149, v26, v27
    v_mfma_f32_16x16x32_bf16 v[20:23], v[70:73], v[156:159], v[56:59]
    v_cvt_pk_bf16_f32 v150, v28, v29
    v_cvt_pk_bf16_f32 v151, v30, v31
    v_mfma_f32_16x16x32_bf16 v[24:27], v[72:75], v[160:163], v[56:59]
    v_cvt_pk_bf16_f32 v152, v80, v81
    v_cvt_pk_bf16_f32 v153, v82, v83
    v_mfma_f32_16x16x32_bf16 v[28:31], v[70:73], v[160:163], v[56:59]
    v_cvt_pk_bf16_f32 v154, v84, v85
    v_cvt_pk_bf16_f32 v155, v86, v87
    v_mfma_f32_16x16x32_bf16 v[80:83], v[72:75], v[164:167], v[56:59]
    buffer_load_dwordx4 v35, s[28:31], s101 offen offset:3072 lds
    s_add_u32 s98, s98, 256
    s_cmp_ge_u32 s98, 1280
    s_cselect_b32 s98, 0, s98
    v_cvt_pk_bf16_f32 v156, v16, v17
    v_cvt_pk_bf16_f32 v157, v18, v19
    v_mfma_f32_16x16x32_bf16 v[84:87], v[70:73], v[164:167], v[56:59]
    v_cvt_pk_bf16_f32 v158, v20, v21
    v_cvt_pk_bf16_f32 v159, v22, v23
    s_waitcnt vmcnt(16)
    ds_read_b128 v[176:179], v36 offset:0
    ds_read_b128 v[180:183], v37 offset:0
    ds_read_b128 v[184:187], v38 offset:0
    ds_read_b128 v[188:191], v39 offset:0
    v_mfma_f32_16x16x32_bf16 v[16:19], v[72:75], v[168:171], v[56:59]
    v_cvt_pk_bf16_f32 v160, v24, v25
    v_cvt_pk_bf16_f32 v161, v26, v27
    v_mfma_f32_16x16x32_bf16 v[20:23], v[70:73], v[168:171], v[56:59]
    v_cvt_pk_bf16_f32 v162, v28, v29
    v_cvt_pk_bf16_f32 v163, v30, v31
    v_mfma_f32_16x16x32_bf16 v[24:27], v[72:75], v[172:175], v[56:59]
    v_cvt_pk_bf16_f32 v164, v80, v81
    v_cvt_pk_bf16_f32 v165, v82, v83
    v_mfma_f32_16x16x32_bf16 v[28:31], v[70:73], v[172:175], v[56:59]
    v_cvt_pk_bf16_f32 v166, v84, v85
    v_cvt_pk_bf16_f32 v167, v86, v87
    v_cvt_pk_bf16_f32 v168, v16, v17
    v_cvt_pk_bf16_f32 v169, v18, v19
    v_cvt_pk_bf16_f32 v170, v20, v21
    v_cvt_pk_bf16_f32 v171, v22, v23
    s_nop 3
    v_cvt_pk_bf16_f32 v172, v24, v25
    v_cvt_pk_bf16_f32 v173, v26, v27
    v_cvt_pk_bf16_f32 v174, v28, v29
    v_cvt_pk_bf16_f32 v175, v30, v31
    s_waitcnt vmcnt(12)
    ds_read_b128 v[192:195], v36 offset:16384
    ds_read_b128 v[196:199], v37 offset:16384
    ds_read_b128 v[200:203], v38 offset:16384
    ds_read_b128 v[204:207], v39 offset:16384
    s_waitcnt lgkmcnt(4)
    v_mfma_f32_16x16x32_bf16 v[44:47], v[60:63], v[176:179], 0
    s_add_u32 m0, s44, 0
    s_nop 0
    buffer_load_dwordx4 v6, s[32:35], s49 offen offset:0 lds
    s_add_u32 s49, s49, s50
    v_mfma_f32_16x16x32_bf16 v[52:55], v[176:179], v[176:179], 0
    v_mfma_f32_16x16x32_bf16 v[44:47], v[60:63], v[180:183], v[44:47]
    v_mfma_f32_16x16x32_bf16 v[52:55], v[180:183], v[180:183], v[52:55]
    v_mul_f32 v13, 0x3acccccd, v13
    v_fma_f32 v13, -v76, v76, v13
    v_mfma_f32_16x16x32_bf16 v[44:47], v[60:63], v[184:187], v[44:47]
    buffer_load_dwordx4 v6, s[32:35], s49 offen offset:1024 lds
    s_add_u32 s49, s49, s51
    v_mfma_f32_16x16x32_bf16 v[52:55], v[184:187], v[184:187], v[52:55]
    v_mfma_f32_16x16x32_bf16 v[44:47], v[60:63], v[188:191], v[44:47]
    v_mfma_f32_16x16x32_bf16 v[52:55], v[188:191], v[188:191], v[52:55]
    v_max_f32 v13, 0, v13
    v_cvt_pk_bf16_f32 v13, v13, v13
    s_waitcnt vmcnt(10)
    ds_read_b128 v[208:211], v36 offset:32768
    ds_read_b128 v[212:215], v37 offset:32768
    ds_read_b128 v[216:219], v38 offset:32768
    ds_read_b128 v[220:223], v39 offset:32768
    s_waitcnt lgkmcnt(4)
    v_mfma_f32_16x16x32_bf16 v[44:47], v[60:63], v[192:195], v[44:47]
    buffer_load_dwordx4 v6, s[32:35], s49 offen offset:2048 lds
    s_add_u32 s49, s49, s50
    v_mfma_f32_16x16x32_bf16 v[52:55], v[192:195], v[192:195], v[52:55]
    v_mfma_f32_16x16x32_bf16 v[44:47], v[60:63], v[196:199], v[44:47]
    v_mfma_f32_16x16x32_bf16 v[52:55], v[196:199], v[196:199], v[52:55]
    v_lshlrev_b32 v13, 16, v13
    v_add_f32 v13, 0x3727c5ac, v13
    v_mfma_f32_16x16x32_bf16 v[44:47], v[60:63], v[200:203], v[44:47]
    buffer_load_dwordx4 v6, s[32:35], s49 offen offset:3072 lds
    s_add_u32 s49, s49, s52
    s_cmp_ge_u32 s49, s34
    s_cselect_b32 s101, s34, 0
    s_sub_u32 s49, s49, s101
    v_mfma_f32_16x16x32_bf16 v[52:55], v[200:203], v[200:203], v[52:55]
    v_mfma_f32_16x16x32_bf16 v[44:47], v[60:63], v[204:207], v[44:47]
    v_mfma_f32_16x16x32_bf16 v[52:55], v[204:207], v[204:207], v[52:55]
    v_cvt_pk_bf16_f32 v13, v13, v13
    v_lshlrev_b32 v13, 16, v13
    s_waitcnt vmcnt(8)
    ds_read_b128 v[224:227], v36 offset:49152
    ds_read_b128 v[228:231], v37 offset:49152
    ds_read_b128 v[232:235], v38 offset:49152
    ds_read_b128 v[236:239], v39 offset:49152
    s_waitcnt lgkmcnt(4)
    v_mfma_f32_16x16x32_bf16 v[44:47], v[60:63], v[208:211], v[44:47]
    s_add_u32 m0, s44, 16384
    s_nop 0
    buffer_load_dwordx4 v6, s[32:35], s49 offen offset:0 lds
    s_add_u32 s49, s49, s50
    v_mfma_f32_16x16x32_bf16 v[52:55], v[208:211], v[208:211], v[52:55]
    v_mfma_f32_16x16x32_bf16 v[44:47], v[60:63], v[212:215], v[44:47]
    v_mfma_f32_16x16x32_bf16 v[52:55], v[212:215], v[212:215], v[52:55]
    v_sqrt_f32 v13, v13
    s_nop 0
    v_mfma_f32_16x16x32_bf16 v[44:47], v[60:63], v[216:219], v[44:47]
    buffer_load_dwordx4 v6, s[32:35], s49 offen offset:1024 lds
    s_add_u32 s49, s49, s51
    v_mfma_f32_16x16x32_bf16 v[52:55], v[216:219], v[216:219], v[52:55]
    v_mfma_f32_16x16x32_bf16 v[44:47], v[60:63], v[220:223], v[44:47]
    v_mfma_f32_16x16x32_bf16 v[52:55], v[220:223], v[220:223], v[52:55]
    v_cvt_pk_bf16_f32 v13, v13, v13
    v_lshlrev_b32 v13, 16, v13
    s_or_b32 s54, s2, s40
    s_cmp_lg_u32 s54, 0
    s_cbranch_scc1 g1_nn
    s_memrealtime s[54:55]
    s_waitcnt lgkmcnt(0)
    s_or_b32 s54, s54, 1
    v_mov_b32 v64, 0
    v_mov_b32 v65, s54
    s_mov_b64 exec, 1
    global_store_dword v64, v65, s[20:21] sc1
    s_mov_b64 exec, -1
g1_nn:
    s_waitcnt vmcnt(6)
    ds_read_b128 v[240:243], v40 offset:0
    ds_read_b128 v[244:247], v41 offset:0
    ds_read_b128 v[248:251], v42 offset:0
    ds_read_b128 v[252:255], v43 offset:0
    s_waitcnt lgkmcnt(4)
    v_mfma_f32_16x16x32_bf16 v[44:47], v[60:63], v[224:227], v[44:47]
    buffer_load_dwordx4 v6, s[32:35], s49 offen offset:2048 lds
    s_add_u32 s49, s49, s50
    v_mfma_f32_16x16x32_bf16 v[52:55], v[224:227], v[224:227], v[52:55]
    v_mfma_f32_16x16x32_bf16 v[44:47], v[60:63], v[228:231], v[44:47]
    v_mfma_f32_16x16x32_bf16 v[52:55], v[228:231], v[228:231], v[52:55]
    v_rcp_f32 v10, v13
    s_nop 0
    v_mfma_f32_16x16x32_bf16 v[44:47], v[60:63], v[232:235], v[44:47]
    buffer_load_dwordx4 v6, s[32:35], s49 offen offset:3072 lds
    s_add_u32 s49, s49, s52
    s_cmp_ge_u32 s49, s34
    s_cselect_b32 s101, s34, 0
    s_sub_u32 s49, s49, s101
    v_mfma_f32_16x16x32_bf16 v[52:55], v[232:235], v[232:235], v[52:55]
    v_mfma_f32_16x16x32_bf16 v[44:47], v[60:63], v[236:239], v[44:47]
    v_mfma_f32_16x16x32_bf16 v[52:55], v[236:239], v[236:239], v[52:55]
    v_mul_f32 v10, s57, v10
    s_waitcnt lgkmcnt(0)
    v_mfma_f32_16x16x32_bf16 v[44:47], v[60:63], v[240:243], v[44:47]
    v_mfma_f32_16x16x32_bf16 v[44:47], v[60:63], v[244:247], v[44:47]
    v_mfma_f32_16x16x32_bf16 v[44:47], v[60:63], v[248:251], v[44:47]
    v_mfma_f32_16x16x32_bf16 v[44:47], v[60:63], v[252:255], v[44:47]
    v_mfma_f32_16x16x32_bf16 v[52:55], v[240:243], v[240:243], v[52:55]
    s_add_u32 m0, s44, 32768
    s_nop 0
    buffer_load_dwordx4 v6, s[32:35], s49 offen offset:0 lds
    s_add_u32 s49, s49, s50
    v_mfma_f32_16x16x32_bf16 v[52:55], v[244:247], v[244:247], v[52:55]
    v_mfma_f32_16x16x32_bf16 v[52:55], v[248:251], v[248:251], v[52:55]
    buffer_load_dwordx4 v6, s[32:35], s49 offen offset:1024 lds
    s_add_u32 s49, s49, s51
    v_mfma_f32_16x16x32_bf16 v[52:55], v[252:255], v[252:255], v[52:55]
    v_mov_b32 v11, 0
    v_mul_f32 v77, 0xbacccccd, v44
    v_cvt_pk_bf16_f32 v56, v77, v77
    v_lshlrev_b32 v56, 16, v56
    v_mov_b32 v57, v56
    v_mov_b32 v58, v56
    v_mov_b32 v59, v56
    s_nop 1
    v_mfma_f32_16x16x32_bf16 v[32:35], v[72:75], v[176:179], v[56:59]
    buffer_load_dwordx4 v6, s[32:35], s49 offen offset:2048 lds
    s_add_u32 s49, s49, s50
    v_mfma_f32_16x16x32_bf16 v[36:39], v[70:73], v[176:179], v[56:59]
    s_nop 2
    v_mfma_f32_16x16x32_bf16 v[80:83], v[72:75], v[180:183], v[56:59]
    v_mfma_f32_16x16x32_bf16 v[84:87], v[70:73], v[180:183], v[56:59]
    s_nop 2
    v_cndmask_b32 v52, v52, v53, s[60:61]
    v_cndmask_b32 v54, v54, v55, s[60:61]
    v_cndmask_b32 v52, v52, v54, s[38:39]
    ds_bpermute_b32 v0, v69, v52
    v_mfma_f32_16x16x32_bf16 v[40:43], v[72:75], v[184:187], v[56:59]
    buffer_load_dwordx4 v6, s[32:35], s49 offen offset:3072 lds
    s_add_u32 s49, s49, s52
    s_cmp_ge_u32 s49, s34
    s_cselect_b32 s101, s34, 0
    s_sub_u32 s49, s49, s101
    v_cvt_pk_bf16_f32 v176, v32, v33
    v_cvt_pk_bf16_f32 v177, v34, v35
    v_mfma_f32_16x16x32_bf16 v[44:47], v[70:73], v[184:187], v[56:59]
    v_cvt_pk_bf16_f32 v178, v36, v37
    v_cvt_pk_bf16_f32 v179, v38, v39
    v_mfma_f32_16x16x32_bf16 v[32:35], v[72:75], v[188:191], v[56:59]
    v_cvt_pk_bf16_f32 v180, v80, v81
    v_cvt_pk_bf16_f32 v181, v82, v83
    v_mfma_f32_16x16x32_bf16 v[36:39], v[70:73], v[188:191], v[56:59]
    v_cvt_pk_bf16_f32 v182, v84, v85
    v_cvt_pk_bf16_f32 v183, v86, v87
    v_mfma_f32_16x16x32_bf16 v[80:83], v[72:75], v[192:195], v[56:59]
    s_add_u32 m0, s44, 49152
    s_nop 0
    buffer_load_dwordx4 v6, s[32:35], s49 offen offset:0 lds
    s_add_u32 s49, s49, s50
    v_cvt_pk_bf16_f32 v184, v40, v41
    v_cvt_pk_bf16_f32 v185, v42, v43
    v_mfma_f32_16x16x32_bf16 v[84:87], v[70:73], v[192:195], v[56:59]
    v_cvt_pk_bf16_f32 v186, v44, v45
    v_cvt_pk_bf16_f32 v187, v46, v47
    v_mfma_f32_16x16x32_bf16 v[40:43], v[72:75], v[196:199], v[56:59]
    v_cvt_pk_bf16_f32 v188, v32, v33
    v_cvt_pk_bf16_f32 v189, v34, v35
    v_mfma_f32_16x16x32_bf16 v[44:47], v[70:73], v[196:199], v[56:59]
    v_cvt_pk_bf16_f32 v190, v36, v37
    v_cvt_pk_bf16_f32 v191, v38, v39
    s_waitcnt lgkmcnt(0)
    v_mul_f32 v0, 0x3acccccd, v0
    v_mfma_f32_16x16x32_bf16 v[32:35], v[72:75], v[200:203], v[56:59]
    buffer_load_dwordx4 v6, s[32:35], s49 offen offset:1024 lds
    v_cvt_pk_bf16_f32 v192, v80, v81
    v_cvt_pk_bf16_f32 v193, v82, v83
    v_mfma_f32_16x16x32_bf16 v[36:39], v[70:73], v[200:203], v[56:59]
    v_cvt_pk_bf16_f32 v194, v84, v85
    v_cvt_pk_bf16_f32 v195, v86, v87
    v_fma_f32 v0, -v77, v77, v0
    v_mfma_f32_16x16x32_bf16 v[80:83], v[72:75], v[204:207], v[56:59]
    s_cmp_eq_u32 s47, 0
    v_cvt_pk_bf16_f32 v196, v40, v41
    v_cvt_pk_bf16_f32 v197, v42, v43
    v_mfma_f32_16x16x32_bf16 v[84:87], v[70:73], v[204:207], v[56:59]
    s_cselect_b32 s99, -1, 1
    v_cvt_pk_bf16_f32 v198, v44, v45
    v_cvt_pk_bf16_f32 v199, v46, v47
    v_max_f32 v0, 0, v0
    v_mfma_f32_16x16x32_bf16 v[40:43], v[72:75], v[208:211], v[56:59]
    s_cselect_b32 s3, -1, 2
    v_cvt_pk_bf16_f32 v200, v32, v33
    v_cvt_pk_bf16_f32 v201, v34, v35
    v_mfma_f32_16x16x32_bf16 v[44:47], v[70:73], v[208:211], v[56:59]
    s_lshl4_add_u32 s100, s42, s41
    v_cvt_pk_bf16_f32 v202, v36, v37
    v_cvt_pk_bf16_f32 v203, v38, v39
    v_cvt_pk_bf16_f32 v0, v0, v0
    v_mfma_f32_16x16x32_bf16 v[32:35], v[72:75], v[212:215], v[56:59]
    s_lshl_b32 s100, s100, 6
    v_cvt_pk_bf16_f32 v204, v80, v81
    v_cvt_pk_bf16_f32 v205, v82, v83
    v_mfma_f32_16x16x32_bf16 v[36:39], v[70:73], v[212:215], v[56:59]
    s_add_u32 s100, s100, 20799488
    v_cvt_pk_bf16_f32 v206, v84, v85
    v_cvt_pk_bf16_f32 v207, v86, v87
    v_lshlrev_b32 v0, 16, v0
    v_mfma_f32_16x16x32_bf16 v[80:83], v[72:75], v[216:219], v[56:59]
    s_cmp_eq_u32 s40, 0
    v_cvt_pk_bf16_f32 v208, v40, v41
    v_cvt_pk_bf16_f32 v209, v42, v43
    v_mfma_f32_16x16x32_bf16 v[84:87], v[70:73], v[216:219], v[56:59]
    s_cselect_b32 s97, 5, -1
    v_cvt_pk_bf16_f32 v210, v44, v45
    v_cvt_pk_bf16_f32 v211, v46, v47
    v_add_f32 v0, 0x3727c5ac, v0
    v_mfma_f32_16x16x32_bf16 v[40:43], v[72:75], v[220:223], v[56:59]
    s_cselect_b32 s99, s99, -1
    v_cvt_pk_bf16_f32 v212, v32, v33
    v_cvt_pk_bf16_f32 v213, v34, v35
    v_mfma_f32_16x16x32_bf16 v[44:47], v[70:73], v[220:223], v[56:59]
    s_mov_b32 s37, s59
    v_cvt_pk_bf16_f32 v214, v36, v37
    v_cvt_pk_bf16_f32 v215, v38, v39
    v_cvt_pk_bf16_f32 v0, v0, v0
    v_mfma_f32_16x16x32_bf16 v[32:35], v[72:75], v[224:227], v[56:59]
    s_cmp_lt_u32 s42, 8
    v_cvt_pk_bf16_f32 v216, v80, v81
    v_cvt_pk_bf16_f32 v217, v82, v83
    v_mfma_f32_16x16x32_bf16 v[36:39], v[70:73], v[224:227], v[56:59]
    s_cselect_b32 s98, 5, 5
    v_cvt_pk_bf16_f32 v218, v84, v85
    v_cvt_pk_bf16_f32 v219, v86, v87
    v_lshlrev_b32 v0, 16, v0
    v_mfma_f32_16x16x32_bf16 v[80:83], v[72:75], v[228:231], v[56:59]
    s_cmp_lt_u32 s42, 12
    v_cvt_pk_bf16_f32 v220, v40, v41
    v_cvt_pk_bf16_f32 v221, v42, v43
    v_mfma_f32_16x16x32_bf16 v[84:87], v[70:73], v[228:231], v[56:59]
    s_cselect_b32 s98, s98, 6
    v_cvt_pk_bf16_f32 v222, v44, v45
    v_cvt_pk_bf16_f32 v223, v46, v47
    v_sqrt_f32 v0, v0
    v_mfma_f32_16x16x32_bf16 v[40:43], v[72:75], v[232:235], v[56:59]
    s_setprio 2
    v_cvt_pk_bf16_f32 v224, v32, v33
    v_cvt_pk_bf16_f32 v225, v34, v35
    v_mfma_f32_16x16x32_bf16 v[44:47], v[70:73], v[232:235], v[56:59]
    v_cvt_pk_bf16_f32 v226, v36, v37
    v_cvt_pk_bf16_f32 v227, v38, v39
    v_cvt_pk_bf16_f32 v0, v0, v0
    v_mfma_f32_16x16x32_bf16 v[32:35], v[72:75], v[236:239], v[56:59]
    v_cvt_pk_bf16_f32 v228, v80, v81
    v_cvt_pk_bf16_f32 v229, v82, v83
    v_mfma_f32_16x16x32_bf16 v[36:39], v[70:73], v[236:239], v[56:59]
    v_cvt_pk_bf16_f32 v230, v84, v85
    v_cvt_pk_bf16_f32 v231, v86, v87
    v_lshlrev_b32 v0, 16, v0
    s_waitcnt vmcnt(10)
    s_barrier
    ds_read_b64_tr_b16 v[16:17], v2 offset:0
    ds_read_b64_tr_b16 v[18:19], v2 offset:1024
    ds_read_b64_tr_b16 v[20:21], v3 offset:0
    ds_read_b64_tr_b16 v[22:23], v3 offset:1024
    ds_read_b64_tr_b16 v[24:25], v2 offset:512
    ds_read_b64_tr_b16 v[26:27], v2 offset:1536
    ds_read_b64_tr_b16 v[28:29], v3 offset:512
    ds_read_b64_tr_b16 v[30:31], v3 offset:1536
    v_mfma_f32_16x16x32_bf16 v[80:83], v[72:75], v[240:243], v[56:59]
    v_cvt_pk_bf16_f32 v232, v40, v41
    v_cvt_pk_bf16_f32 v233, v42, v43
    v_mfma_f32_16x16x32_bf16 v[84:87], v[70:73], v[240:243], v[56:59]
    v_cvt_pk_bf16_f32 v234, v44, v45
    v_cvt_pk_bf16_f32 v235, v46, v47
    v_rcp_f32 v14, v0
    v_mfma_f32_16x16x32_bf16 v[40:43], v[72:75], v[244:247], v[56:59]
    v_cvt_pk_bf16_f32 v236, v32, v33
    v_cvt_pk_bf16_f32 v237, v34, v35
    v_mfma_f32_16x16x32_bf16 v[44:47], v[70:73], v[244:247], v[56:59]
    v_cvt_pk_bf16_f32 v238, v36, v37
    v_cvt_pk_bf16_f32 v239, v38, v39
    v_mul_f32 v14, s57, v14
    v_mfma_f32_16x16x32_bf16 v[32:35], v[72:75], v[248:251], v[56:59]
    v_cvt_pk_bf16_f32 v240, v80, v81
    v_cvt_pk_bf16_f32 v241, v82, v83
    v_mfma_f32_16x16x32_bf16 v[36:39], v[70:73], v[248:251], v[56:59]
    v_cvt_pk_bf16_f32 v242, v84, v85
    v_cvt_pk_bf16_f32 v243, v86, v87
    v_mfma_f32_16x16x32_bf16 v[80:83], v[72:75], v[252:255], v[56:59]
    v_cvt_pk_bf16_f32 v244, v40, v41
    v_cvt_pk_bf16_f32 v245, v42, v43
    v_mfma_f32_16x16x32_bf16 v[84:87], v[70:73], v[252:255], v[56:59]
    v_cvt_pk_bf16_f32 v246, v44, v45
    v_cvt_pk_bf16_f32 v247, v46, v47
    v_cvt_pk_bf16_f32 v248, v32, v33
    v_cvt_pk_bf16_f32 v249, v34, v35
    v_cvt_pk_bf16_f32 v250, v36, v37
    v_cvt_pk_bf16_f32 v251, v38, v39
    s_nop 3
    v_cvt_pk_bf16_f32 v252, v80, v81
    v_cvt_pk_bf16_f32 v253, v82, v83
    v_cvt_pk_bf16_f32 v254, v84, v85
    v_cvt_pk_bf16_f32 v255, v86, v87
    s_cmp_lt_u32 s42, 10
    s_cbranch_scc1 g1_hi
    s_cmp_eq_u32 s47, 0
    s_cbranch_scc1 g1_toffn
    v_and_b32 v64, 48, v1
    ds_bpermute_b32 v80, v64, v10 offset:0
    ds_bpermute_b32 v81, v64, v10 offset:4
    ds_bpermute_b32 v82, v64, v10 offset:8
    ds_bpermute_b32 v83, v64, v10 offset:12
    ds_bpermute_b32 v84, v64, v14 offset:0
    ds_bpermute_b32 v85, v64, v14 offset:4
    ds_bpermute_b32 v86, v64, v14 offset:8
    ds_bpermute_b32 v87, v64, v14 offset:12
g1_vloop:
    s_waitcnt lgkmcnt(6)
    v_mfma_f32_16x16x32_bf16 v[32:35], v[96:99], v[16:19], 0
    s_add_u32 s49, s49, s51
    buffer_load_dwordx4 v6, s[32:35], s49 offen offset:2048 lds
    v_mfma_f32_16x16x32_bf16 v[48:51], v[176:179], v[16:19], 0
    s_waitcnt lgkmcnt(4)
    ds_read_b64_tr_b16 v[16:17], v2 offset:4096
    ds_read_b64_tr_b16 v[18:19], v2 offset:5120
    v_mfma_f32_16x16x32_bf16 v[52:55], v[176:179], v[20:23], 0
    s_add_u32 s54, s45, 1
    s_sub_u32 s55, s54, s47
    s_lshr_b32 s55, s55, 1
    v_mfma_f32_16x16x32_bf16 v[36:39], v[96:99], v[20:23], 0
    s_waitcnt lgkmcnt(4)
    ds_read_b64_tr_b16 v[20:21], v3 offset:4096
    ds_read_b64_tr_b16 v[22:23], v3 offset:5120
    v_mfma_f32_16x16x32_bf16 v[40:43], v[96:99], v[24:27], 0
    s_add_u32 s49, s49, s50
    buffer_load_dwordx4 v6, s[32:35], s49 offen offset:3072 lds
    v_mfma_f32_16x16x32_bf16 v[56:59], v[176:179], v[24:27], 0
    s_waitcnt lgkmcnt(4)
    ds_read_b64_tr_b16 v[24:25], v2 offset:4608
    ds_read_b64_tr_b16 v[26:27], v2 offset:5632
    v_mfma_f32_16x16x32_bf16 v[60:63], v[176:179], v[28:31], 0
    s_mul_i32 s55, s55, s48
    s_add_u32 s55, s55, s42
    s_mul_i32 s56, s54, 5
    v_mfma_f32_16x16x32_bf16 v[44:47], v[96:99], v[28:31], 0
    s_waitcnt lgkmcnt(4)
    ds_read_b64_tr_b16 v[28:29], v3 offset:4608
    ds_read_b64_tr_b16 v[30:31], v3 offset:5632
    v_mfma_f32_16x16x32_bf16 v[32:35], v[100:103], v[16:19], v[32:35]
    s_add_u32 s49, s49, s52
    s_cmp_ge_u32 s49, s34
    s_cselect_b32 s101, s34, 0
    v_mfma_f32_16x16x32_bf16 v[48:51], v[180:183], v[16:19], v[48:51]
    s_waitcnt lgkmcnt(4)
    ds_read_b64_tr_b16 v[16:17], v2 offset:8192
    ds_read_b64_tr_b16 v[18:19], v2 offset:9216
    v_mfma_f32_16x16x32_bf16 v[52:55], v[180:183], v[20:23], v[52:55]
    s_sub_u32 s49, s49, s101
    v_mfma_f32_16x16x32_bf16 v[36:39], v[100:103], v[20:23], v[36:39]
    s_waitcnt lgkmcnt(4)
    ds_read_b64_tr_b16 v[20:21], v3 offset:8192
    ds_read_b64_tr_b16 v[22:23], v3 offset:9216
    v_mfma_f32_16x16x32_bf16 v[40:43], v[100:103], v[24:27], v[40:43]
    s_add_u32 s56, s56, s36
    s_movk_i32 s53, 3456
    v_mfma_f32_16x16x32_bf16 v[56:59], v[180:183], v[24:27], v[56:59]
    s_waitcnt lgkmcnt(4)
    ds_read_b64_tr_b16 v[24:25], v2 offset:8704
    ds_read_b64_tr_b16 v[26:27], v2 offset:9728
    v_mfma_f32_16x16x32_bf16 v[60:63], v[180:183], v[28:31], v[60:63]
    s_cmp_lt_u32 s54, s47
    s_cselect_b32 s55, s56, s55
    s_cselect_b32 s53, 3840, s53
    v_mfma_f32_16x16x32_bf16 v[44:47], v[100:103], v[28:31], v[44:47]
    s_waitcnt lgkmcnt(4)
    ds_read_b64_tr_b16 v[28:29], v3 offset:8704
    ds_read_b64_tr_b16 v[30:31], v3 offset:9728
    v_mfma_f32_16x16x32_bf16 v[32:35], v[104:107], v[16:19], v[32:35]
    s_mul_i32 s56, s96, s53
    s_add_u32 s55, s55, s56
    v_mfma_f32_16x16x32_bf16 v[48:51], v[184:187], v[16:19], v[48:51]
    s_waitcnt lgkmcnt(4)
    ds_read_b64_tr_b16 v[16:17], v2 offset:12288
    ds_read_b64_tr_b16 v[18:19], v2 offset:13312
    v_mfma_f32_16x16x32_bf16 v[52:55], v[184:187], v[20:23], v[52:55]
    v_mfma_f32_16x16x32_bf16 v[36:39], v[104:107], v[20:23], v[36:39]
    s_waitcnt lgkmcnt(4)
    ds_read_b64_tr_b16 v[20:21], v3 offset:12288
    ds_read_b64_tr_b16 v[22:23], v3 offset:13312
    v_mfma_f32_16x16x32_bf16 v[40:43], v[104:107], v[24:27], v[40:43]
    v_mfma_f32_16x16x32_bf16 v[56:59], v[184:187], v[24:27], v[56:59]
    s_waitcnt lgkmcnt(4)
    ds_read_b64_tr_b16 v[24:25], v2 offset:12800
    ds_read_b64_tr_b16 v[26:27], v2 offset:13824
    v_mfma_f32_16x16x32_bf16 v[60:63], v[184:187], v[28:31], v[60:63]
    s_add_u32 m0, s44, 65536
    s_cmp_eq_u32 s45, s3
    v_mfma_f32_16x16x32_bf16 v[44:47], v[104:107], v[28:31], v[44:47]
    s_waitcnt lgkmcnt(4)
    ds_read_b64_tr_b16 v[28:29], v3 offset:12800
    ds_read_b64_tr_b16 v[30:31], v3 offset:13824
    v_mfma_f32_16x16x32_bf16 v[32:35], v[108:111], v[16:19], v[32:35]
    s_cbranch_scc1 g1_pubv
    s_waitcnt vmcnt(8)
    s_barrier
g1_pubretv:
    v_mfma_f32_16x16x32_bf16 v[48:51], v[188:191], v[16:19], v[48:51]
    s_waitcnt lgkmcnt(4)
    ds_read_b64_tr_b16 v[16:17], v2 offset:16384
    ds_read_b64_tr_b16 v[18:19], v2 offset:17408
    v_mfma_f32_16x16x32_bf16 v[52:55], v[188:191], v[20:23], v[52:55]
    buffer_load_dwordx4 v6, s[32:35], s49 offen offset:0 lds
    v_mfma_f32_16x16x32_bf16 v[36:39], v[108:111], v[20:23], v[36:39]
    s_waitcnt lgkmcnt(4)
    ds_read_b64_tr_b16 v[20:21], v3 offset:16384
    ds_read_b64_tr_b16 v[22:23], v3 offset:17408
    v_mfma_f32_16x16x32_bf16 v[40:43], v[108:111], v[24:27], v[40:43]
    v_mfma_f32_16x16x32_bf16 v[56:59], v[188:191], v[24:27], v[56:59]
    s_waitcnt lgkmcnt(4)
    ds_read_b64_tr_b16 v[24:25], v2 offset:16896
    ds_read_b64_tr_b16 v[26:27], v2 offset:17920
    v_mfma_f32_16x16x32_bf16 v[60:63], v[188:191], v[28:31], v[60:63]
    s_add_u32 s49, s49, s50
    buffer_load_dwordx4 v6, s[32:35], s49 offen offset:1024 lds
    v_mfma_f32_16x16x32_bf16 v[44:47], v[108:111], v[28:31], v[44:47]
    s_waitcnt lgkmcnt(4)
    ds_read_b64_tr_b16 v[28:29], v3 offset:16896
    ds_read_b64_tr_b16 v[30:31], v3 offset:17920
    v_mfma_f32_16x16x32_bf16 v[32:35], v[112:115], v[16:19], v[32:35]
    v_mfma_f32_16x16x32_bf16 v[48:51], v[192:195], v[16:19], v[48:51]
    s_waitcnt lgkmcnt(4)
    ds_read_b64_tr_b16 v[16:17], v2 offset:20480
    ds_read_b64_tr_b16 v[18:19], v2 offset:21504
    v_mfma_f32_16x16x32_bf16 v[52:55], v[192:195], v[20:23], v[52:55]
    s_add_u32 s49, s49, s51
    buffer_load_dwordx4 v6, s[32:35], s49 offen offset:2048 lds
    v_mfma_f32_16x16x32_bf16 v[36:39], v[112:115], v[20:23], v[36:39]
    s_waitcnt lgkmcnt(4)
    ds_read_b64_tr_b16 v[20:21], v3 offset:20480
    ds_read_b64_tr_b16 v[22:23], v3 offset:21504
    v_mfma_f32_16x16x32_bf16 v[40:43], v[112:115], v[24:27], v[40:43]
    v_mfma_f32_16x16x32_bf16 v[56:59], v[192:195], v[24:27], v[56:59]
    s_waitcnt lgkmcnt(4)
    ds_read_b64_tr_b16 v[24:25], v2 offset:20992
    ds_read_b64_tr_b16 v[26:27], v2 offset:22016
    v_mfma_f32_16x16x32_bf16 v[60:63], v[192:195], v[28:31], v[60:63]
    s_add_u32 s49, s49, s50
    buffer_load_dwordx4 v6, s[32:35], s49 offen offset:3072 lds
    v_mfma_f32_16x16x32_bf16 v[44:47], v[112:115], v[28:31], v[44:47]
    s_waitcnt lgkmcnt(4)
    ds_read_b64_tr_b16 v[28:29], v3 offset:20992
    ds_read_b64_tr_b16 v[30:31], v3 offset:22016
    v_mfma_f32_16x16x32_bf16 v[32:35], v[116:119], v[16:19], v[32:35]
    s_bitcmp1_b32 s54, 0
    s_cselect_b32 s32, s14, s12
    s_cselect_b32 s33, s15, s13
    v_mfma_f32_16x16x32_bf16 v[48:51], v[196:199], v[16:19], v[48:51]
    s_waitcnt lgkmcnt(4)
    ds_read_b64_tr_b16 v[16:17], v2 offset:24576
    ds_read_b64_tr_b16 v[18:19], v2 offset:25600
    v_mfma_f32_16x16x32_bf16 v[52:55], v[196:199], v[20:23], v[52:55]
    s_cmp_lt_u32 s54, s47
    s_cselect_b32 s32, s6, s32
    s_cselect_b32 s33, s7, s33
    v_mfma_f32_16x16x32_bf16 v[36:39], v[116:119], v[20:23], v[36:39]
    s_waitcnt lgkmcnt(4)
    ds_read_b64_tr_b16 v[20:21], v3 offset:24576
    ds_read_b64_tr_b16 v[22:23], v3 offset:25600
    v_mfma_f32_16x16x32_bf16 v[40:43], v[116:119], v[24:27], v[40:43]
    s_mul_i32 s34, s53, 640
    s_cmp_lt_u32 s54, s46
    s_cselect_b32 s34, s34, 0
    v_mfma_f32_16x16x32_bf16 v[56:59], v[196:199], v[24:27], v[56:59]
    s_waitcnt lgkmcnt(4)
    ds_read_b64_tr_b16 v[24:25], v2 offset:25088
    ds_read_b64_tr_b16 v[26:27], v2 offset:26112
    v_mfma_f32_16x16x32_bf16 v[60:63], v[196:199], v[28:31], v[60:63]
    s_lshl_b32 s49, s55, 7
    s_lshl_b32 s50, s53, 2
    s_mul_i32 s51, s53, 12
    v_mfma_f32_16x16x32_bf16 v[44:47], v[116:119], v[28:31], v[44:47]
    s_waitcnt lgkmcnt(4)
    ds_read_b64_tr_b16 v[28:29], v3 offset:25088
    ds_read_b64_tr_b16 v[30:31], v3 offset:26112
    v_mfma_f32_16x16x32_bf16 v[32:35], v[120:123], v[16:19], v[32:35]
    s_mul_i32 s52, s53, 108
    s_sub_u32 s50, s50, 1024
    s_sub_u32 s51, s51, 1024
    v_mfma_f32_16x16x32_bf16 v[48:51], v[200:203], v[16:19], v[48:51]
    s_waitcnt lgkmcnt(4)
    ds_read_b64_tr_b16 v[16:17], v2 offset:28672
    ds_read_b64_tr_b16 v[18:19], v2 offset:29696
    v_mfma_f32_16x16x32_bf16 v[52:55], v[200:203], v[20:23], v[52:55]
    s_add_u32 s52, s52, 3072
    v_mfma_f32_16x16x32_bf16 v[36:39], v[120:123], v[20:23], v[36:39]
    s_waitcnt lgkmcnt(4)
    ds_read_b64_tr_b16 v[20:21], v3 offset:28672
    ds_read_b64_tr_b16 v[22:23], v3 offset:29696
    v_mfma_f32_16x16x32_bf16 v[40:43], v[120:123], v[24:27], v[40:43]
    s_cmp_eq_u32 s45, s37
    s_cbranch_scc1 g1_swv
g1_swrv:
    v_mfma_f32_16x16x32_bf16 v[56:59], v[200:203], v[24:27], v[56:59]
    s_waitcnt lgkmcnt(4)
    ds_read_b64_tr_b16 v[24:25], v2 offset:29184
    ds_read_b64_tr_b16 v[26:27], v2 offset:30208
    v_mfma_f32_16x16x32_bf16 v[60:63], v[200:203], v[28:31], v[60:63]
    s_add_u32 m0, s44, 0
    v_mfma_f32_16x16x32_bf16 v[44:47], v[120:123], v[28:31], v[44:47]
    s_waitcnt lgkmcnt(4)
    ds_read_b64_tr_b16 v[28:29], v3 offset:29184
    ds_read_b64_tr_b16 v[30:31], v3 offset:30208
    v_mfma_f32_16x16x32_bf16 v[32:35], v[124:127], v[16:19], v[32:35]
    s_waitcnt vmcnt(8)
    s_barrier
    v_mfma_f32_16x16x32_bf16 v[48:51], v[204:207], v[16:19], v[48:51]
    s_waitcnt lgkmcnt(4)
    ds_read_b64_tr_b16 v[16:17], v2 offset:32768
    ds_read_b64_tr_b16 v[18:19], v2 offset:33792
    v_mfma_f32_16x16x32_bf16 v[52:55], v[204:207], v[20:23], v[52:55]
    buffer_load_dwordx4 v6, s[32:35], s49 offen offset:0 lds
    v_mfma_f32_16x16x32_bf16 v[36:39], v[124:127], v[20:23], v[36:39]
    s_waitcnt lgkmcnt(4)
    ds_read_b64_tr_b16 v[20:21], v3 offset:32768
    ds_read_b64_tr_b16 v[22:23], v3 offset:33792
    v_mfma_f32_16x16x32_bf16 v[40:43], v[124:127], v[24:27], v[40:43]
    v_mfma_f32_16x16x32_bf16 v[56:59], v[204:207], v[24:27], v[56:59]
    s_waitcnt lgkmcnt(4)
    ds_read_b64_tr_b16 v[24:25], v2 offset:33280
    ds_read_b64_tr_b16 v[26:27], v2 offset:34304
    v_mfma_f32_16x16x32_bf16 v[60:63], v[204:207], v[28:31], v[60:63]
    s_add_u32 s49, s49, s50
    buffer_load_dwordx4 v6, s[32:35], s49 offen offset:1024 lds
    v_mfma_f32_16x16x32_bf16 v[44:47], v[124:127], v[28:31], v[44:47]
    s_waitcnt lgkmcnt(4)
    ds_read_b64_tr_b16 v[28:29], v3 offset:33280
    ds_read_b64_tr_b16 v[30:31], v3 offset:34304
    v_mfma_f32_16x16x32_bf16 v[32:35], v[128:131], v[16:19], v[32:35]
    v_mfma_f32_16x16x32_bf16 v[48:51], v[208:211], v[16:19], v[48:51]
    s_waitcnt lgkmcnt(4)
    ds_read_b64_tr_b16 v[16:17], v2 offset:36864
    ds_read_b64_tr_b16 v[18:19], v2 offset:37888
    v_mfma_f32_16x16x32_bf16 v[52:55], v[208:211], v[20:23], v[52:55]
    s_add_u32 s49, s49, s51
    buffer_load_dwordx4 v6, s[32:35], s49 offen offset:2048 lds
    v_mfma_f32_16x16x32_bf16 v[36:39], v[128:131], v[20:23], v[36:39]
    s_waitcnt lgkmcnt(4)
    ds_read_b64_tr_b16 v[20:21], v3 offset:36864
    ds_read_b64_tr_b16 v[22:23], v3 offset:37888
    v_mfma_f32_16x16x32_bf16 v[40:43], v[128:131], v[24:27], v[40:43]
    v_mfma_f32_16x16x32_bf16 v[56:59], v[208:211], v[24:27], v[56:59]
    s_waitcnt lgkmcnt(4)
    ds_read_b64_tr_b16 v[24:25], v2 offset:37376
    ds_read_b64_tr_b16 v[26:27], v2 offset:38400
    v_mfma_f32_16x16x32_bf16 v[60:63], v[208:211], v[28:31], v[60:63]
    s_add_u32 s49, s49, s50
    buffer_load_dwordx4 v6, s[32:35], s49 offen offset:3072 lds
    v_mfma_f32_16x16x32_bf16 v[44:47], v[128:131], v[28:31], v[44:47]
    s_waitcnt lgkmcnt(4)
    ds_read_b64_tr_b16 v[28:29], v3 offset:37376
    ds_read_b64_tr_b16 v[30:31], v3 offset:38400
    v_mfma_f32_16x16x32_bf16 v[32:35], v[132:135], v[16:19], v[32:35]
    s_add_u32 s49, s49, s52
    s_cmp_ge_u32 s49, s34
    s_cselect_b32 s101, s34, 0
    v_mfma_f32_16x16x32_bf16 v[48:51], v[212:215], v[16:19], v[48:51]
    s_waitcnt lgkmcnt(4)
    ds_read_b64_tr_b16 v[16:17], v2 offset:40960
    ds_read_b64_tr_b16 v[18:19], v2 offset:41984
    v_mfma_f32_16x16x32_bf16 v[52:55], v[212:215], v[20:23], v[52:55]
    s_sub_u32 s49, s49, s101
    v_mfma_f32_16x16x32_bf16 v[36:39], v[132:135], v[20:23], v[36:39]
    s_waitcnt lgkmcnt(4)
    ds_read_b64_tr_b16 v[20:21], v3 offset:40960
    ds_read_b64_tr_b16 v[22:23], v3 offset:41984
    v_mfma_f32_16x16x32_bf16 v[40:43], v[132:135], v[24:27], v[40:43]
    v_mfma_f32_16x16x32_bf16 v[56:59], v[212:215], v[24:27], v[56:59]
    s_waitcnt lgkmcnt(4)
    ds_read_b64_tr_b16 v[24:25], v2 offset:41472
    ds_read_b64_tr_b16 v[26:27], v2 offset:42496
    v_mfma_f32_16x16x32_bf16 v[60:63], v[212:215], v[28:31], v[60:63]
    v_mfma_f32_16x16x32_bf16 v[44:47], v[132:135], v[28:31], v[44:47]
    s_waitcnt lgkmcnt(4)
    ds_read_b64_tr_b16 v[28:29], v3 offset:41472
    ds_read_b64_tr_b16 v[30:31], v3 offset:42496
    v_mfma_f32_16x16x32_bf16 v[32:35], v[136:139], v[16:19], v[32:35]
    v_mfma_f32_16x16x32_bf16 v[48:51], v[216:219], v[16:19], v[48:51]
    s_waitcnt lgkmcnt(4)
    ds_read_b64_tr_b16 v[16:17], v2 offset:45056
    ds_read_b64_tr_b16 v[18:19], v2 offset:46080
    v_mfma_f32_16x16x32_bf16 v[52:55], v[216:219], v[20:23], v[52:55]
    v_mfma_f32_16x16x32_bf16 v[36:39], v[136:139], v[20:23], v[36:39]
    s_waitcnt lgkmcnt(4)
    ds_read_b64_tr_b16 v[20:21], v3 offset:45056
    ds_read_b64_tr_b16 v[22:23], v3 offset:46080
    v_mfma_f32_16x16x32_bf16 v[40:43], v[136:139], v[24:27], v[40:43]
    v_mfma_f32_16x16x32_bf16 v[56:59], v[216:219], v[24:27], v[56:59]
    s_waitcnt lgkmcnt(4)
    ds_read_b64_tr_b16 v[24:25], v2 offset:45568
    ds_read_b64_tr_b16 v[26:27], v2 offset:46592
    v_mfma_f32_16x16x32_bf16 v[60:63], v[216:219], v[28:31], v[60:63]
    s_add_u32 m0, s44, 16384
    s_cmp_eq_u32 s45, s99
    v_mfma_f32_16x16x32_bf16 v[44:47], v[136:139], v[28:31], v[44:47]
    s_waitcnt lgkmcnt(4)
    ds_read_b64_tr_b16 v[28:29], v3 offset:45568
    ds_read_b64_tr_b16 v[30:31], v3 offset:46592
    v_mfma_f32_16x16x32_bf16 v[32:35], v[140:143], v[16:19], v[32:35]
    s_waitcnt vmcnt(8)
    s_barrier
    s_cbranch_scc1 g1_pzv
g1_pzrv:
    v_mfma_f32_16x16x32_bf16 v[48:51], v[220:223], v[16:19], v[48:51]
    s_waitcnt lgkmcnt(4)
    ds_read_b64_tr_b16 v[16:17], v2 offset:49152
    ds_read_b64_tr_b16 v[18:19], v2 offset:50176
    v_mfma_f32_16x16x32_bf16 v[52:55], v[220:223], v[20:23], v[52:55]
    buffer_load_dwordx4 v6, s[32:35], s49 offen offset:0 lds
    v_mfma_f32_16x16x32_bf16 v[36:39], v[140:143], v[20:23], v[36:39]
    s_waitcnt lgkmcnt(4)
    ds_read_b64_tr_b16 v[20:21], v3 offset:49152
    ds_read_b64_tr_b16 v[22:23], v3 offset:50176
    v_mfma_f32_16x16x32_bf16 v[40:43], v[140:143], v[24:27], v[40:43]
    s_mul_i32 s58, s43, 1280
    s_add_u32 s58, s58, 5242880
    v_mfma_f32_16x16x32_bf16 v[56:59], v[220:223], v[24:27], v[56:59]
    s_waitcnt lgkmcnt(4)
    ds_read_b64_tr_b16 v[24:25], v2 offset:49664
    ds_read_b64_tr_b16 v[26:27], v2 offset:50688
    v_mfma_f32_16x16x32_bf16 v[60:63], v[220:223], v[28:31], v[60:63]
    s_add_u32 s49, s49, s50
    buffer_load_dwordx4 v6, s[32:35], s49 offen offset:1024 lds
    v_mfma_f32_16x16x32_bf16 v[44:47], v[140:143], v[28:31], v[44:47]
    s_waitcnt lgkmcnt(4)
    ds_read_b64_tr_b16 v[28:29], v3 offset:49664
    ds_read_b64_tr_b16 v[30:31], v3 offset:50688
    v_mfma_f32_16x16x32_bf16 v[32:35], v[144:147], v[16:19], v[32:35]
    v_mfma_f32_16x16x32_bf16 v[48:51], v[224:227], v[16:19], v[48:51]
    s_waitcnt lgkmcnt(4)
    ds_read_b64_tr_b16 v[16:17], v2 offset:53248
    ds_read_b64_tr_b16 v[18:19], v2 offset:54272
    v_mfma_f32_16x16x32_bf16 v[52:55], v[224:227], v[20:23], v[52:55]
    s_add_u32 s49, s49, s51
    buffer_load_dwordx4 v6, s[32:35], s49 offen offset:2048 lds
    v_mfma_f32_16x16x32_bf16 v[36:39], v[144:147], v[20:23], v[36:39]
    s_waitcnt lgkmcnt(4)
    ds_read_b64_tr_b16 v[20:21], v3 offset:53248
    ds_read_b64_tr_b16 v[22:23], v3 offset:54272
    v_mfma_f32_16x16x32_bf16 v[40:43], v[144:147], v[24:27], v[40:43]
    v_mfma_f32_16x16x32_bf16 v[56:59], v[224:227], v[24:27], v[56:59]
    s_waitcnt lgkmcnt(4)
    ds_read_b64_tr_b16 v[24:25], v2 offset:53760
    ds_read_b64_tr_b16 v[26:27], v2 offset:54784
    v_mfma_f32_16x16x32_bf16 v[60:63], v[224:227], v[28:31], v[60:63]
    s_add_u32 s49, s49, s50
    buffer_load_dwordx4 v6, s[32:35], s49 offen offset:3072 lds
    v_mfma_f32_16x16x32_bf16 v[44:47], v[144:147], v[28:31], v[44:47]
    s_waitcnt lgkmcnt(4)
    ds_read_b64_tr_b16 v[28:29], v3 offset:53760
    ds_read_b64_tr_b16 v[30:31], v3 offset:54784
    v_mfma_f32_16x16x32_bf16 v[32:35], v[148:151], v[16:19], v[32:35]
    s_add_u32 s49, s49, s52
    s_cmp_ge_u32 s49, s34
    s_cselect_b32 s101, s34, 0
    v_mfma_f32_16x16x32_bf16 v[48:51], v[228:231], v[16:19], v[48:51]
    s_waitcnt lgkmcnt(4)
    ds_read_b64_tr_b16 v[16:17], v2 offset:57344
    ds_read_b64_tr_b16 v[18:19], v2 offset:58368
    v_mfma_f32_16x16x32_bf16 v[52:55], v[228:231], v[20:23], v[52:55]
    s_sub_u32 s49, s49, s101
    v_mfma_f32_16x16x32_bf16 v[36:39], v[148:151], v[20:23], v[36:39]
    s_waitcnt lgkmcnt(4)
    ds_read_b64_tr_b16 v[20:21], v3 offset:57344
    ds_read_b64_tr_b16 v[22:23], v3 offset:58368
    v_mfma_f32_16x16x32_bf16 v[40:43], v[148:151], v[24:27], v[40:43]
    v_mfma_f32_16x16x32_bf16 v[56:59], v[228:231], v[24:27], v[56:59]
    s_waitcnt lgkmcnt(4)
    ds_read_b64_tr_b16 v[24:25], v2 offset:57856
    ds_read_b64_tr_b16 v[26:27], v2 offset:58880
    v_mfma_f32_16x16x32_bf16 v[60:63], v[228:231], v[28:31], v[60:63]
    v_mfma_f32_16x16x32_bf16 v[44:47], v[148:151], v[28:31], v[44:47]
    s_waitcnt lgkmcnt(4)
    ds_read_b64_tr_b16 v[28:29], v3 offset:57856
    ds_read_b64_tr_b16 v[30:31], v3 offset:58880
    v_mfma_f32_16x16x32_bf16 v[32:35], v[152:155], v[16:19], v[32:35]
    v_mfma_f32_16x16x32_bf16 v[48:51], v[232:235], v[16:19], v[48:51]
    s_waitcnt lgkmcnt(4)
    ds_read_b64_tr_b16 v[16:17], v2 offset:61440
    ds_read_b64_tr_b16 v[18:19], v2 offset:62464
    v_mfma_f32_16x16x32_bf16 v[52:55], v[232:235], v[20:23], v[52:55]
    v_mfma_f32_16x16x32_bf16 v[36:39], v[152:155], v[20:23], v[36:39]
    s_waitcnt lgkmcnt(4)
    ds_read_b64_tr_b16 v[20:21], v3 offset:61440
    ds_read_b64_tr_b16 v[22:23], v3 offset:62464
    v_mfma_f32_16x16x32_bf16 v[40:43], v[152:155], v[24:27], v[40:43]
    v_mfma_f32_16x16x32_bf16 v[56:59], v[232:235], v[24:27], v[56:59]
    s_waitcnt lgkmcnt(4)
    ds_read_b64_tr_b16 v[24:25], v2 offset:61952
    ds_read_b64_tr_b16 v[26:27], v2 offset:62976
    v_mfma_f32_16x16x32_bf16 v[60:63], v[232:235], v[28:31], v[60:63]
    s_add_u32 m0, s44, 32768
    v_mfma_f32_16x16x32_bf16 v[44:47], v[152:155], v[28:31], v[44:47]
    s_waitcnt lgkmcnt(4)
    ds_read_b64_tr_b16 v[28:29], v3 offset:61952
    ds_read_b64_tr_b16 v[30:31], v3 offset:62976
    v_mfma_f32_16x16x32_bf16 v[32:35], v[156:159], v[16:19], v[32:35]
    s_waitcnt vmcnt(8)
    s_barrier
    v_mfma_f32_16x16x32_bf16 v[48:51], v[236:239], v[16:19], v[48:51]
    s_waitcnt lgkmcnt(4)
    ds_read_b64_tr_b16 v[16:17], v4 offset:0
    ds_read_b64_tr_b16 v[18:19], v4 offset:1024
    v_mfma_f32_16x16x32_bf16 v[52:55], v[236:239], v[20:23], v[52:55]
    buffer_load_dwordx4 v6, s[32:35], s49 offen offset:0 lds
    v_mfma_f32_16x16x32_bf16 v[36:39], v[156:159], v[20:23], v[36:39]
    s_waitcnt lgkmcnt(4)
    ds_read_b64_tr_b16 v[20:21], v5 offset:0
    ds_read_b64_tr_b16 v[22:23], v5 offset:1024
    v_mfma_f32_16x16x32_bf16 v[40:43], v[156:159], v[24:27], v[40:43]
    s_cmp_eq_u32 s45, 0
    s_cbranch_scc1 g1_nlv
g1_nlrv:
    v_mfma_f32_16x16x32_bf16 v[56:59], v[236:239], v[24:27], v[56:59]
    s_waitcnt lgkmcnt(4)
    ds_read_b64_tr_b16 v[24:25], v4 offset:512
    ds_read_b64_tr_b16 v[26:27], v4 offset:1536
    v_mfma_f32_16x16x32_bf16 v[60:63], v[236:239], v[28:31], v[60:63]
    s_add_u32 s49, s49, s50
    buffer_load_dwordx4 v6, s[32:35], s49 offen offset:1024 lds
    v_mfma_f32_16x16x32_bf16 v[44:47], v[156:159], v[28:31], v[44:47]
    s_waitcnt lgkmcnt(4)
    ds_read_b64_tr_b16 v[28:29], v5 offset:512
    ds_read_b64_tr_b16 v[30:31], v5 offset:1536
    v_mfma_f32_16x16x32_bf16 v[32:35], v[160:163], v[16:19], v[32:35]
    v_mfma_f32_16x16x32_bf16 v[48:51], v[240:243], v[16:19], v[48:51]
    s_waitcnt lgkmcnt(4)
    ds_read_b64_tr_b16 v[16:17], v4 offset:4096
    ds_read_b64_tr_b16 v[18:19], v4 offset:5120
    v_mfma_f32_16x16x32_bf16 v[52:55], v[240:243], v[20:23], v[52:55]
    s_add_u32 s49, s49, s51
    buffer_load_dwordx4 v6, s[32:35], s49 offen offset:2048 lds
    v_mfma_f32_16x16x32_bf16 v[36:39], v[160:163], v[20:23], v[36:39]
    s_waitcnt lgkmcnt(4)
    ds_read_b64_tr_b16 v[20:21], v5 offset:4096
    ds_read_b64_tr_b16 v[22:23], v5 offset:5120
    v_mfma_f32_16x16x32_bf16 v[40:43], v[160:163], v[24:27], v[40:43]
    v_mfma_f32_16x16x32_bf16 v[56:59], v[240:243], v[24:27], v[56:59]
    s_waitcnt lgkmcnt(4)
    ds_read_b64_tr_b16 v[24:25], v4 offset:4608
    ds_read_b64_tr_b16 v[26:27], v4 offset:5632
    v_mfma_f32_16x16x32_bf16 v[60:63], v[240:243], v[28:31], v[60:63]
    s_add_u32 s49, s49, s50
    buffer_load_dwordx4 v6, s[32:35], s49 offen offset:3072 lds
    v_mfma_f32_16x16x32_bf16 v[44:47], v[160:163], v[28:31], v[44:47]
    s_waitcnt lgkmcnt(4)
    ds_read_b64_tr_b16 v[28:29], v5 offset:4608
    ds_read_b64_tr_b16 v[30:31], v5 offset:5632
    v_mfma_f32_16x16x32_bf16 v[32:35], v[164:167], v[16:19], v[32:35]
    s_add_u32 s49, s49, s52
    s_cmp_ge_u32 s49, s34
    s_cselect_b32 s101, s34, 0
    v_mfma_f32_16x16x32_bf16 v[48:51], v[244:247], v[16:19], v[48:51]
    s_waitcnt lgkmcnt(4)
    ds_read_b64_tr_b16 v[16:17], v4 offset:8192
    ds_read_b64_tr_b16 v[18:19], v4 offset:9216
    v_mfma_f32_16x16x32_bf16 v[52:55], v[244:247], v[20:23], v[52:55]
    s_sub_u32 s49, s49, s101
    v_mfma_f32_16x16x32_bf16 v[36:39], v[164:167], v[20:23], v[36:39]
    s_waitcnt lgkmcnt(4)
    ds_read_b64_tr_b16 v[20:21], v5 offset:8192
    ds_read_b64_tr_b16 v[22:23], v5 offset:9216
    v_mfma_f32_16x16x32_bf16 v[40:43], v[164:167], v[24:27], v[40:43]
    v_mfma_f32_16x16x32_bf16 v[56:59], v[244:247], v[24:27], v[56:59]
    s_waitcnt lgkmcnt(4)
    ds_read_b64_tr_b16 v[24:25], v4 offset:8704
    ds_read_b64_tr_b16 v[26:27], v4 offset:9728
    v_mfma_f32_16x16x32_bf16 v[60:63], v[244:247], v[28:31], v[60:63]
    v_mfma_f32_16x16x32_bf16 v[44:47], v[164:167], v[28:31], v[44:47]
    s_waitcnt lgkmcnt(4)
    ds_read_b64_tr_b16 v[28:29], v5 offset:8704
    ds_read_b64_tr_b16 v[30:31], v5 offset:9728
    v_mfma_f32_16x16x32_bf16 v[32:35], v[168:171], v[16:19], v[32:35]
    v_mfma_f32_16x16x32_bf16 v[48:51], v[248:251], v[16:19], v[48:51]
    s_waitcnt lgkmcnt(4)
    ds_read_b64_tr_b16 v[16:17], v4 offset:12288
    ds_read_b64_tr_b16 v[18:19], v4 offset:13312
    v_mfma_f32_16x16x32_bf16 v[52:55], v[248:251], v[20:23], v[52:55]
    v_mfma_f32_16x16x32_bf16 v[36:39], v[168:171], v[20:23], v[36:39]
    s_waitcnt lgkmcnt(4)
    ds_read_b64_tr_b16 v[20:21], v5 offset:12288
    ds_read_b64_tr_b16 v[22:23], v5 offset:13312
    v_mfma_f32_16x16x32_bf16 v[40:43], v[168:171], v[24:27], v[40:43]
    v_mfma_f32_16x16x32_bf16 v[56:59], v[248:251], v[24:27], v[56:59]
    s_waitcnt lgkmcnt(4)
    ds_read_b64_tr_b16 v[24:25], v4 offset:12800
    ds_read_b64_tr_b16 v[26:27], v4 offset:13824
    v_mfma_f32_16x16x32_bf16 v[60:63], v[248:251], v[28:31], v[60:63]
    s_add_u32 m0, s44, 49152
    v_mfma_f32_16x16x32_bf16 v[44:47], v[168:171], v[28:31], v[44:47]
    s_waitcnt lgkmcnt(4)
    ds_read_b64_tr_b16 v[28:29], v5 offset:12800
    ds_read_b64_tr_b16 v[30:31], v5 offset:13824
    v_mfma_f32_16x16x32_bf16 v[32:35], v[172:175], v[16:19], v[32:35]
    s_waitcnt vmcnt(8)
    s_barrier
    v_mfma_f32_16x16x32_bf16 v[48:51], v[252:255], v[16:19], v[48:51]
    s_waitcnt lgkmcnt(4)
    ds_read_b64_tr_b16 v[16:17], v2 offset:0
    ds_read_b64_tr_b16 v[18:19], v2 offset:1024
    v_mfma_f32_16x16x32_bf16 v[52:55], v[252:255], v[20:23], v[52:55]
    buffer_load_dwordx4 v6, s[32:35], s49 offen offset:0 lds
    v_mfma_f32_16x16x32_bf16 v[36:39], v[172:175], v[20:23], v[36:39]
    s_waitcnt lgkmcnt(4)
    ds_read_b64_tr_b16 v[20:21], v3 offset:0
    ds_read_b64_tr_b16 v[22:23], v3 offset:1024
    v_mfma_f32_16x16x32_bf16 v[40:43], v[172:175], v[24:27], v[40:43]
    v_mfma_f32_16x16x32_bf16 v[56:59], v[252:255], v[24:27], v[56:59]
    s_waitcnt lgkmcnt(4)
    ds_read_b64_tr_b16 v[24:25], v2 offset:512
    ds_read_b64_tr_b16 v[26:27], v2 offset:1536
    v_mfma_f32_16x16x32_bf16 v[60:63], v[252:255], v[28:31], v[60:63]
    s_add_u32 s49, s49, s50
    buffer_load_dwordx4 v6, s[32:35], s49 offen offset:1024 lds
    v_mfma_f32_16x16x32_bf16 v[44:47], v[172:175], v[28:31], v[44:47]
    s_waitcnt lgkmcnt(4)
    ds_read_b64_tr_b16 v[28:29], v3 offset:512
    ds_read_b64_tr_b16 v[30:31], v3 offset:1536
    s_setprio 2
    v_pk_mul_f32 v[32:33], v[32:33], v[80:81] op_sel:[0,0] op_sel_hi:[1,1]
    v_pk_mul_f32 v[34:35], v[34:35], v[82:83] op_sel:[0,0] op_sel_hi:[1,1]
    v_pk_mul_f32 v[48:49], v[48:49], v[84:85] op_sel:[0,0] op_sel_hi:[1,1]
    v_pk_mul_f32 v[50:51], v[50:51], v[86:87] op_sel:[0,0] op_sel_hi:[1,1]
    v_cvt_pk_bf16_f32 v64, v32, v33
    v_cvt_pk_bf16_f32 v65, v34, v35
    v_cvt_pk_bf16_f32 v66, v48, v49
    v_cvt_pk_bf16_f32 v67, v50, v51
    buffer_store_dwordx4 v[64:67], v88, s[24:27], s58 offen sc1
    v_pk_mul_f32 v[36:37], v[36:37], v[80:81] op_sel:[0,0] op_sel_hi:[1,1]
    v_pk_mul_f32 v[38:39], v[38:39], v[82:83] op_sel:[0,0] op_sel_hi:[1,1]
    v_pk_mul_f32 v[52:53], v[52:53], v[84:85] op_sel:[0,0] op_sel_hi:[1,1]
    v_pk_mul_f32 v[54:55], v[54:55], v[86:87] op_sel:[0,0] op_sel_hi:[1,1]
    v_cvt_pk_bf16_f32 v68, v36, v37
    v_cvt_pk_bf16_f32 v69, v38, v39
    v_cvt_pk_bf16_f32 v70, v52, v53
    v_cvt_pk_bf16_f32 v71, v54, v55
    buffer_store_dwordx4 v[68:71], v89, s[24:27], s58 offen sc1
    v_pk_mul_f32 v[40:41], v[40:41], v[80:81] op_sel:[0,0] op_sel_hi:[1,1]
    v_pk_mul_f32 v[42:43], v[42:43], v[82:83] op_sel:[0,0] op_sel_hi:[1,1]
    v_pk_mul_f32 v[56:57], v[56:57], v[84:85] op_sel:[0,0] op_sel_hi:[1,1]
    v_pk_mul_f32 v[58:59], v[58:59], v[86:87] op_sel:[0,0] op_sel_hi:[1,1]
    v_cvt_pk_bf16_f32 v72, v40, v41
    v_cvt_pk_bf16_f32 v73, v42, v43
    v_cvt_pk_bf16_f32 v74, v56, v57
    v_cvt_pk_bf16_f32 v75, v58, v59
    buffer_store_dwordx4 v[72:75], v90, s[24:27], s58 offen sc1
    v_pk_mul_f32 v[44:45], v[44:45], v[80:81] op_sel:[0,0] op_sel_hi:[1,1]
    v_pk_mul_f32 v[46:47], v[46:47], v[82:83] op_sel:[0,0] op_sel_hi:[1,1]
    v_pk_mul_f32 v[60:61], v[60:61], v[84:85] op_sel:[0,0] op_sel_hi:[1,1]
    v_pk_mul_f32 v[62:63], v[62:63], v[86:87] op_sel:[0,0] op_sel_hi:[1,1]
    v_cvt_pk_bf16_f32 v76, v44, v45
    v_cvt_pk_bf16_f32 v77, v46, v47
    v_cvt_pk_bf16_f32 v78, v60, v61
    v_cvt_pk_bf16_f32 v79, v62, v63
    buffer_store_dwordx4 v[76:79], v91, s[24:27], s58 offen sc1
    s_cmp_eq_u32 s45, 1
    s_cbranch_scc1 g1_qdone
    v_mov_b32 v88, v92
    v_mov_b32 v89, v93
    v_mov_b32 v90, v94
    v_mov_b32 v91, v95
    s_mov_b32 s45, 1
    s_waitcnt vmcnt(9)
    s_mov_b32 s55, 0x20000
g1_ncv:
    v_readfirstlane_b32 s54, v11
    s_sub_u32 s55, s55, 1
    s_cbranch_scc1 g1_vloop
    s_cmp_lg_u32 s54, 0
    s_cbranch_scc1 g1_vloop
    s_sleep 2
    v_mov_b32 v11, 0
    global_load_dword v11, v11, s[20:21] sc1
    s_waitcnt vmcnt(0)
    s_branch g1_ncv
g1_ncv_ok:
g1_nlv:
    global_load_dword v11, v11, s[20:21] sc1
    s_branch g1_nlrv
g1_swv:
    v_mad_u32_u24 v6, v7, s53, v8
    s_branch g1_swrv
g1_pubv:
    s_waitcnt vmcnt(2)
    s_barrier
    s_cmp_lt_u32 5, s98
    s_cbranch_scc1 g1_pubhiv
    s_setprio 0
g1_pubhiv:
    s_cmp_lg_u32 s40, 0
    s_cbranch_scc1 g1_pubretv
    s_lshl4_add_u32 s101, s42, s41
    s_mul_i32 s101, s101, 64
    s_add_u32 s101, s101, 20856832
    s_mov_b64 exec, 1
    buffer_store_dword v11, off, s[24:27], s101 sc1
    s_mov_b64 exec, -1
    s_branch g1_pubretv
g1_nln:
    global_load_dword v11, v11, s[20:21] sc1
    s_branch g1_nlrn
g1_swn:
    v_mad_u32_u24 v6, v7, s53, v8
    s_branch g1_swrn
g1_pubn:
    s_waitcnt vmcnt(2)
    s_barrier
    s_cmp_lt_u32 5, s98
    s_cbranch_scc1 g1_pubhin
    s_setprio 0
g1_pubhin:
    s_cmp_lg_u32 s40, 0
    s_cbranch_scc1 g1_pubretn
    s_lshl4_add_u32 s101, s42, s41
    s_mul_i32 s101, s101, 64
    s_add_u32 s101, s101, 20856832
    s_mov_b64 exec, 1
    buffer_store_dword v11, off, s[24:27], s101 sc1
    s_mov_b64 exec, -1
    s_branch g1_pubretn
g1_lo:
    s_setprio 0
    s_branch g1_lor
g1_chk:
    buffer_load_dword v8, v7, s[24:27], 0 offen sc1
    s_branch g1_chkr
g1_pzv:
    s_mov_b64 exec, 1
    buffer_store_dword v11, off, s[24:27], s100 sc1
    s_mov_b64 exec, -1
    s_mov_b32 s99, 4
    s_lshl4_add_u32 s100, s41, s42
    s_lshl_b32 s100, s100, 6
    s_add_u32 s100, s100, 20611072
    s_branch g1_pzrv
g1_pzn:
    s_mov_b64 exec, 1
    buffer_store_dword v11, off, s[24:27], s100 sc1
    s_mov_b64 exec, -1
    s_mov_b32 s99, 4
    s_lshl4_add_u32 s100, s41, s42
    s_lshl_b32 s100, s100, 6
    s_add_u32 s100, s100, 20611072
    s_branch g1_pzrn
g1_eq:
    v_pk_mul_f32 v[32:33], v[32:33], v[10:11] op_sel:[0,0] op_sel_hi:[1,0]
    v_pk_mul_f32 v[34:35], v[34:35], v[10:11] op_sel:[0,0] op_sel_hi:[1,0]
    v_pk_mul_f32 v[36:37], v[36:37], v[10:11] op_sel:[0,0] op_sel_hi:[1,0]
    v_pk_mul_f32 v[38:39], v[38:39], v[10:11] op_sel:[0,0] op_sel_hi:[1,0]
    v_cvt_pk_bf16_f32 v64, v32, v33
    v_cvt_pk_bf16_f32 v65, v34, v35
    v_cvt_pk_bf16_f32 v66, v36, v37
    v_cvt_pk_bf16_f32 v67, v38, v39
    v_pk_mul_f32 v[48:49], v[48:49], v[14:15] op_sel:[0,0] op_sel_hi:[1,0]
    v_pk_mul_f32 v[50:51], v[50:51], v[14:15] op_sel:[0,0] op_sel_hi:[1,0]
    v_pk_mul_f32 v[52:53], v[52:53], v[14:15] op_sel:[0,0] op_sel_hi:[1,0]
    v_pk_mul_f32 v[54:55], v[54:55], v[14:15] op_sel:[0,0] op_sel_hi:[1,0]
    v_cvt_pk_bf16_f32 v68, v48, v49
    v_cvt_pk_bf16_f32 v69, v50, v51
    v_cvt_pk_bf16_f32 v70, v52, v53
    v_cvt_pk_bf16_f32 v71, v54, v55
    v_permlane16_swap_b32 v64, v66
    v_permlane16_swap_b32 v65, v67
    v_permlane16_swap_b32 v68, v70
    v_permlane16_swap_b32 v69, v71
    s_mov_b64 exec, s[60:61]
    v_swap_b32 v66, v68
    v_swap_b32 v67, v69
    s_mov_b64 exec, -1
    buffer_store_dwordx4 v[64:67], v9, s[24:27], s58 offen offset:0 sc1
    buffer_store_dwordx4 v[68:71], v9, s[24:27], s58 offen offset:256 sc1
    v_pk_mul_f32 v[40:41], v[40:41], v[10:11] op_sel:[0,0] op_sel_hi:[1,0]
    v_pk_mul_f32 v[42:43], v[42:43], v[10:11] op_sel:[0,0] op_sel_hi:[1,0]
    v_pk_mul_f32 v[44:45], v[44:45], v[10:11] op_sel:[0,0] op_sel_hi:[1,0]
    v_pk_mul_f32 v[46:47], v[46:47], v[10:11] op_sel:[0,0] op_sel_hi:[1,0]
    v_cvt_pk_bf16_f32 v72, v40, v41
    v_cvt_pk_bf16_f32 v73, v42, v43
    v_cvt_pk_bf16_f32 v74, v44, v45
    v_cvt_pk_bf16_f32 v75, v46, v47
    v_pk_mul_f32 v[56:57], v[56:57], v[14:15] op_sel:[0,0] op_sel_hi:[1,0]
    v_pk_mul_f32 v[58:59], v[58:59], v[14:15] op_sel:[0,0] op_sel_hi:[1,0]
    v_pk_mul_f32 v[60:61], v[60:61], v[14:15] op_sel:[0,0] op_sel_hi:[1,0]
    v_pk_mul_f32 v[62:63], v[62:63], v[14:15] op_sel:[0,0] op_sel_hi:[1,0]
    v_cvt_pk_bf16_f32 v76, v56, v57
    v_cvt_pk_bf16_f32 v77, v58, v59
    v_cvt_pk_bf16_f32 v78, v60, v61
    v_cvt_pk_bf16_f32 v79, v62, v63
    v_permlane16_swap_b32 v72, v74
    v_permlane16_swap_b32 v73, v75
    v_permlane16_swap_b32 v76, v78
    v_permlane16_swap_b32 v77, v79
    s_mov_b64 exec, s[38:39]
    v_swap_b32 v74, v76
    v_swap_b32 v75, v77
    s_mov_b64 exec, -1
    buffer_store_dwordx4 v[72:75], v9, s[24:27], s57 offen offset:0 sc1
    buffer_store_dwordx4 v[76:79], v9, s[24:27], s57 offen offset:256 sc1
    s_cmp_eq_u32 s45, 1
    s_cbranch_scc1 g1_qdone
    s_mov_b32 s45, 1
    s_waitcnt vmcnt(9)
    s_mov_b32 s55, 0x20000
g1_ncq:
    v_readfirstlane_b32 s54, v11
    s_sub_u32 s55, s55, 1
    s_cbranch_scc1 g1_hi
    s_cmp_lg_u32 s54, 0
    s_cbranch_scc1 g1_hi
    s_sleep 2
    v_mov_b32 v11, 0
    global_load_dword v11, v11, s[20:21] sc1
    s_waitcnt vmcnt(0)
    s_branch g1_ncq
g1_ncq_ok:
g1_qdone:
    s_mov_b32 s45, 2
g1_toffn:
    v_rcp_f32 v12, v13
    v_mul_f32 v13, v13, v13
    v_mul_f32 v10, 0xc0135761, v12
    v_mul_f32 v12, v12, v12
    v_mul_f32 v12, v12, v10
    v_mul_f32 v12, 0x3d372713, v12
    v_rcp_f32 v15, v0
    v_mul_f32 v0, v0, v0
    v_mul_f32 v14, 0xc0135761, v15
    v_mul_f32 v15, v15, v15
    v_mul_f32 v15, v15, v14
    v_mul_f32 v15, 0x3d372713, v15
    v_lshlrev_b32 v9, 4, v1
    s_lshr_b32 s54, s2, 7
    s_lshl_b32 s54, s54, 12
    s_add_u32 s54, s54, 20758528
    s_and_b32 s55, s2, 7
    s_lshl_b32 s55, s55, 1
    s_bfe_u32 s56, s2, 65540
    s_add_u32 s55, s55, s56
    s_lshl_b32 s55, s55, 10
    s_add_u32 s55, s55, 20608000
    v_mov_b32 v7, s54
    s_mov_b32 exec_lo, 0
    s_mov_b32 exec_hi, 0xffff0000
    v_mov_b32 v7, s55
    s_mov_b64 exec, -1
    v_lshl_add_u32 v7, v1, 6, v7
    s_mov_b32 exec_lo, 0
    s_mov_b32 exec_hi, 0xffff
    s_lshl_b32 s54, s2, 6
    s_add_u32 s54, s54, 20783136
    v_mov_b32 v7, s54
    s_mov_b64 exec, -1
    v_mov_b32 v8, 0
g1_loop:
    s_lshl_b32 s54, s45, 1
    s_cmp_lt_u32 s54, s98
    s_cbranch_scc1 g1_hi
    s_setprio 0
g1_hi:
    s_waitcnt lgkmcnt(6)
    v_mfma_f32_16x16x32_bf16 v[32:35], v[16:19], v[96:99], 0
    s_add_u32 s49, s49, s51
    buffer_load_dwordx4 v6, s[32:35], s49 offen offset:2048 lds
    v_mfma_f32_16x16x32_bf16 v[48:51], v[16:19], v[176:179], 0
    s_waitcnt lgkmcnt(4)
    ds_read_b64_tr_b16 v[16:17], v2 offset:4096
    ds_read_b64_tr_b16 v[18:19], v2 offset:5120
    v_mfma_f32_16x16x32_bf16 v[52:55], v[20:23], v[176:179], 0
    s_add_u32 s54, s45, 1
    s_sub_u32 s55, s54, s47
    s_lshr_b32 s55, s55, 1
    v_mfma_f32_16x16x32_bf16 v[36:39], v[20:23], v[96:99], 0
    s_waitcnt lgkmcnt(4)
    ds_read_b64_tr_b16 v[20:21], v3 offset:4096
    ds_read_b64_tr_b16 v[22:23], v3 offset:5120
    v_mfma_f32_16x16x32_bf16 v[40:43], v[24:27], v[96:99], 0
    s_add_u32 s49, s49, s50
    buffer_load_dwordx4 v6, s[32:35], s49 offen offset:3072 lds
    v_mfma_f32_16x16x32_bf16 v[56:59], v[24:27], v[176:179], 0
    s_waitcnt lgkmcnt(4)
    ds_read_b64_tr_b16 v[24:25], v2 offset:4608
    ds_read_b64_tr_b16 v[26:27], v2 offset:5632
    v_mfma_f32_16x16x32_bf16 v[60:63], v[28:31], v[176:179], 0
    s_mul_i32 s55, s55, s48
    s_add_u32 s55, s55, s42
    s_mul_i32 s56, s54, 5
    v_mfma_f32_16x16x32_bf16 v[44:47], v[28:31], v[96:99], 0
    s_waitcnt lgkmcnt(4)
    ds_read_b64_tr_b16 v[28:29], v3 offset:4608
    ds_read_b64_tr_b16 v[30:31], v3 offset:5632
    v_mfma_f32_16x16x32_bf16 v[32:35], v[16:19], v[100:103], v[32:35]
    s_add_u32 s49, s49, s52
    s_cmp_ge_u32 s49, s34
    s_cselect_b32 s101, s34, 0
    v_mfma_f32_16x16x32_bf16 v[48:51], v[16:19], v[180:183], v[48:51]
    s_waitcnt lgkmcnt(4)
    ds_read_b64_tr_b16 v[16:17], v2 offset:8192
    ds_read_b64_tr_b16 v[18:19], v2 offset:9216
    v_mfma_f32_16x16x32_bf16 v[52:55], v[20:23], v[180:183], v[52:55]
    s_sub_u32 s49, s49, s101
    v_mfma_f32_16x16x32_bf16 v[36:39], v[20:23], v[100:103], v[36:39]
    s_waitcnt lgkmcnt(4)
    ds_read_b64_tr_b16 v[20:21], v3 offset:8192
    ds_read_b64_tr_b16 v[22:23], v3 offset:9216
    v_mfma_f32_16x16x32_bf16 v[40:43], v[24:27], v[100:103], v[40:43]
    s_add_u32 s56, s56, s36
    s_movk_i32 s53, 3456
    v_mfma_f32_16x16x32_bf16 v[56:59], v[24:27], v[180:183], v[56:59]
    s_waitcnt lgkmcnt(4)
    ds_read_b64_tr_b16 v[24:25], v2 offset:8704
    ds_read_b64_tr_b16 v[26:27], v2 offset:9728
    v_mfma_f32_16x16x32_bf16 v[60:63], v[28:31], v[180:183], v[60:63]
    s_cmp_lt_u32 s54, s47
    s_cselect_b32 s55, s56, s55
    s_cselect_b32 s53, 3840, s53
    v_mfma_f32_16x16x32_bf16 v[44:47], v[28:31], v[100:103], v[44:47]
    s_waitcnt lgkmcnt(4)
    ds_read_b64_tr_b16 v[28:29], v3 offset:8704
    ds_read_b64_tr_b16 v[30:31], v3 offset:9728
    v_mfma_f32_16x16x32_bf16 v[32:35], v[16:19], v[104:107], v[32:35]
    s_mul_i32 s56, s96, s53
    s_add_u32 s55, s55, s56
    v_mfma_f32_16x16x32_bf16 v[48:51], v[16:19], v[184:187], v[48:51]
    s_waitcnt lgkmcnt(4)
    ds_read_b64_tr_b16 v[16:17], v2 offset:12288
    ds_read_b64_tr_b16 v[18:19], v2 offset:13312
    v_mfma_f32_16x16x32_bf16 v[52:55], v[20:23], v[184:187], v[52:55]
    v_mfma_f32_16x16x32_bf16 v[36:39], v[20:23], v[104:107], v[36:39]
    s_waitcnt lgkmcnt(4)
    ds_read_b64_tr_b16 v[20:21], v3 offset:12288
    ds_read_b64_tr_b16 v[22:23], v3 offset:13312
    v_mfma_f32_16x16x32_bf16 v[40:43], v[24:27], v[104:107], v[40:43]
    v_mfma_f32_16x16x32_bf16 v[56:59], v[24:27], v[184:187], v[56:59]
    s_waitcnt lgkmcnt(4)
    ds_read_b64_tr_b16 v[24:25], v2 offset:12800
    ds_read_b64_tr_b16 v[26:27], v2 offset:13824
    v_mfma_f32_16x16x32_bf16 v[60:63], v[28:31], v[184:187], v[60:63]
    s_add_u32 m0, s44, 65536
    s_cmp_eq_u32 s45, s3
    v_mfma_f32_16x16x32_bf16 v[44:47], v[28:31], v[104:107], v[44:47]
    s_waitcnt lgkmcnt(4)
    ds_read_b64_tr_b16 v[28:29], v3 offset:12800
    ds_read_b64_tr_b16 v[30:31], v3 offset:13824
    v_mfma_f32_16x16x32_bf16 v[32:35], v[16:19], v[108:111], v[32:35]
    s_cbranch_scc1 g1_pubn
    s_waitcnt vmcnt(8)
    s_barrier
g1_pubretn:
    v_mfma_f32_16x16x32_bf16 v[48:51], v[16:19], v[188:191], v[48:51]
    s_waitcnt lgkmcnt(4)
    ds_read_b64_tr_b16 v[16:17], v2 offset:16384
    ds_read_b64_tr_b16 v[18:19], v2 offset:17408
    v_mfma_f32_16x16x32_bf16 v[52:55], v[20:23], v[188:191], v[52:55]
    buffer_load_dwordx4 v6, s[32:35], s49 offen offset:0 lds
    v_mfma_f32_16x16x32_bf16 v[36:39], v[20:23], v[108:111], v[36:39]
    s_waitcnt lgkmcnt(4)
    ds_read_b64_tr_b16 v[20:21], v3 offset:16384
    ds_read_b64_tr_b16 v[22:23], v3 offset:17408
    v_mfma_f32_16x16x32_bf16 v[40:43], v[24:27], v[108:111], v[40:43]
    v_mfma_f32_16x16x32_bf16 v[56:59], v[24:27], v[188:191], v[56:59]
    s_waitcnt lgkmcnt(4)
    ds_read_b64_tr_b16 v[24:25], v2 offset:16896
    ds_read_b64_tr_b16 v[26:27], v2 offset:17920
    v_mfma_f32_16x16x32_bf16 v[60:63], v[28:31], v[188:191], v[60:63]
    s_add_u32 s49, s49, s50
    buffer_load_dwordx4 v6, s[32:35], s49 offen offset:1024 lds
    v_mfma_f32_16x16x32_bf16 v[44:47], v[28:31], v[108:111], v[44:47]
    s_waitcnt lgkmcnt(4)
    ds_read_b64_tr_b16 v[28:29], v3 offset:16896
    ds_read_b64_tr_b16 v[30:31], v3 offset:17920
    v_mfma_f32_16x16x32_bf16 v[32:35], v[16:19], v[112:115], v[32:35]
    v_mfma_f32_16x16x32_bf16 v[48:51], v[16:19], v[192:195], v[48:51]
    s_waitcnt lgkmcnt(4)
    ds_read_b64_tr_b16 v[16:17], v2 offset:20480
    ds_read_b64_tr_b16 v[18:19], v2 offset:21504
    v_mfma_f32_16x16x32_bf16 v[52:55], v[20:23], v[192:195], v[52:55]
    s_add_u32 s49, s49, s51
    buffer_load_dwordx4 v6, s[32:35], s49 offen offset:2048 lds
    v_mfma_f32_16x16x32_bf16 v[36:39], v[20:23], v[112:115], v[36:39]
    s_waitcnt lgkmcnt(4)
    ds_read_b64_tr_b16 v[20:21], v3 offset:20480
    ds_read_b64_tr_b16 v[22:23], v3 offset:21504
    v_mfma_f32_16x16x32_bf16 v[40:43], v[24:27], v[112:115], v[40:43]
    v_mfma_f32_16x16x32_bf16 v[56:59], v[24:27], v[192:195], v[56:59]
    s_waitcnt lgkmcnt(4)
    ds_read_b64_tr_b16 v[24:25], v2 offset:20992
    ds_read_b64_tr_b16 v[26:27], v2 offset:22016
    v_mfma_f32_16x16x32_bf16 v[60:63], v[28:31], v[192:195], v[60:63]
    s_add_u32 s49, s49, s50
    buffer_load_dwordx4 v6, s[32:35], s49 offen offset:3072 lds
    v_mfma_f32_16x16x32_bf16 v[44:47], v[28:31], v[112:115], v[44:47]
    s_waitcnt lgkmcnt(4)
    ds_read_b64_tr_b16 v[28:29], v3 offset:20992
    ds_read_b64_tr_b16 v[30:31], v3 offset:22016
    v_mfma_f32_16x16x32_bf16 v[32:35], v[16:19], v[116:119], v[32:35]
    s_bitcmp1_b32 s54, 0
    s_cselect_b32 s32, s14, s12
    s_cselect_b32 s33, s15, s13
    v_mfma_f32_16x16x32_bf16 v[48:51], v[16:19], v[196:199], v[48:51]
    s_waitcnt lgkmcnt(4)
    ds_read_b64_tr_b16 v[16:17], v2 offset:24576
    ds_read_b64_tr_b16 v[18:19], v2 offset:25600
    v_mfma_f32_16x16x32_bf16 v[52:55], v[20:23], v[196:199], v[52:55]
    s_cmp_lt_u32 s54, s47
    s_cselect_b32 s32, s6, s32
    s_cselect_b32 s33, s7, s33
    v_mfma_f32_16x16x32_bf16 v[36:39], v[20:23], v[116:119], v[36:39]
    s_waitcnt lgkmcnt(4)
    ds_read_b64_tr_b16 v[20:21], v3 offset:24576
    ds_read_b64_tr_b16 v[22:23], v3 offset:25600
    v_mfma_f32_16x16x32_bf16 v[40:43], v[24:27], v[116:119], v[40:43]
    s_mul_i32 s34, s53, 640
    s_cmp_lt_u32 s54, s46
    s_cselect_b32 s34, s34, 0
    v_mfma_f32_16x16x32_bf16 v[56:59], v[24:27], v[196:199], v[56:59]
    s_waitcnt lgkmcnt(4)
    ds_read_b64_tr_b16 v[24:25], v2 offset:25088
    ds_read_b64_tr_b16 v[26:27], v2 offset:26112
    v_mfma_f32_16x16x32_bf16 v[60:63], v[28:31], v[196:199], v[60:63]
    s_lshl_b32 s49, s55, 7
    s_lshl_b32 s50, s53, 2
    s_mul_i32 s51, s53, 12
    v_mfma_f32_16x16x32_bf16 v[44:47], v[28:31], v[116:119], v[44:47]
    s_waitcnt lgkmcnt(4)
    ds_read_b64_tr_b16 v[28:29], v3 offset:25088
    ds_read_b64_tr_b16 v[30:31], v3 offset:26112
    v_mfma_f32_16x16x32_bf16 v[32:35], v[16:19], v[120:123], v[32:35]
    s_mul_i32 s52, s53, 108
    s_sub_u32 s50, s50, 1024
    s_sub_u32 s51, s51, 1024
    v_mfma_f32_16x16x32_bf16 v[48:51], v[16:19], v[200:203], v[48:51]
    s_waitcnt lgkmcnt(4)
    ds_read_b64_tr_b16 v[16:17], v2 offset:28672
    ds_read_b64_tr_b16 v[18:19], v2 offset:29696
    v_mfma_f32_16x16x32_bf16 v[52:55], v[20:23], v[200:203], v[52:55]
    s_add_u32 s52, s52, 3072
    v_mfma_f32_16x16x32_bf16 v[36:39], v[20:23], v[120:123], v[36:39]
    s_waitcnt lgkmcnt(4)
    ds_read_b64_tr_b16 v[20:21], v3 offset:28672
    ds_read_b64_tr_b16 v[22:23], v3 offset:29696
    v_mfma_f32_16x16x32_bf16 v[40:43], v[24:27], v[120:123], v[40:43]
    s_cmp_eq_u32 s45, s37
    s_cbranch_scc1 g1_swn
g1_swrn:
    v_mfma_f32_16x16x32_bf16 v[56:59], v[24:27], v[200:203], v[56:59]
    s_waitcnt lgkmcnt(4)
    ds_read_b64_tr_b16 v[24:25], v2 offset:29184
    ds_read_b64_tr_b16 v[26:27], v2 offset:30208
    v_mfma_f32_16x16x32_bf16 v[60:63], v[28:31], v[200:203], v[60:63]
    s_add_u32 m0, s44, 0
    v_mfma_f32_16x16x32_bf16 v[44:47], v[28:31], v[120:123], v[44:47]
    s_waitcnt lgkmcnt(4)
    ds_read_b64_tr_b16 v[28:29], v3 offset:29184
    ds_read_b64_tr_b16 v[30:31], v3 offset:30208
    v_mfma_f32_16x16x32_bf16 v[32:35], v[16:19], v[124:127], v[32:35]
    s_waitcnt vmcnt(8)
    s_barrier
    v_mfma_f32_16x16x32_bf16 v[48:51], v[16:19], v[204:207], v[48:51]
    s_waitcnt lgkmcnt(4)
    ds_read_b64_tr_b16 v[16:17], v2 offset:32768
    ds_read_b64_tr_b16 v[18:19], v2 offset:33792
    v_mfma_f32_16x16x32_bf16 v[52:55], v[20:23], v[204:207], v[52:55]
    buffer_load_dwordx4 v6, s[32:35], s49 offen offset:0 lds
    v_mfma_f32_16x16x32_bf16 v[36:39], v[20:23], v[124:127], v[36:39]
    s_waitcnt lgkmcnt(4)
    ds_read_b64_tr_b16 v[20:21], v3 offset:32768
    ds_read_b64_tr_b16 v[22:23], v3 offset:33792
    v_mfma_f32_16x16x32_bf16 v[40:43], v[24:27], v[124:127], v[40:43]
    s_mov_b32 s54, s42
    s_mul_i32 s55, s54, 52
    s_lshr_b32 s55, s55, 8
    v_mfma_f32_16x16x32_bf16 v[56:59], v[24:27], v[204:207], v[56:59]
    s_waitcnt lgkmcnt(4)
    ds_read_b64_tr_b16 v[24:25], v2 offset:33280
    ds_read_b64_tr_b16 v[26:27], v2 offset:34304
    v_mfma_f32_16x16x32_bf16 v[60:63], v[28:31], v[204:207], v[60:63]
    s_add_u32 s49, s49, s50
    buffer_load_dwordx4 v6, s[32:35], s49 offen offset:1024 lds
    v_mfma_f32_16x16x32_bf16 v[44:47], v[28:31], v[124:127], v[44:47]
    s_waitcnt lgkmcnt(4)
    ds_read_b64_tr_b16 v[28:29], v3 offset:33280
    ds_read_b64_tr_b16 v[30:31], v3 offset:34304
    v_mfma_f32_16x16x32_bf16 v[32:35], v[16:19], v[128:131], v[32:35]
    s_mul_i32 s55, s55, 5
    s_sub_u32 s54, s54, s55
    s_mul_i32 s54, s54, 3
    v_mfma_f32_16x16x32_bf16 v[48:51], v[16:19], v[208:211], v[48:51]
    s_waitcnt lgkmcnt(4)
    ds_read_b64_tr_b16 v[16:17], v2 offset:36864
    ds_read_b64_tr_b16 v[18:19], v2 offset:37888
    v_mfma_f32_16x16x32_bf16 v[52:55], v[20:23], v[208:211], v[52:55]
    s_add_u32 s49, s49, s51
    buffer_load_dwordx4 v6, s[32:35], s49 offen offset:2048 lds
    v_mfma_f32_16x16x32_bf16 v[36:39], v[20:23], v[128:131], v[36:39]
    s_waitcnt lgkmcnt(4)
    ds_read_b64_tr_b16 v[20:21], v3 offset:36864
    ds_read_b64_tr_b16 v[22:23], v3 offset:37888
    v_mfma_f32_16x16x32_bf16 v[40:43], v[24:27], v[128:131], v[40:43]
    s_lshr_b32 s55, 27152, s54
    s_and_b32 s56, s55, 0x30
    v_mfma_f32_16x16x32_bf16 v[56:59], v[24:27], v[208:211], v[56:59]
    s_waitcnt lgkmcnt(4)
    ds_read_b64_tr_b16 v[24:25], v2 offset:37376
    ds_read_b64_tr_b16 v[26:27], v2 offset:38400
    v_mfma_f32_16x16x32_bf16 v[60:63], v[28:31], v[208:211], v[60:63]
    s_add_u32 s49, s49, s50
    buffer_load_dwordx4 v6, s[32:35], s49 offen offset:3072 lds
    v_mfma_f32_16x16x32_bf16 v[44:47], v[28:31], v[128:131], v[44:47]
    s_waitcnt lgkmcnt(4)
    ds_read_b64_tr_b16 v[28:29], v3 offset:37376
    ds_read_b64_tr_b16 v[30:31], v3 offset:38400
    v_mfma_f32_16x16x32_bf16 v[32:35], v[16:19], v[132:135], v[32:35]
    s_add_u32 s49, s49, s52
    s_cmp_ge_u32 s49, s34
    s_cselect_b32 s101, s34, 0
    v_mfma_f32_16x16x32_bf16 v[48:51], v[16:19], v[212:215], v[48:51]
    s_waitcnt lgkmcnt(4)
    ds_read_b64_tr_b16 v[16:17], v2 offset:40960
    ds_read_b64_tr_b16 v[18:19], v2 offset:41984
    v_mfma_f32_16x16x32_bf16 v[52:55], v[20:23], v[212:215], v[52:55]
    s_sub_u32 s49, s49, s101
    v_mfma_f32_16x16x32_bf16 v[36:39], v[20:23], v[132:135], v[36:39]
    s_waitcnt lgkmcnt(4)
    ds_read_b64_tr_b16 v[20:21], v3 offset:40960
    ds_read_b64_tr_b16 v[22:23], v3 offset:41984
    v_mfma_f32_16x16x32_bf16 v[40:43], v[24:27], v[132:135], v[40:43]
    s_bitcmp1_b32 s55, 6
    s_cselect_b32 s60, 0, 0xffff
    s_mov_b32 s61, 0
    v_mfma_f32_16x16x32_bf16 v[56:59], v[24:27], v[212:215], v[56:59]
    s_waitcnt lgkmcnt(4)
    ds_read_b64_tr_b16 v[24:25], v2 offset:41472
    ds_read_b64_tr_b16 v[26:27], v2 offset:42496
    v_mfma_f32_16x16x32_bf16 v[60:63], v[28:31], v[212:215], v[60:63]
    s_lshl_b64 s[60:61], s[60:61], s56
    s_lshr_b32 s55, 164912, s54
    s_and_b32 s56, s55, 0x30
    v_mfma_f32_16x16x32_bf16 v[44:47], v[28:31], v[132:135], v[44:47]
    s_waitcnt lgkmcnt(4)
    ds_read_b64_tr_b16 v[28:29], v3 offset:41472
    ds_read_b64_tr_b16 v[30:31], v3 offset:42496
    v_mfma_f32_16x16x32_bf16 v[32:35], v[16:19], v[136:139], v[32:35]
    s_bitcmp1_b32 s55, 6
    s_cselect_b32 s38, 0, 0xffff
    s_mov_b32 s39, 0
    v_mfma_f32_16x16x32_bf16 v[48:51], v[16:19], v[216:219], v[48:51]
    s_waitcnt lgkmcnt(4)
    ds_read_b64_tr_b16 v[16:17], v2 offset:45056
    ds_read_b64_tr_b16 v[18:19], v2 offset:46080
    v_mfma_f32_16x16x32_bf16 v[52:55], v[20:23], v[216:219], v[52:55]
    s_lshl_b64 s[38:39], s[38:39], s56
    v_mfma_f32_16x16x32_bf16 v[36:39], v[20:23], v[136:139], v[36:39]
    s_waitcnt lgkmcnt(4)
    ds_read_b64_tr_b16 v[20:21], v3 offset:45056
    ds_read_b64_tr_b16 v[22:23], v3 offset:46080
    v_mfma_f32_16x16x32_bf16 v[40:43], v[24:27], v[136:139], v[40:43]
    s_lshl1_add_u32 s54, s45, 1
    s_cmp_eq_u32 s54, s98
    s_cbranch_scc1 g1_lo
g1_lor:
    v_mfma_f32_16x16x32_bf16 v[56:59], v[24:27], v[216:219], v[56:59]
    s_waitcnt lgkmcnt(4)
    ds_read_b64_tr_b16 v[24:25], v2 offset:45568
    ds_read_b64_tr_b16 v[26:27], v2 offset:46592
    v_mfma_f32_16x16x32_bf16 v[60:63], v[28:31], v[216:219], v[60:63]
    s_add_u32 m0, s44, 16384
    s_cmp_eq_u32 s45, s99
    v_mfma_f32_16x16x32_bf16 v[44:47], v[28:31], v[136:139], v[44:47]
    s_waitcnt lgkmcnt(4)
    ds_read_b64_tr_b16 v[28:29], v3 offset:45568
    ds_read_b64_tr_b16 v[30:31], v3 offset:46592
    v_mfma_f32_16x16x32_bf16 v[32:35], v[16:19], v[140:143], v[32:35]
    s_waitcnt vmcnt(8)
    s_barrier
    s_cbranch_scc1 g1_pzn
g1_pzrn:
    v_mfma_f32_16x16x32_bf16 v[48:51], v[16:19], v[220:223], v[48:51]
    s_waitcnt lgkmcnt(4)
    ds_read_b64_tr_b16 v[16:17], v2 offset:49152
    ds_read_b64_tr_b16 v[18:19], v2 offset:50176
    v_mfma_f32_16x16x32_bf16 v[52:55], v[20:23], v[220:223], v[52:55]
    buffer_load_dwordx4 v6, s[32:35], s49 offen offset:0 lds
    v_mfma_f32_16x16x32_bf16 v[36:39], v[20:23], v[140:143], v[36:39]
    s_waitcnt lgkmcnt(4)
    ds_read_b64_tr_b16 v[20:21], v3 offset:49152
    ds_read_b64_tr_b16 v[22:23], v3 offset:50176
    v_mfma_f32_16x16x32_bf16 v[40:43], v[24:27], v[140:143], v[40:43]
    s_sub_u32 s54, s45, s47
    s_lshr_b32 s54, s54, 1
    s_mul_i32 s54, s54, s48
    v_mfma_f32_16x16x32_bf16 v[56:59], v[24:27], v[220:223], v[56:59]
    s_waitcnt lgkmcnt(4)
    ds_read_b64_tr_b16 v[24:25], v2 offset:49664
    ds_read_b64_tr_b16 v[26:27], v2 offset:50688
    v_mfma_f32_16x16x32_bf16 v[60:63], v[28:31], v[220:223], v[60:63]
    s_add_u32 s49, s49, s50
    buffer_load_dwordx4 v6, s[32:35], s49 offen offset:1024 lds
    v_mfma_f32_16x16x32_bf16 v[44:47], v[28:31], v[140:143], v[44:47]
    s_waitcnt lgkmcnt(4)
    ds_read_b64_tr_b16 v[28:29], v3 offset:49664
    ds_read_b64_tr_b16 v[30:31], v3 offset:50688
    v_mfma_f32_16x16x32_bf16 v[32:35], v[16:19], v[144:147], v[32:35]
    s_add_u32 s54, s54, s42
    s_lshl_b32 s54, s54, 11
    s_mul_i32 s58, s43, 110592
    v_mfma_f32_16x16x32_bf16 v[48:51], v[16:19], v[224:227], v[48:51]
    s_waitcnt lgkmcnt(4)
    ds_read_b64_tr_b16 v[16:17], v2 offset:53248
    ds_read_b64_tr_b16 v[18:19], v2 offset:54272
    v_mfma_f32_16x16x32_bf16 v[52:55], v[20:23], v[224:227], v[52:55]
    s_add_u32 s49, s49, s51
    buffer_load_dwordx4 v6, s[32:35], s49 offen offset:2048 lds
    v_mfma_f32_16x16x32_bf16 v[36:39], v[20:23], v[144:147], v[36:39]
    s_waitcnt lgkmcnt(4)
    ds_read_b64_tr_b16 v[20:21], v3 offset:53248
    ds_read_b64_tr_b16 v[22:23], v3 offset:54272
    v_mfma_f32_16x16x32_bf16 v[40:43], v[24:27], v[144:147], v[40:43]
    s_add_u32 s58, s58, s54
    s_add_u32 s58, s58, 7864320
    s_mul_i32 s54, s45, 5
    v_mfma_f32_16x16x32_bf16 v[56:59], v[24:27], v[224:227], v[56:59]
    s_waitcnt lgkmcnt(4)
    ds_read_b64_tr_b16 v[24:25], v2 offset:53760
    ds_read_b64_tr_b16 v[26:27], v2 offset:54784
    v_mfma_f32_16x16x32_bf16 v[60:63], v[28:31], v[224:227], v[60:63]
    s_add_u32 s49, s49, s50
    buffer_load_dwordx4 v6, s[32:35], s49 offen offset:3072 lds
    v_mfma_f32_16x16x32_bf16 v[44:47], v[28:31], v[144:147], v[44:47]
    s_waitcnt lgkmcnt(4)
    ds_read_b64_tr_b16 v[28:29], v3 offset:53760
    ds_read_b64_tr_b16 v[30:31], v3 offset:54784
    v_mfma_f32_16x16x32_bf16 v[32:35], v[16:19], v[148:151], v[32:35]
    s_add_u32 s49, s49, s52
    s_cmp_ge_u32 s49, s34
    s_cselect_b32 s101, s34, 0
    v_mfma_f32_16x16x32_bf16 v[48:51], v[16:19], v[228:231], v[48:51]
    s_waitcnt lgkmcnt(4)
    ds_read_b64_tr_b16 v[16:17], v2 offset:57344
    ds_read_b64_tr_b16 v[18:19], v2 offset:58368
    v_mfma_f32_16x16x32_bf16 v[52:55], v[20:23], v[228:231], v[52:55]
    s_sub_u32 s49, s49, s101
    v_mfma_f32_16x16x32_bf16 v[36:39], v[20:23], v[148:151], v[36:39]
    s_waitcnt lgkmcnt(4)
    ds_read_b64_tr_b16 v[20:21], v3 offset:57344
    ds_read_b64_tr_b16 v[22:23], v3 offset:58368
    v_mfma_f32_16x16x32_bf16 v[40:43], v[24:27], v[148:151], v[40:43]
    s_add_u32 s54, s54, s36
    s_lshl_b32 s54, s54, 18
    s_lshl_b32 s55, s43, 9
    v_mfma_f32_16x16x32_bf16 v[56:59], v[24:27], v[228:231], v[56:59]
    s_waitcnt lgkmcnt(4)
    ds_read_b64_tr_b16 v[24:25], v2 offset:57856
    ds_read_b64_tr_b16 v[26:27], v2 offset:58880
    v_mfma_f32_16x16x32_bf16 v[60:63], v[28:31], v[228:231], v[60:63]
    s_add_u32 s54, s54, s55
    s_mov_b32 s55, 55296
    v_mfma_f32_16x16x32_bf16 v[44:47], v[28:31], v[148:151], v[44:47]
    s_waitcnt lgkmcnt(4)
    ds_read_b64_tr_b16 v[28:29], v3 offset:57856
    ds_read_b64_tr_b16 v[30:31], v3 offset:58880
    v_mfma_f32_16x16x32_bf16 v[32:35], v[16:19], v[152:155], v[32:35]
    s_cmp_lt_u32 s45, s47
    s_cselect_b32 s58, s54, s58
    s_cselect_b32 s55, 131072, s55
    v_mfma_f32_16x16x32_bf16 v[48:51], v[16:19], v[232:235], v[48:51]
    s_waitcnt lgkmcnt(4)
    ds_read_b64_tr_b16 v[16:17], v2 offset:61440
    ds_read_b64_tr_b16 v[18:19], v2 offset:62464
    v_mfma_f32_16x16x32_bf16 v[52:55], v[20:23], v[232:235], v[52:55]
    s_add_u32 s57, s58, s55
    v_mfma_f32_16x16x32_bf16 v[36:39], v[20:23], v[152:155], v[36:39]
    s_waitcnt lgkmcnt(4)
    ds_read_b64_tr_b16 v[20:21], v3 offset:61440
    ds_read_b64_tr_b16 v[22:23], v3 offset:62464
    v_mfma_f32_16x16x32_bf16 v[40:43], v[24:27], v[152:155], v[40:43]
    v_mfma_f32_16x16x32_bf16 v[56:59], v[24:27], v[232:235], v[56:59]
    s_waitcnt lgkmcnt(4)
    ds_read_b64_tr_b16 v[24:25], v2 offset:61952
    ds_read_b64_tr_b16 v[26:27], v2 offset:62976
    v_mfma_f32_16x16x32_bf16 v[60:63], v[28:31], v[232:235], v[60:63]
    s_add_u32 m0, s44, 32768
    v_mfma_f32_16x16x32_bf16 v[44:47], v[28:31], v[152:155], v[44:47]
    s_waitcnt lgkmcnt(4)
    ds_read_b64_tr_b16 v[28:29], v3 offset:61952
    ds_read_b64_tr_b16 v[30:31], v3 offset:62976
    v_mfma_f32_16x16x32_bf16 v[32:35], v[16:19], v[156:159], v[32:35]
    s_waitcnt vmcnt(8)
    s_barrier
    v_mfma_f32_16x16x32_bf16 v[48:51], v[16:19], v[236:239], v[48:51]
    s_waitcnt lgkmcnt(4)
    ds_read_b64_tr_b16 v[16:17], v4 offset:0
    ds_read_b64_tr_b16 v[18:19], v4 offset:1024
    v_mfma_f32_16x16x32_bf16 v[52:55], v[20:23], v[236:239], v[52:55]
    buffer_load_dwordx4 v6, s[32:35], s49 offen offset:0 lds
    v_mfma_f32_16x16x32_bf16 v[36:39], v[20:23], v[156:159], v[36:39]
    s_waitcnt lgkmcnt(4)
    ds_read_b64_tr_b16 v[20:21], v5 offset:0
    ds_read_b64_tr_b16 v[22:23], v5 offset:1024
    v_mfma_f32_16x16x32_bf16 v[40:43], v[24:27], v[156:159], v[40:43]
    s_cmp_eq_u32 s45, 0
    s_cbranch_scc1 g1_nln
g1_nlrn:
    v_mfma_f32_16x16x32_bf16 v[56:59], v[24:27], v[236:239], v[56:59]
    s_waitcnt lgkmcnt(4)
    ds_read_b64_tr_b16 v[24:25], v4 offset:512
    ds_read_b64_tr_b16 v[26:27], v4 offset:1536
    v_mfma_f32_16x16x32_bf16 v[60:63], v[28:31], v[236:239], v[60:63]
    s_add_u32 s49, s49, s50
    buffer_load_dwordx4 v6, s[32:35], s49 offen offset:1024 lds
    v_mfma_f32_16x16x32_bf16 v[44:47], v[28:31], v[156:159], v[44:47]
    s_waitcnt lgkmcnt(4)
    ds_read_b64_tr_b16 v[28:29], v5 offset:512
    ds_read_b64_tr_b16 v[30:31], v5 offset:1536
    v_mfma_f32_16x16x32_bf16 v[32:35], v[16:19], v[160:163], v[32:35]
    s_add_u32 s54, s45, 0
    v_mfma_f32_16x16x32_bf16 v[48:51], v[16:19], v[240:243], v[48:51]
    s_waitcnt lgkmcnt(4)
    ds_read_b64_tr_b16 v[16:17], v4 offset:4096
    ds_read_b64_tr_b16 v[18:19], v4 offset:5120
    v_mfma_f32_16x16x32_bf16 v[52:55], v[20:23], v[240:243], v[52:55]
    s_add_u32 s49, s49, s51
    buffer_load_dwordx4 v6, s[32:35], s49 offen offset:2048 lds
    v_mfma_f32_16x16x32_bf16 v[36:39], v[20:23], v[160:163], v[36:39]
    s_waitcnt lgkmcnt(4)
    ds_read_b64_tr_b16 v[20:21], v5 offset:4096
    ds_read_b64_tr_b16 v[22:23], v5 offset:5120
    v_mfma_f32_16x16x32_bf16 v[40:43], v[24:27], v[160:163], v[40:43]
    s_cmp_eq_u32 s54, s97
    s_cbranch_scc1 g1_chk
g1_chkr:
    v_mfma_f32_16x16x32_bf16 v[56:59], v[24:27], v[240:243], v[56:59]
    s_waitcnt lgkmcnt(4)
    ds_read_b64_tr_b16 v[24:25], v4 offset:4608
    ds_read_b64_tr_b16 v[26:27], v4 offset:5632
    v_mfma_f32_16x16x32_bf16 v[60:63], v[28:31], v[240:243], v[60:63]
    s_add_u32 s49, s49, s50
    buffer_load_dwordx4 v6, s[32:35], s49 offen offset:3072 lds
    v_mfma_f32_16x16x32_bf16 v[44:47], v[28:31], v[160:163], v[44:47]
    s_waitcnt lgkmcnt(4)
    ds_read_b64_tr_b16 v[28:29], v5 offset:4608
    ds_read_b64_tr_b16 v[30:31], v5 offset:5632
    v_mfma_f32_16x16x32_bf16 v[32:35], v[16:19], v[164:167], v[32:35]
    s_add_u32 s49, s49, s52
    s_cmp_ge_u32 s49, s34
    s_cselect_b32 s101, s34, 0
    v_mfma_f32_16x16x32_bf16 v[48:51], v[16:19], v[244:247], v[48:51]
    s_waitcnt lgkmcnt(4)
    ds_read_b64_tr_b16 v[16:17], v4 offset:8192
    ds_read_b64_tr_b16 v[18:19], v4 offset:9216
    v_mfma_f32_16x16x32_bf16 v[52:55], v[20:23], v[244:247], v[52:55]
    s_sub_u32 s49, s49, s101
    v_mfma_f32_16x16x32_bf16 v[36:39], v[20:23], v[164:167], v[36:39]
    s_waitcnt lgkmcnt(4)
    ds_read_b64_tr_b16 v[20:21], v5 offset:8192
    ds_read_b64_tr_b16 v[22:23], v5 offset:9216
    v_mfma_f32_16x16x32_bf16 v[40:43], v[24:27], v[164:167], v[40:43]
    v_mfma_f32_16x16x32_bf16 v[56:59], v[24:27], v[244:247], v[56:59]
    s_waitcnt lgkmcnt(4)
    ds_read_b64_tr_b16 v[24:25], v4 offset:8704
    ds_read_b64_tr_b16 v[26:27], v4 offset:9728
    v_mfma_f32_16x16x32_bf16 v[60:63], v[28:31], v[244:247], v[60:63]
    v_mfma_f32_16x16x32_bf16 v[44:47], v[28:31], v[164:167], v[44:47]
    s_waitcnt lgkmcnt(4)
    ds_read_b64_tr_b16 v[28:29], v5 offset:8704
    ds_read_b64_tr_b16 v[30:31], v5 offset:9728
    v_mfma_f32_16x16x32_bf16 v[32:35], v[16:19], v[168:171], v[32:35]
    v_mfma_f32_16x16x32_bf16 v[48:51], v[16:19], v[248:251], v[48:51]
    s_waitcnt lgkmcnt(4)
    ds_read_b64_tr_b16 v[16:17], v4 offset:12288
    ds_read_b64_tr_b16 v[18:19], v4 offset:13312
    v_mfma_f32_16x16x32_bf16 v[52:55], v[20:23], v[248:251], v[52:55]
    v_mfma_f32_16x16x32_bf16 v[36:39], v[20:23], v[168:171], v[36:39]
    s_waitcnt lgkmcnt(4)
    ds_read_b64_tr_b16 v[20:21], v5 offset:12288
    ds_read_b64_tr_b16 v[22:23], v5 offset:13312
    v_mfma_f32_16x16x32_bf16 v[40:43], v[24:27], v[168:171], v[40:43]
    v_mfma_f32_16x16x32_bf16 v[56:59], v[24:27], v[248:251], v[56:59]
    s_waitcnt lgkmcnt(4)
    ds_read_b64_tr_b16 v[24:25], v4 offset:12800
    ds_read_b64_tr_b16 v[26:27], v4 offset:13824
    v_mfma_f32_16x16x32_bf16 v[60:63], v[28:31], v[248:251], v[60:63]
    s_add_u32 m0, s44, 49152
    v_mfma_f32_16x16x32_bf16 v[44:47], v[28:31], v[168:171], v[44:47]
    s_waitcnt lgkmcnt(4)
    ds_read_b64_tr_b16 v[28:29], v5 offset:12800
    ds_read_b64_tr_b16 v[30:31], v5 offset:13824
    v_mfma_f32_16x16x32_bf16 v[32:35], v[16:19], v[172:175], v[32:35]
    s_waitcnt vmcnt(8)
    s_barrier
    v_mfma_f32_16x16x32_bf16 v[48:51], v[16:19], v[252:255], v[48:51]
    s_waitcnt lgkmcnt(4)
    ds_read_b64_tr_b16 v[16:17], v2 offset:0
    ds_read_b64_tr_b16 v[18:19], v2 offset:1024
    v_mfma_f32_16x16x32_bf16 v[52:55], v[20:23], v[252:255], v[52:55]
    buffer_load_dwordx4 v6, s[32:35], s49 offen offset:0 lds
    v_mfma_f32_16x16x32_bf16 v[36:39], v[20:23], v[172:175], v[36:39]
    s_waitcnt lgkmcnt(4)
    ds_read_b64_tr_b16 v[20:21], v3 offset:0
    ds_read_b64_tr_b16 v[22:23], v3 offset:1024
    v_mfma_f32_16x16x32_bf16 v[40:43], v[24:27], v[172:175], v[40:43]
    v_mfma_f32_16x16x32_bf16 v[56:59], v[24:27], v[252:255], v[56:59]
    s_waitcnt lgkmcnt(4)
    ds_read_b64_tr_b16 v[24:25], v2 offset:512
    ds_read_b64_tr_b16 v[26:27], v2 offset:1536
    v_mfma_f32_16x16x32_bf16 v[60:63], v[28:31], v[252:255], v[60:63]
    s_add_u32 s49, s49, s50
    buffer_load_dwordx4 v6, s[32:35], s49 offen offset:1024 lds
    v_mfma_f32_16x16x32_bf16 v[44:47], v[28:31], v[172:175], v[44:47]
    s_waitcnt lgkmcnt(4)
    ds_read_b64_tr_b16 v[28:29], v3 offset:512
    ds_read_b64_tr_b16 v[30:31], v3 offset:1536
    s_setprio 2
    s_cmp_lt_u32 s45, s47
    s_cbranch_scc1 g1_eq
    s_bitcmp1_b32 s45, 0
    s_cbranch_scc1 g1_eu
    v_pk_mul_f32 v[64:65], v[32:33], v[32:33] op_sel:[0,0] op_sel_hi:[1,1]
    v_pk_mul_f32 v[66:67], v[34:35], v[34:35] op_sel:[0,0] op_sel_hi:[1,1]
    v_pk_mul_f32 v[68:69], v[36:37], v[36:37] op_sel:[0,0] op_sel_hi:[1,1]
    v_pk_mul_f32 v[70:71], v[38:39], v[38:39] op_sel:[0,0] op_sel_hi:[1,1]
    v_pk_fma_f32 v[64:65], v[64:65], v[12:13], v[10:11] op_sel:[0,0,0] op_sel_hi:[1,0,0]
    v_pk_fma_f32 v[66:67], v[66:67], v[12:13], v[10:11] op_sel:[0,0,0] op_sel_hi:[1,0,0]
    v_pk_fma_f32 v[68:69], v[68:69], v[12:13], v[10:11] op_sel:[0,0,0] op_sel_hi:[1,0,0]
    v_pk_fma_f32 v[70:71], v[70:71], v[12:13], v[10:11] op_sel:[0,0,0] op_sel_hi:[1,0,0]
    v_pk_mul_f32 v[64:65], v[64:65], v[32:33] op_sel:[0,0] op_sel_hi:[1,1]
    v_pk_mul_f32 v[66:67], v[66:67], v[34:35] op_sel:[0,0] op_sel_hi:[1,1]
    v_pk_mul_f32 v[68:69], v[68:69], v[36:37] op_sel:[0,0] op_sel_hi:[1,1]
    v_pk_mul_f32 v[70:71], v[70:71], v[38:39] op_sel:[0,0] op_sel_hi:[1,1]
    v_exp_f32 v64, v64
    v_exp_f32 v65, v65
    v_exp_f32 v66, v66
    v_exp_f32 v67, v67
    v_exp_f32 v68, v68
    v_exp_f32 v69, v69
    v_exp_f32 v70, v70
    v_exp_f32 v71, v71
    v_pk_fma_f32 v[64:65], v[64:65], v[12:13], v[12:13] op_sel:[0,1,1] op_sel_hi:[1,1,1]
    v_pk_fma_f32 v[66:67], v[66:67], v[12:13], v[12:13] op_sel:[0,1,1] op_sel_hi:[1,1,1]
    v_pk_fma_f32 v[68:69], v[68:69], v[12:13], v[12:13] op_sel:[0,1,1] op_sel_hi:[1,1,1]
    v_pk_fma_f32 v[70:71], v[70:71], v[12:13], v[12:13] op_sel:[0,1,1] op_sel_hi:[1,1,1]
    v_rcp_f32 v64, v64
    v_rcp_f32 v65, v65
    v_rcp_f32 v66, v66
    v_rcp_f32 v67, v67
    v_rcp_f32 v68, v68
    v_rcp_f32 v69, v69
    v_rcp_f32 v70, v70
    v_rcp_f32 v71, v71
    v_pk_mul_f32 v[64:65], v[64:65], v[32:33] op_sel:[0,0] op_sel_hi:[1,1]
    v_pk_mul_f32 v[66:67], v[66:67], v[34:35] op_sel:[0,0] op_sel_hi:[1,1]
    v_pk_mul_f32 v[68:69], v[68:69], v[36:37] op_sel:[0,0] op_sel_hi:[1,1]
    v_pk_mul_f32 v[70:71], v[70:71], v[38:39] op_sel:[0,0] op_sel_hi:[1,1]
    v_pk_mul_f32 v[72:73], v[40:41], v[40:41] op_sel:[0,0] op_sel_hi:[1,1]
    v_pk_mul_f32 v[74:75], v[42:43], v[42:43] op_sel:[0,0] op_sel_hi:[1,1]
    v_pk_mul_f32 v[76:77], v[44:45], v[44:45] op_sel:[0,0] op_sel_hi:[1,1]
    v_pk_mul_f32 v[78:79], v[46:47], v[46:47] op_sel:[0,0] op_sel_hi:[1,1]
    v_pk_fma_f32 v[72:73], v[72:73], v[12:13], v[10:11] op_sel:[0,0,0] op_sel_hi:[1,0,0]
    v_pk_fma_f32 v[74:75], v[74:75], v[12:13], v[10:11] op_sel:[0,0,0] op_sel_hi:[1,0,0]
    v_pk_fma_f32 v[76:77], v[76:77], v[12:13], v[10:11] op_sel:[0,0,0] op_sel_hi:[1,0,0]
    v_pk_fma_f32 v[78:79], v[78:79], v[12:13], v[10:11] op_sel:[0,0,0] op_sel_hi:[1,0,0]
    v_pk_mul_f32 v[72:73], v[72:73], v[40:41] op_sel:[0,0] op_sel_hi:[1,1]
    v_pk_mul_f32 v[74:75], v[74:75], v[42:43] op_sel:[0,0] op_sel_hi:[1,1]
    v_pk_mul_f32 v[76:77], v[76:77], v[44:45] op_sel:[0,0] op_sel_hi:[1,1]
    v_pk_mul_f32 v[78:79], v[78:79], v[46:47] op_sel:[0,0] op_sel_hi:[1,1]
    v_exp_f32 v72, v72
    v_exp_f32 v73, v73
    v_exp_f32 v74, v74
    v_exp_f32 v75, v75
    v_exp_f32 v76, v76
    v_exp_f32 v77, v77
    v_exp_f32 v78, v78
    v_exp_f32 v79, v79
    v_pk_fma_f32 v[72:73], v[72:73], v[12:13], v[12:13] op_sel:[0,1,1] op_sel_hi:[1,1,1]
    v_pk_fma_f32 v[74:75], v[74:75], v[12:13], v[12:13] op_sel:[0,1,1] op_sel_hi:[1,1,1]
    v_pk_fma_f32 v[76:77], v[76:77], v[12:13], v[12:13] op_sel:[0,1,1] op_sel_hi:[1,1,1]
    v_pk_fma_f32 v[78:79], v[78:79], v[12:13], v[12:13] op_sel:[0,1,1] op_sel_hi:[1,1,1]
    v_rcp_f32 v72, v72
    v_rcp_f32 v73, v73
    v_rcp_f32 v74, v74
    v_rcp_f32 v75, v75
    v_rcp_f32 v76, v76
    v_rcp_f32 v77, v77
    v_rcp_f32 v78, v78
    v_rcp_f32 v79, v79
    v_pk_mul_f32 v[72:73], v[72:73], v[40:41] op_sel:[0,0] op_sel_hi:[1,1]
    v_pk_mul_f32 v[74:75], v[74:75], v[42:43] op_sel:[0,0] op_sel_hi:[1,1]
    v_pk_mul_f32 v[76:77], v[76:77], v[44:45] op_sel:[0,0] op_sel_hi:[1,1]
    v_pk_mul_f32 v[78:79], v[78:79], v[46:47] op_sel:[0,0] op_sel_hi:[1,1]
    v_pk_mul_f32 v[80:81], v[48:49], v[48:49] op_sel:[0,0] op_sel_hi:[1,1]
    v_pk_mul_f32 v[82:83], v[50:51], v[50:51] op_sel:[0,0] op_sel_hi:[1,1]
    v_pk_mul_f32 v[84:85], v[52:53], v[52:53] op_sel:[0,0] op_sel_hi:[1,1]
    v_pk_mul_f32 v[86:87], v[54:55], v[54:55] op_sel:[0,0] op_sel_hi:[1,1]
    v_pk_fma_f32 v[80:81], v[80:81], v[14:15], v[14:15] op_sel:[0,1,0] op_sel_hi:[1,1,0]
    v_pk_fma_f32 v[82:83], v[82:83], v[14:15], v[14:15] op_sel:[0,1,0] op_sel_hi:[1,1,0]
    v_pk_fma_f32 v[84:85], v[84:85], v[14:15], v[14:15] op_sel:[0,1,0] op_sel_hi:[1,1,0]
    v_pk_fma_f32 v[86:87], v[86:87], v[14:15], v[14:15] op_sel:[0,1,0] op_sel_hi:[1,1,0]
    v_pk_mul_f32 v[80:81], v[80:81], v[48:49] op_sel:[0,0] op_sel_hi:[1,1]
    v_pk_mul_f32 v[82:83], v[82:83], v[50:51] op_sel:[0,0] op_sel_hi:[1,1]
    v_pk_mul_f32 v[84:85], v[84:85], v[52:53] op_sel:[0,0] op_sel_hi:[1,1]
    v_pk_mul_f32 v[86:87], v[86:87], v[54:55] op_sel:[0,0] op_sel_hi:[1,1]
    v_exp_f32 v80, v80
    v_exp_f32 v81, v81
    v_exp_f32 v82, v82
    v_exp_f32 v83, v83
    v_exp_f32 v84, v84
    v_exp_f32 v85, v85
    v_exp_f32 v86, v86
    v_exp_f32 v87, v87
    v_pk_fma_f32 v[80:81], v[80:81], v[0:1], v[0:1] op_sel:[0,0,0] op_sel_hi:[1,0,0]
    v_pk_fma_f32 v[82:83], v[82:83], v[0:1], v[0:1] op_sel:[0,0,0] op_sel_hi:[1,0,0]
    v_pk_fma_f32 v[84:85], v[84:85], v[0:1], v[0:1] op_sel:[0,0,0] op_sel_hi:[1,0,0]
    v_pk_fma_f32 v[86:87], v[86:87], v[0:1], v[0:1] op_sel:[0,0,0] op_sel_hi:[1,0,0]
    v_rcp_f32 v80, v80
    v_rcp_f32 v81, v81
    v_rcp_f32 v82, v82
    v_rcp_f32 v83, v83
    v_rcp_f32 v84, v84
    v_rcp_f32 v85, v85
    v_rcp_f32 v86, v86
    v_rcp_f32 v87, v87
    v_pk_mul_f32 v[80:81], v[80:81], v[48:49] op_sel:[0,0] op_sel_hi:[1,1]
    v_pk_mul_f32 v[82:83], v[82:83], v[50:51] op_sel:[0,0] op_sel_hi:[1,1]
    v_pk_mul_f32 v[84:85], v[84:85], v[52:53] op_sel:[0,0] op_sel_hi:[1,1]
    v_pk_mul_f32 v[86:87], v[86:87], v[54:55] op_sel:[0,0] op_sel_hi:[1,1]
    v_pk_mul_f32 v[88:89], v[56:57], v[56:57] op_sel:[0,0] op_sel_hi:[1,1]
    v_pk_mul_f32 v[90:91], v[58:59], v[58:59] op_sel:[0,0] op_sel_hi:[1,1]
    v_pk_mul_f32 v[92:93], v[60:61], v[60:61] op_sel:[0,0] op_sel_hi:[1,1]
    v_pk_mul_f32 v[94:95], v[62:63], v[62:63] op_sel:[0,0] op_sel_hi:[1,1]
    v_pk_fma_f32 v[88:89], v[88:89], v[14:15], v[14:15] op_sel:[0,1,0] op_sel_hi:[1,1,0]
    v_pk_fma_f32 v[90:91], v[90:91], v[14:15], v[14:15] op_sel:[0,1,0] op_sel_hi:[1,1,0]
    v_pk_fma_f32 v[92:93], v[92:93], v[14:15], v[14:15] op_sel:[0,1,0] op_sel_hi:[1,1,0]
    v_pk_fma_f32 v[94:95], v[94:95], v[14:15], v[14:15] op_sel:[0,1,0] op_sel_hi:[1,1,0]
    v_pk_mul_f32 v[88:89], v[88:89], v[56:57] op_sel:[0,0] op_sel_hi:[1,1]
    v_pk_mul_f32 v[90:91], v[90:91], v[58:59] op_sel:[0,0] op_sel_hi:[1,1]
    v_pk_mul_f32 v[92:93], v[92:93], v[60:61] op_sel:[0,0] op_sel_hi:[1,1]
    v_pk_mul_f32 v[94:95], v[94:95], v[62:63] op_sel:[0,0] op_sel_hi:[1,1]
    v_exp_f32 v88, v88
    v_exp_f32 v89, v89
    v_exp_f32 v90, v90
    v_exp_f32 v91, v91
    v_exp_f32 v92, v92
    v_exp_f32 v93, v93
    v_exp_f32 v94, v94
    v_exp_f32 v95, v95
    v_pk_fma_f32 v[88:89], v[88:89], v[0:1], v[0:1] op_sel:[0,0,0] op_sel_hi:[1,0,0]
    v_pk_fma_f32 v[90:91], v[90:91], v[0:1], v[0:1] op_sel:[0,0,0] op_sel_hi:[1,0,0]
    v_pk_fma_f32 v[92:93], v[92:93], v[0:1], v[0:1] op_sel:[0,0,0] op_sel_hi:[1,0,0]
    v_pk_fma_f32 v[94:95], v[94:95], v[0:1], v[0:1] op_sel:[0,0,0] op_sel_hi:[1,0,0]
    v_rcp_f32 v88, v88
    v_rcp_f32 v89, v89
    v_rcp_f32 v90, v90
    v_rcp_f32 v91, v91
    v_rcp_f32 v92, v92
    v_rcp_f32 v93, v93
    v_rcp_f32 v94, v94
    v_rcp_f32 v95, v95
    v_pk_mul_f32 v[88:89], v[88:89], v[56:57] op_sel:[0,0] op_sel_hi:[1,1]
    v_pk_mul_f32 v[90:91], v[90:91], v[58:59] op_sel:[0,0] op_sel_hi:[1,1]
    v_pk_mul_f32 v[92:93], v[92:93], v[60:61] op_sel:[0,0] op_sel_hi:[1,1]
    v_pk_mul_f32 v[94:95], v[94:95], v[62:63] op_sel:[0,0] op_sel_hi:[1,1]
    s_add_u32 s45, s45, 1
    s_branch g1_loop
g1_eu:
    s_cmp_eq_u32 s45, 5
    s_cbranch_scc1 g1_heavy
    v_pk_mul_f32 v[32:33], v[32:33], v[64:65] op_sel:[0,0] op_sel_hi:[1,1]
    v_pk_mul_f32 v[34:35], v[34:35], v[66:67] op_sel:[0,0] op_sel_hi:[1,1]
    v_pk_mul_f32 v[36:37], v[36:37], v[68:69] op_sel:[0,0] op_sel_hi:[1,1]
    v_pk_mul_f32 v[38:39], v[38:39], v[70:71] op_sel:[0,0] op_sel_hi:[1,1]
    v_cvt_pk_bf16_f32 v64, v32, v33
    v_cvt_pk_bf16_f32 v65, v34, v35
    v_cvt_pk_bf16_f32 v66, v36, v37
    v_cvt_pk_bf16_f32 v67, v38, v39
    buffer_store_dwordx4 v[64:67], v9, s[24:27], s58 offen offset:0 sc1
    v_pk_mul_f32 v[40:41], v[40:41], v[72:73] op_sel:[0,0] op_sel_hi:[1,1]
    v_pk_mul_f32 v[42:43], v[42:43], v[74:75] op_sel:[0,0] op_sel_hi:[1,1]
    v_pk_mul_f32 v[44:45], v[44:45], v[76:77] op_sel:[0,0] op_sel_hi:[1,1]
    v_pk_mul_f32 v[46:47], v[46:47], v[78:79] op_sel:[0,0] op_sel_hi:[1,1]
    v_cvt_pk_bf16_f32 v72, v40, v41
    v_cvt_pk_bf16_f32 v73, v42, v43
    v_cvt_pk_bf16_f32 v74, v44, v45
    v_cvt_pk_bf16_f32 v75, v46, v47
    buffer_store_dwordx4 v[72:75], v9, s[24:27], s58 offen offset:1024 sc1
    v_pk_mul_f32 v[48:49], v[48:49], v[80:81] op_sel:[0,0] op_sel_hi:[1,1]
    v_pk_mul_f32 v[50:51], v[50:51], v[82:83] op_sel:[0,0] op_sel_hi:[1,1]
    v_pk_mul_f32 v[52:53], v[52:53], v[84:85] op_sel:[0,0] op_sel_hi:[1,1]
    v_pk_mul_f32 v[54:55], v[54:55], v[86:87] op_sel:[0,0] op_sel_hi:[1,1]
    v_cvt_pk_bf16_f32 v80, v48, v49
    v_cvt_pk_bf16_f32 v81, v50, v51
    v_cvt_pk_bf16_f32 v82, v52, v53
    v_cvt_pk_bf16_f32 v83, v54, v55
    buffer_store_dwordx4 v[80:83], v9, s[24:27], s57 offen offset:0 sc1
    v_pk_mul_f32 v[56:57], v[56:57], v[88:89] op_sel:[0,0] op_sel_hi:[1,1]
    v_pk_mul_f32 v[58:59], v[58:59], v[90:91] op_sel:[0,0] op_sel_hi:[1,1]
    v_pk_mul_f32 v[60:61], v[60:61], v[92:93] op_sel:[0,0] op_sel_hi:[1,1]
    v_pk_mul_f32 v[62:63], v[62:63], v[94:95] op_sel:[0,0] op_sel_hi:[1,1]
    v_cvt_pk_bf16_f32 v88, v56, v57
    v_cvt_pk_bf16_f32 v89, v58, v59
    v_cvt_pk_bf16_f32 v90, v60, v61
    v_cvt_pk_bf16_f32 v91, v62, v63
    buffer_store_dwordx4 v[88:91], v9, s[24:27], s57 offen offset:1024 sc1
    s_add_u32 s45, s45, 1
    s_sub_u32 s54, s42, 8
    s_cmp_lt_u32 s54, 4
    s_cbranch_scc1 g1_medium
    s_cmp_lt_u32 s45, s46
    s_cbranch_scc1 g1_loop
    s_mov_b32 s55, 0x20000
g1_nc2:
    v_readfirstlane_b32 s54, v11
    s_sub_u32 s55, s55, 1
    s_cbranch_scc1 g1_nc2_ok
    s_cmp_lg_u32 s54, 0
    s_cbranch_scc1 g1_nc2_ok
    s_sleep 2
    v_mov_b32 v11, 0
    global_load_dword v11, v11, s[20:21] sc1
    s_waitcnt vmcnt(0)
    s_branch g1_nc2
g1_nc2_ok:
    s_lshl_b32 s100, s41, 4
    s_add_u32 s100, s100, s42
    s_lshl_b32 s100, s100, 6
    s_add_u32 s100, s100, 20611072
    s_sub_u32 s54, s42, 12
    s_lshl_b32 s99, s54, 6
    s_add_u32 s99, s99, s43
    s_lshl_b32 s54, s54, 3
    s_lshr_b32 s55, s41, 1
    s_add_u32 s54, s54, s55
    s_and_b32 s55, s41, 1
    s_lshl_b32 s55, s55, 6
    s_add_u32 s54, s54, s55
    s_lshl_b32 s54, s54, 6
    s_add_u32 s57, s54, 20758528
    s_waitcnt vmcnt(4) lgkmcnt(0)
    s_barrier
    s_mov_b32 s39, 0x00020000
    v_add_u32 v160, 0, v1
    v_mul_u32_u24 v168, 6554, v160
    v_lshrrev_b32 v168, 16, v168
    v_mul_u32_u24 v173, 10, v168
    v_sub_u32 v173, v160, v173
    v_lshlrev_b32 v173, 4, v173
    v_add_u32 v160, 64, v1
    v_mul_u32_u24 v169, 6554, v160
    v_lshrrev_b32 v169, 16, v169
    v_mul_u32_u24 v174, 10, v169
    v_sub_u32 v174, v160, v174
    v_lshlrev_b32 v174, 4, v174
    v_add_u32 v160, 128, v1
    v_mul_u32_u24 v170, 6554, v160
    v_lshrrev_b32 v170, 16, v170
    v_mul_u32_u24 v175, 10, v170
    v_sub_u32 v175, v160, v175
    v_lshlrev_b32 v175, 4, v175
    v_add_u32 v160, 192, v1
    v_mul_u32_u24 v171, 6554, v160
    v_lshrrev_b32 v171, 16, v171
    v_mul_u32_u24 v176, 10, v171
    v_sub_u32 v176, v160, v176
    v_lshlrev_b32 v176, 4, v176
    v_add_u32 v160, 256, v1
    v_mul_u32_u24 v172, 6554, v160
    v_lshrrev_b32 v172, 16, v172
    v_mul_u32_u24 v177, 10, v172
    v_sub_u32 v177, v160, v177
    v_lshlrev_b32 v177, 4, v177
g1_rl_pass:
    s_mul_i32 s101, s40, 5120
    s_mov_b32 s49, 0
g1_rl_loop:
    s_and_b32 s59, s99, 7
    s_lshr_b32 s58, s99, 3
    s_sub_u32 s97, s58, 54
    s_mul_i32 s48, s97, 52
    s_lshr_b32 s48, s48, 8
    s_mul_i32 s98, s48, 5
    s_sub_u32 s97, s97, s98
    s_mul_i32 s98, s48, 160
    s_mul_i32 s48, s97, 40
    s_cmp_eq_u32 s97, 4
    s_cselect_b32 s48, 16, s48
    s_cselect_b32 s60, 80, 20
    s_cselect_b32 s61, 40, 4
    s_cselect_b32 s96, 20, 8
    s_add_u32 s98, s98, s48
    s_lshl_b32 s48, s58, 5
    s_mov_b32 s97, 819200
    s_cmp_lt_u32 s58, 54
    s_cselect_b32 s36, s16, s8
    s_cselect_b32 s37, s17, s9
    s_cselect_b32 s38, 2211840, s97
    s_cselect_b32 s60, 8, s60
    s_cselect_b32 s61, 4, s61
    s_cselect_b32 s96, 16, s96
    s_cselect_b32 s98, s48, s98
    s_mul_i32 s98, s98, 1280
    s_mul_i32 s97, s59, 160
    s_add_u32 s98, s98, s97
    s_movk_i32 s97, 1280
    v_and_b32 v160, 3, v168
    v_lshrrev_b32 v161, 4, v168
    v_mad_u32_u24 v160, v161, s60, v160
    v_bfe_u32 v161, v168, 3, 1
    v_mad_u32_u24 v160, v161, s61, v160
    v_bfe_u32 v161, v168, 2, 1
    v_mad_u32_u24 v160, v161, s96, v160
    s_add_u32 m0, s101, 0
    v_mad_u32_u24 v160, v160, s97, v173
    s_waitcnt vmcnt(3)
    buffer_load_dwordx4 v160, s[36:39], s98 offen lds
    v_and_b32 v160, 3, v169
    v_lshrrev_b32 v161, 4, v169
    v_mad_u32_u24 v160, v161, s60, v160
    v_bfe_u32 v161, v169, 3, 1
    v_mad_u32_u24 v160, v161, s61, v160
    v_bfe_u32 v161, v169, 2, 1
    v_mad_u32_u24 v160, v161, s96, v160
    s_add_u32 m0, s101, 1024
    v_mad_u32_u24 v160, v160, s97, v174
    s_waitcnt vmcnt(3)
    buffer_load_dwordx4 v160, s[36:39], s98 offen lds
    v_and_b32 v160, 3, v170
    v_lshrrev_b32 v161, 4, v170
    v_mad_u32_u24 v160, v161, s60, v160
    v_bfe_u32 v161, v170, 3, 1
    v_mad_u32_u24 v160, v161, s61, v160
    v_bfe_u32 v161, v170, 2, 1
    v_mad_u32_u24 v160, v161, s96, v160
    s_add_u32 m0, s101, 2048
    v_mad_u32_u24 v160, v160, s97, v175
    s_waitcnt vmcnt(3)
    buffer_load_dwordx4 v160, s[36:39], s98 offen lds
    v_and_b32 v160, 3, v171
    v_lshrrev_b32 v161, 4, v171
    v_mad_u32_u24 v160, v161, s60, v160
    v_bfe_u32 v161, v171, 3, 1
    v_mad_u32_u24 v160, v161, s61, v160
    v_bfe_u32 v161, v171, 2, 1
    v_mad_u32_u24 v160, v161, s96, v160
    s_add_u32 m0, s101, 3072
    v_mad_u32_u24 v160, v160, s97, v176
    s_waitcnt vmcnt(3)
    buffer_load_dwordx4 v160, s[36:39], s98 offen lds
    v_and_b32 v160, 3, v172
    v_lshrrev_b32 v161, 4, v172
    v_mad_u32_u24 v160, v161, s60, v160
    v_bfe_u32 v161, v172, 3, 1
    v_mad_u32_u24 v160, v161, s61, v160
    v_bfe_u32 v161, v172, 2, 1
    v_mad_u32_u24 v160, v161, s96, v160
    s_add_u32 m0, s101, 4096
    v_mad_u32_u24 v160, v160, s97, v177
    s_waitcnt vmcnt(3)
    buffer_load_dwordx4 v160, s[36:39], s98 offen lds
    s_mul_i32 s48, s59, 74
    s_add_u32 s48, s48, s58
    s_mul_i32 s48, s48, 5120
    s_add_u32 s48, s48, 17563648
    s_cmp_eq_u32 s49, 0
    s_cselect_b32 s50, s48, s50
    s_cmp_eq_u32 s49, 1
    s_cselect_b32 s51, s48, s51
    s_add_u32 s49, s49, 1
    s_add_u32 s99, s99, 256
    s_add_u32 s101, s101, 20480
    s_sub_u32 s47, s99, 512
    s_cmp_lt_u32 s47, 80
    s_cbranch_scc1 g1_rl_loop
    s_mul_i32 s101, s40, 5120
    v_lshrrev_b32 v160, 4, v1
    v_bfe_u32 v161, v1, 2, 2
    v_lshl_add_u32 v160, v160, 3, v161
    v_mul_u32_u24 v160, 160, v160
    v_and_b32 v161, 3, v1
    v_mad_u32_u24 v160, v161, 40, v160
    v_add_u32 v160, s101, v160
    v_lshlrev_b32 v161, 4, v1
    v_add_u32 v162, 4096, v161
    s_waitcnt vmcnt(0)
    s_barrier
    s_cmp_lg_u32 s40, 0
    s_cbranch_scc1 g1_rl_np
    s_mov_b64 exec, 1
    buffer_store_dword v11, off, s[24:27], s100 sc1
    s_mov_b64 exec, -1
g1_rl_np:
    ds_read_b64_tr_b16 v[180:181], v160 offset:0
    ds_read_b64_tr_b16 v[182:183], v160 offset:640
    ds_read_b64_tr_b16 v[184:185], v160 offset:8
    ds_read_b64_tr_b16 v[186:187], v160 offset:648
    ds_read_b64_tr_b16 v[188:189], v160 offset:16
    ds_read_b64_tr_b16 v[190:191], v160 offset:656
    ds_read_b64_tr_b16 v[192:193], v160 offset:24
    ds_read_b64_tr_b16 v[194:195], v160 offset:664
    ds_read_b64_tr_b16 v[196:197], v160 offset:32
    ds_read_b64_tr_b16 v[198:199], v160 offset:672
    s_waitcnt lgkmcnt(0)
    s_waitcnt vmcnt(3)
    buffer_store_dwordx4 v[180:183], v161, s[24:27], s50 offen offset:0 sc1
    s_waitcnt vmcnt(3)
    buffer_store_dwordx4 v[184:187], v161, s[24:27], s50 offen offset:1024 sc1
    s_waitcnt vmcnt(3)
    buffer_store_dwordx4 v[188:191], v161, s[24:27], s50 offen offset:2048 sc1
    s_waitcnt vmcnt(3)
    buffer_store_dwordx4 v[192:195], v161, s[24:27], s50 offen offset:3072 sc1
    s_waitcnt vmcnt(3)
    buffer_store_dwordx4 v[196:199], v162, s[24:27], s50 offen offset:0 sc1
    s_cmp_eq_u32 s49, 1
    s_cbranch_scc1 g1_rl_fin
    ds_read_b64_tr_b16 v[200:201], v160 offset:20480
    ds_read_b64_tr_b16 v[202:203], v160 offset:21120
    ds_read_b64_tr_b16 v[204:205], v160 offset:20488
    ds_read_b64_tr_b16 v[206:207], v160 offset:21128
    ds_read_b64_tr_b16 v[208:209], v160 offset:20496
    ds_read_b64_tr_b16 v[210:211], v160 offset:21136
    ds_read_b64_tr_b16 v[212:213], v160 offset:20504
    ds_read_b64_tr_b16 v[214:215], v160 offset:21144
    ds_read_b64_tr_b16 v[216:217], v160 offset:20512
    ds_read_b64_tr_b16 v[218:219], v160 offset:21152
    s_waitcnt lgkmcnt(0)
    s_waitcnt vmcnt(3)
    buffer_store_dwordx4 v[200:203], v161, s[24:27], s51 offen offset:0 sc1
    s_waitcnt vmcnt(3)
    buffer_store_dwordx4 v[204:207], v161, s[24:27], s51 offen offset:1024 sc1
    s_waitcnt vmcnt(3)
    buffer_store_dwordx4 v[208:211], v161, s[24:27], s51 offen offset:2048 sc1
    s_waitcnt vmcnt(3)
    buffer_store_dwordx4 v[212:215], v161, s[24:27], s51 offen offset:3072 sc1
    s_waitcnt vmcnt(3)
    buffer_store_dwordx4 v[216:219], v162, s[24:27], s51 offen offset:0 sc1
g1_rl_fin:
    s_waitcnt vmcnt(0)
    s_barrier
    s_cmp_lg_u32 s40, 0
    s_cbranch_scc1 g1_rl_done
    s_mov_b64 exec, 1
    buffer_store_dword v11, off, s[24:27], s57 sc1
    s_mov_b64 exec, -1
g1_rl_done:
    s_add_u32 s57, s57, 2048
    s_cmp_lt_u32 s99, 512
    s_cbranch_scc1 g1_rl_pass
    s_lshr_b32 s42, s2, 5
    s_and_b32 s55, s2, 7
    s_bfe_u32 s54, s2, 131075
    s_lshl2_add_u32 s41, s55, s54
    s_mul_i32 s44, s42, 378880
    s_mul_i32 s43, s40, 5120
    s_add_u32 s44, s44, s43
    s_add_u32 s44, s44, 17563648
    s_add_u32 s50, s44, 276480
    s_mul_i32 s45, s41, 221184
    s_lshl_b32 s54, s40, 10
    s_add_u32 s45, s45, s54
    s_add_u32 s45, s45, 7864320
    v_lshlrev_b32 v2, 4, v1
    v_add_u32 v4, 4096, v2
    s_add_u32 s54, s40, 0
    s_and_b32 s54, s54, 3
    s_mul_i32 s54, s54, 55296
    v_add_u32 v12, s54, v2
    s_add_u32 s54, s40, 1
    s_and_b32 s54, s54, 3
    s_mul_i32 s54, s54, 55296
    v_add_u32 v13, s54, v2
    s_add_u32 s54, s40, 2
    s_and_b32 s54, s54, 3
    s_mul_i32 s54, s54, 55296
    v_add_u32 v14, s54, v2
    s_add_u32 s54, s40, 3
    s_and_b32 s54, s54, 3
    s_mul_i32 s54, s54, 55296
    v_add_u32 v15, s54, v2
    s_mov_b32 s54, 0
    s_cmp_eq_u32 s40, 0
    s_cselect_b32 s49, -1, -1
    s_waitcnt vmcnt(0) lgkmcnt(0)
    s_cbranch_scc0 g2l_p4_ok
    v_cmp_ne_u32 vcc, v8, v11
    s_nop 1
    s_cbranch_vccz g2l_p4_ok
    s_mov_b32 s56, 0x20000
g2l_p4:
    buffer_load_dword v8, v7, s[24:27], s54 offen sc1
    s_waitcnt vmcnt(0)
    v_cmp_ne_u32 vcc, v8, v11
    s_sub_u32 s56, s56, 1
    s_cbranch_scc1 g2l_p4_ok
    s_cbranch_vccz g2l_p4_ok
    s_mov_b64 exec, vcc
    s_sleep 16
    s_branch g2l_p4
g2l_p4_ok:
    s_mov_b64 exec, -1
    s_barrier
    buffer_load_dwordx4 v[112:115], v2, s[24:27], s44 offen offset:0 sc1
    buffer_load_dwordx4 v[96:99], v12, s[24:27], s45 offen sc1
    buffer_load_dwordx4 v[116:119], v2, s[24:27], s44 offen offset:1024 sc1
    buffer_load_dwordx4 v[100:103], v13, s[24:27], s45 offen sc1
    buffer_load_dwordx4 v[120:123], v2, s[24:27], s44 offen offset:2048 sc1
    buffer_load_dwordx4 v[104:107], v14, s[24:27], s45 offen sc1
    buffer_load_dwordx4 v[124:127], v2, s[24:27], s44 offen offset:3072 sc1
    buffer_load_dwordx4 v[108:111], v15, s[24:27], s45 offen sc1
    buffer_load_dwordx4 v[128:131], v4, s[24:27], s44 offen offset:0 sc1
    s_add_u32 s44, s44, 20480
    s_add_u32 s45, s45, 4096
    buffer_load_dwordx4 v[148:151], v2, s[24:27], s44 offen offset:0 sc1
    v_add_u32 v3, 61440, v2
    v_and_b32 v8, 15, v1
    buffer_load_dwordx4 v[132:135], v12, s[24:27], s45 offen sc1
    v_mul_u32_u24 v5, 1280, v8
    v_lshrrev_b32 v8, 4, v1
    buffer_load_dwordx4 v[152:155], v2, s[24:27], s44 offen offset:1024 sc1
    v_mad_u32_u24 v5, v8, 40, v5
    v_and_b32 v0, 31, v1
    buffer_load_dwordx4 v[136:139], v13, s[24:27], s45 offen sc1
    v_lshlrev_b32 v0, 6, v0
    v_min_u32 v6, 11, v1
    buffer_load_dwordx4 v[156:159], v2, s[24:27], s44 offen offset:2048 sc1
    s_lshr_b32 s54, s41, 1
    s_lshl_b32 s54, s54, 10
    buffer_load_dwordx4 v[140:143], v14, s[24:27], s45 offen sc1
    s_add_u32 s54, s54, 20766720
    v_lshl_add_u32 v6, v6, 6, s54
    buffer_load_dwordx4 v[160:163], v2, s[24:27], s44 offen offset:3072 sc1
    s_lshr_b32 s54, s2, 7
    s_lshl_b32 s54, s54, 12
    buffer_load_dwordx4 v[144:147], v15, s[24:27], s45 offen sc1
    s_add_u32 s54, s54, 20758528
    s_mov_b32 exec_lo, 0
    v_lshl_add_u32 v6, v1, 6, s54
    s_mov_b32 exec_lo, -1
    buffer_load_dwordx4 v[164:167], v4, s[24:27], s44 offen offset:0 sc1
    s_add_u32 s44, s44, 20480
    s_add_u32 s45, s45, 4096
    s_waitcnt vmcnt(9)
    s_branch g1_g1end
g1_medium:
    s_and_b32 s54, s42, 1
    s_lshl_b32 s55, s54, 9
    v_add_u32 v2, s55, v2
    v_add_u32 v3, s55, v3
    v_add_u32 v4, s55, v4
    v_add_u32 v5, s55, v5
    ds_read_b64_tr_b16 v[16:17], v2 offset:0
    ds_read_b64_tr_b16 v[18:19], v2 offset:1024
    ds_read_b64_tr_b16 v[20:21], v3 offset:0
    ds_read_b64_tr_b16 v[22:23], v3 offset:1024
    ds_read_b64_tr_b16 v[24:25], v2 offset:4096
    ds_read_b64_tr_b16 v[26:27], v2 offset:5120
    ds_read_b64_tr_b16 v[28:29], v3 offset:4096
    ds_read_b64_tr_b16 v[30:31], v3 offset:5120
    s_add_u32 s55, s42, s48
    s_lshl1_add_u32 s54, s55, s54
    s_lshl_b32 s54, s54, 10
    s_mul_i32 s58, s43, 110592
    s_add_u32 s58, s58, s54
    s_add_u32 s58, s58, 7864320
    s_add_u32 s57, s58, 55296
    s_sub_u32 s99, s97, 1
g1_hloop:
    s_waitcnt lgkmcnt(6)
    s_setprio 0
    v_mfma_f32_16x16x32_bf16 v[32:35], v[16:19], v[96:99], 0
    s_add_u32 s49, s49, s51
    buffer_load_dwordx4 v6, s[32:35], s49 offen offset:2048 lds
    v_mfma_f32_16x16x32_bf16 v[48:51], v[16:19], v[176:179], 0
    s_waitcnt lgkmcnt(4)
    ds_read_b64_tr_b16 v[16:17], v2 offset:8192
    ds_read_b64_tr_b16 v[18:19], v2 offset:9216
    v_mfma_f32_16x16x32_bf16 v[52:55], v[20:23], v[176:179], 0
    s_add_u32 s49, s49, s50
    buffer_load_dwordx4 v6, s[32:35], s49 offen offset:3072 lds
    v_mfma_f32_16x16x32_bf16 v[36:39], v[20:23], v[96:99], 0
    s_waitcnt lgkmcnt(4)
    ds_read_b64_tr_b16 v[20:21], v3 offset:8192
    ds_read_b64_tr_b16 v[22:23], v3 offset:9216
    v_mfma_f32_16x16x32_bf16 v[32:35], v[24:27], v[100:103], v[32:35]
    s_add_u32 s49, s49, s52
    s_cmp_ge_u32 s49, s34
    s_cselect_b32 s101, s34, 0
    s_sub_u32 s49, s49, s101
    s_add_u32 s54, s45, 1
    s_sub_u32 s55, s54, s47
    s_lshr_b32 s55, s55, 1
    s_mul_i32 s55, s55, s48
    s_add_u32 s55, s55, s42
    s_mul_i32 s56, s54, 5
    s_add_u32 s56, s56, s36
    s_movk_i32 s53, 3456
    s_cmp_lt_u32 s54, s47
    s_cselect_b32 s55, s56, s55
    s_cselect_b32 s53, 3840, s53
    s_mul_i32 s56, s96, s53
    s_add_u32 s55, s55, s56
    v_mfma_f32_16x16x32_bf16 v[48:51], v[24:27], v[180:183], v[48:51]
    s_waitcnt lgkmcnt(4)
    ds_read_b64_tr_b16 v[24:25], v2 offset:12288
    ds_read_b64_tr_b16 v[26:27], v2 offset:13312
    v_mfma_f32_16x16x32_bf16 v[52:55], v[28:31], v[180:183], v[52:55]
    v_mfma_f32_16x16x32_bf16 v[36:39], v[28:31], v[100:103], v[36:39]
    s_waitcnt lgkmcnt(4)
    ds_read_b64_tr_b16 v[28:29], v3 offset:12288
    ds_read_b64_tr_b16 v[30:31], v3 offset:13312
    v_mfma_f32_16x16x32_bf16 v[32:35], v[16:19], v[104:107], v[32:35]
    s_add_u32 m0, s44, 65536
    s_waitcnt vmcnt(8)
    s_barrier
    v_mfma_f32_16x16x32_bf16 v[48:51], v[16:19], v[184:187], v[48:51]
    s_waitcnt lgkmcnt(4)
    ds_read_b64_tr_b16 v[16:17], v2 offset:16384
    ds_read_b64_tr_b16 v[18:19], v2 offset:17408
    v_mfma_f32_16x16x32_bf16 v[52:55], v[20:23], v[184:187], v[52:55]
    buffer_load_dwordx4 v6, s[32:35], s49 offen offset:0 lds
    v_mfma_f32_16x16x32_bf16 v[36:39], v[20:23], v[104:107], v[36:39]
    s_waitcnt lgkmcnt(4)
    ds_read_b64_tr_b16 v[20:21], v3 offset:16384
    ds_read_b64_tr_b16 v[22:23], v3 offset:17408
    v_mfma_f32_16x16x32_bf16 v[32:35], v[24:27], v[108:111], v[32:35]
    s_add_u32 s49, s49, s50
    buffer_load_dwordx4 v6, s[32:35], s49 offen offset:1024 lds
    v_mfma_f32_16x16x32_bf16 v[48:51], v[24:27], v[188:191], v[48:51]
    s_waitcnt lgkmcnt(4)
    ds_read_b64_tr_b16 v[24:25], v2 offset:20480
    ds_read_b64_tr_b16 v[26:27], v2 offset:21504
    v_mfma_f32_16x16x32_bf16 v[52:55], v[28:31], v[188:191], v[52:55]
    s_add_u32 s49, s49, s51
    buffer_load_dwordx4 v6, s[32:35], s49 offen offset:2048 lds
    v_mfma_f32_16x16x32_bf16 v[36:39], v[28:31], v[108:111], v[36:39]
    s_waitcnt lgkmcnt(4)
    ds_read_b64_tr_b16 v[28:29], v3 offset:20480
    ds_read_b64_tr_b16 v[30:31], v3 offset:21504
    v_mfma_f32_16x16x32_bf16 v[32:35], v[16:19], v[112:115], v[32:35]
    s_add_u32 s49, s49, s50
    buffer_load_dwordx4 v6, s[32:35], s49 offen offset:3072 lds
    v_mfma_f32_16x16x32_bf16 v[48:51], v[16:19], v[192:195], v[48:51]
    s_waitcnt lgkmcnt(4)
    ds_read_b64_tr_b16 v[16:17], v2 offset:24576
    ds_read_b64_tr_b16 v[18:19], v2 offset:25600
    v_mfma_f32_16x16x32_bf16 v[52:55], v[20:23], v[192:195], v[52:55]
    s_bitcmp1_b32 s54, 0
    s_cselect_b32 s32, s14, s12
    s_cselect_b32 s33, s15, s13
    s_cmp_lt_u32 s54, s47
    s_cselect_b32 s32, s6, s32
    s_cselect_b32 s33, s7, s33
    s_mul_i32 s34, s53, 640
    s_cmp_lt_u32 s54, s46
    s_cselect_b32 s34, s34, 0
    s_lshl_b32 s49, s55, 7
    s_lshl_b32 s50, s53, 2
    s_mul_i32 s51, s53, 12
    s_mul_i32 s52, s53, 108
    s_sub_u32 s50, s50, 1024
    s_sub_u32 s51, s51, 1024
    s_add_u32 s52, s52, 3072
    v_mfma_f32_16x16x32_bf16 v[36:39], v[20:23], v[112:115], v[36:39]
    s_waitcnt lgkmcnt(4)
    ds_read_b64_tr_b16 v[20:21], v3 offset:24576
    ds_read_b64_tr_b16 v[22:23], v3 offset:25600
    v_mfma_f32_16x16x32_bf16 v[32:35], v[24:27], v[116:119], v[32:35]
    v_mfma_f32_16x16x32_bf16 v[48:51], v[24:27], v[196:199], v[48:51]
    s_waitcnt lgkmcnt(4)
    ds_read_b64_tr_b16 v[24:25], v2 offset:28672
    ds_read_b64_tr_b16 v[26:27], v2 offset:29696
    v_mfma_f32_16x16x32_bf16 v[52:55], v[28:31], v[196:199], v[52:55]
    v_mfma_f32_16x16x32_bf16 v[36:39], v[28:31], v[116:119], v[36:39]
    s_waitcnt lgkmcnt(4)
    ds_read_b64_tr_b16 v[28:29], v3 offset:28672
    ds_read_b64_tr_b16 v[30:31], v3 offset:29696
    v_mfma_f32_16x16x32_bf16 v[32:35], v[16:19], v[120:123], v[32:35]
    s_add_u32 m0, s44, 0
    s_waitcnt vmcnt(8)
    s_barrier
    v_mfma_f32_16x16x32_bf16 v[48:51], v[16:19], v[200:203], v[48:51]
    s_waitcnt lgkmcnt(4)
    ds_read_b64_tr_b16 v[16:17], v2 offset:32768
    ds_read_b64_tr_b16 v[18:19], v2 offset:33792
    v_mfma_f32_16x16x32_bf16 v[52:55], v[20:23], v[200:203], v[52:55]
    buffer_load_dwordx4 v6, s[32:35], s49 offen offset:0 lds
    v_mfma_f32_16x16x32_bf16 v[36:39], v[20:23], v[120:123], v[36:39]
    s_waitcnt lgkmcnt(4)
    ds_read_b64_tr_b16 v[20:21], v3 offset:32768
    ds_read_b64_tr_b16 v[22:23], v3 offset:33792
    v_mfma_f32_16x16x32_bf16 v[32:35], v[24:27], v[124:127], v[32:35]
    s_add_u32 s49, s49, s50
    buffer_load_dwordx4 v6, s[32:35], s49 offen offset:1024 lds
    v_mfma_f32_16x16x32_bf16 v[48:51], v[24:27], v[204:207], v[48:51]
    s_waitcnt lgkmcnt(4)
    ds_read_b64_tr_b16 v[24:25], v2 offset:36864
    ds_read_b64_tr_b16 v[26:27], v2 offset:37888
    v_mfma_f32_16x16x32_bf16 v[52:55], v[28:31], v[204:207], v[52:55]
    s_add_u32 s49, s49, s51
    buffer_load_dwordx4 v6, s[32:35], s49 offen offset:2048 lds
    v_mfma_f32_16x16x32_bf16 v[36:39], v[28:31], v[124:127], v[36:39]
    s_waitcnt lgkmcnt(4)
    ds_read_b64_tr_b16 v[28:29], v3 offset:36864
    ds_read_b64_tr_b16 v[30:31], v3 offset:37888
    v_mfma_f32_16x16x32_bf16 v[32:35], v[16:19], v[128:131], v[32:35]
    s_add_u32 s49, s49, s50
    buffer_load_dwordx4 v6, s[32:35], s49 offen offset:3072 lds
    v_mfma_f32_16x16x32_bf16 v[48:51], v[16:19], v[208:211], v[48:51]
    s_waitcnt lgkmcnt(4)
    ds_read_b64_tr_b16 v[16:17], v2 offset:40960
    ds_read_b64_tr_b16 v[18:19], v2 offset:41984
    v_mfma_f32_16x16x32_bf16 v[52:55], v[20:23], v[208:211], v[52:55]
    s_add_u32 s49, s49, s52
    s_cmp_ge_u32 s49, s34
    s_cselect_b32 s101, s34, 0
    v_mfma_f32_16x16x32_bf16 v[36:39], v[20:23], v[128:131], v[36:39]
    s_waitcnt lgkmcnt(4)
    ds_read_b64_tr_b16 v[20:21], v3 offset:40960
    ds_read_b64_tr_b16 v[22:23], v3 offset:41984
    v_mfma_f32_16x16x32_bf16 v[32:35], v[24:27], v[132:135], v[32:35]
    s_sub_u32 s49, s49, s101
    v_mfma_f32_16x16x32_bf16 v[48:51], v[24:27], v[212:215], v[48:51]
    s_waitcnt lgkmcnt(4)
    ds_read_b64_tr_b16 v[24:25], v2 offset:45056
    ds_read_b64_tr_b16 v[26:27], v2 offset:46080
    v_mfma_f32_16x16x32_bf16 v[52:55], v[28:31], v[212:215], v[52:55]
    v_mfma_f32_16x16x32_bf16 v[36:39], v[28:31], v[132:135], v[36:39]
    s_waitcnt lgkmcnt(4)
    ds_read_b64_tr_b16 v[28:29], v3 offset:45056
    ds_read_b64_tr_b16 v[30:31], v3 offset:46080
    v_mfma_f32_16x16x32_bf16 v[32:35], v[16:19], v[136:139], v[32:35]
    s_add_u32 m0, s44, 16384
    s_waitcnt vmcnt(8)
    s_barrier
    v_mfma_f32_16x16x32_bf16 v[48:51], v[16:19], v[216:219], v[48:51]
    s_waitcnt lgkmcnt(4)
    ds_read_b64_tr_b16 v[16:17], v2 offset:49152
    ds_read_b64_tr_b16 v[18:19], v2 offset:50176
    v_mfma_f32_16x16x32_bf16 v[52:55], v[20:23], v[216:219], v[52:55]
    s_cmp_eq_u32 s45, s99
    s_cbranch_scc1 g1_hpub
g1_hpubr:
    v_mfma_f32_16x16x32_bf16 v[36:39], v[20:23], v[136:139], v[36:39]
    s_waitcnt lgkmcnt(4)
    ds_read_b64_tr_b16 v[20:21], v3 offset:49152
    ds_read_b64_tr_b16 v[22:23], v3 offset:50176
    v_mfma_f32_16x16x32_bf16 v[32:35], v[24:27], v[140:143], v[32:35]
    buffer_load_dwordx4 v6, s[32:35], s49 offen offset:0 lds
    v_mfma_f32_16x16x32_bf16 v[48:51], v[24:27], v[220:223], v[48:51]
    s_waitcnt lgkmcnt(4)
    ds_read_b64_tr_b16 v[24:25], v2 offset:53248
    ds_read_b64_tr_b16 v[26:27], v2 offset:54272
    v_mfma_f32_16x16x32_bf16 v[52:55], v[28:31], v[220:223], v[52:55]
    s_add_u32 s49, s49, s50
    buffer_load_dwordx4 v6, s[32:35], s49 offen offset:1024 lds
    v_mfma_f32_16x16x32_bf16 v[36:39], v[28:31], v[140:143], v[36:39]
    s_waitcnt lgkmcnt(4)
    ds_read_b64_tr_b16 v[28:29], v3 offset:53248
    ds_read_b64_tr_b16 v[30:31], v3 offset:54272
    v_mfma_f32_16x16x32_bf16 v[32:35], v[16:19], v[144:147], v[32:35]
    s_add_u32 s49, s49, s51
    buffer_load_dwordx4 v6, s[32:35], s49 offen offset:2048 lds
    v_mfma_f32_16x16x32_bf16 v[48:51], v[16:19], v[224:227], v[48:51]
    s_waitcnt lgkmcnt(4)
    ds_read_b64_tr_b16 v[16:17], v2 offset:57344
    ds_read_b64_tr_b16 v[18:19], v2 offset:58368
    v_mfma_f32_16x16x32_bf16 v[52:55], v[20:23], v[224:227], v[52:55]
    s_add_u32 s49, s49, s50
    buffer_load_dwordx4 v6, s[32:35], s49 offen offset:3072 lds
    v_mfma_f32_16x16x32_bf16 v[36:39], v[20:23], v[144:147], v[36:39]
    s_waitcnt lgkmcnt(4)
    ds_read_b64_tr_b16 v[20:21], v3 offset:57344
    ds_read_b64_tr_b16 v[22:23], v3 offset:58368
    v_mfma_f32_16x16x32_bf16 v[32:35], v[24:27], v[148:151], v[32:35]
    s_add_u32 s49, s49, s52
    s_cmp_ge_u32 s49, s34
    s_cselect_b32 s101, s34, 0
    v_mfma_f32_16x16x32_bf16 v[48:51], v[24:27], v[228:231], v[48:51]
    s_waitcnt lgkmcnt(4)
    ds_read_b64_tr_b16 v[24:25], v2 offset:61440
    ds_read_b64_tr_b16 v[26:27], v2 offset:62464
    v_mfma_f32_16x16x32_bf16 v[52:55], v[28:31], v[228:231], v[52:55]
    s_sub_u32 s49, s49, s101
    v_mfma_f32_16x16x32_bf16 v[36:39], v[28:31], v[148:151], v[36:39]
    s_waitcnt lgkmcnt(4)
    ds_read_b64_tr_b16 v[28:29], v3 offset:61440
    ds_read_b64_tr_b16 v[30:31], v3 offset:62464
    v_mfma_f32_16x16x32_bf16 v[32:35], v[16:19], v[152:155], v[32:35]
    s_add_u32 m0, s44, 32768
    s_waitcnt vmcnt(8)
    s_barrier
    v_mfma_f32_16x16x32_bf16 v[48:51], v[16:19], v[232:235], v[48:51]
    s_waitcnt lgkmcnt(4)
    ds_read_b64_tr_b16 v[16:17], v4 offset:0
    ds_read_b64_tr_b16 v[18:19], v4 offset:1024
    v_mfma_f32_16x16x32_bf16 v[52:55], v[20:23], v[232:235], v[52:55]
    s_cmp_eq_u32 s45, s97
    s_cbranch_scc1 g1_hchk
g1_hchkr:
    v_mfma_f32_16x16x32_bf16 v[36:39], v[20:23], v[152:155], v[36:39]
    s_waitcnt lgkmcnt(4)
    ds_read_b64_tr_b16 v[20:21], v5 offset:0
    ds_read_b64_tr_b16 v[22:23], v5 offset:1024
    v_mfma_f32_16x16x32_bf16 v[32:35], v[24:27], v[156:159], v[32:35]
    buffer_load_dwordx4 v6, s[32:35], s49 offen offset:0 lds
    v_mfma_f32_16x16x32_bf16 v[48:51], v[24:27], v[236:239], v[48:51]
    s_waitcnt lgkmcnt(4)
    ds_read_b64_tr_b16 v[24:25], v4 offset:4096
    ds_read_b64_tr_b16 v[26:27], v4 offset:5120
    v_mfma_f32_16x16x32_bf16 v[52:55], v[28:31], v[236:239], v[52:55]
    s_add_u32 s49, s49, s50
    buffer_load_dwordx4 v6, s[32:35], s49 offen offset:1024 lds
    v_mfma_f32_16x16x32_bf16 v[36:39], v[28:31], v[156:159], v[36:39]
    s_waitcnt lgkmcnt(4)
    ds_read_b64_tr_b16 v[28:29], v5 offset:4096
    ds_read_b64_tr_b16 v[30:31], v5 offset:5120
    v_mfma_f32_16x16x32_bf16 v[32:35], v[16:19], v[160:163], v[32:35]
    s_add_u32 s49, s49, s51
    buffer_load_dwordx4 v6, s[32:35], s49 offen offset:2048 lds
    v_mfma_f32_16x16x32_bf16 v[48:51], v[16:19], v[240:243], v[48:51]
    s_waitcnt lgkmcnt(4)
    ds_read_b64_tr_b16 v[16:17], v4 offset:8192
    ds_read_b64_tr_b16 v[18:19], v4 offset:9216
    v_mfma_f32_16x16x32_bf16 v[52:55], v[20:23], v[240:243], v[52:55]
    s_add_u32 s49, s49, s50
    buffer_load_dwordx4 v6, s[32:35], s49 offen offset:3072 lds
    v_mfma_f32_16x16x32_bf16 v[36:39], v[20:23], v[160:163], v[36:39]
    s_waitcnt lgkmcnt(4)
    ds_read_b64_tr_b16 v[20:21], v5 offset:8192
    ds_read_b64_tr_b16 v[22:23], v5 offset:9216
    v_mfma_f32_16x16x32_bf16 v[32:35], v[24:27], v[164:167], v[32:35]
    s_add_u32 s49, s49, s52
    s_cmp_ge_u32 s49, s34
    s_cselect_b32 s101, s34, 0
    v_mfma_f32_16x16x32_bf16 v[48:51], v[24:27], v[244:247], v[48:51]
    s_waitcnt lgkmcnt(4)
    ds_read_b64_tr_b16 v[24:25], v4 offset:12288
    ds_read_b64_tr_b16 v[26:27], v4 offset:13312
    v_mfma_f32_16x16x32_bf16 v[52:55], v[28:31], v[244:247], v[52:55]
    s_sub_u32 s49, s49, s101
    v_mfma_f32_16x16x32_bf16 v[36:39], v[28:31], v[164:167], v[36:39]
    s_waitcnt lgkmcnt(4)
    ds_read_b64_tr_b16 v[28:29], v5 offset:12288
    ds_read_b64_tr_b16 v[30:31], v5 offset:13312
    v_mfma_f32_16x16x32_bf16 v[32:35], v[16:19], v[168:171], v[32:35]
    s_add_u32 m0, s44, 49152
    s_waitcnt vmcnt(8)
    s_barrier
    v_mfma_f32_16x16x32_bf16 v[48:51], v[16:19], v[248:251], v[48:51]
    s_waitcnt lgkmcnt(4)
    ds_read_b64_tr_b16 v[16:17], v2 offset:0
    ds_read_b64_tr_b16 v[18:19], v2 offset:1024
    v_mfma_f32_16x16x32_bf16 v[52:55], v[20:23], v[248:251], v[52:55]
    buffer_load_dwordx4 v6, s[32:35], s49 offen offset:0 lds
    v_mfma_f32_16x16x32_bf16 v[36:39], v[20:23], v[168:171], v[36:39]
    s_waitcnt lgkmcnt(4)
    ds_read_b64_tr_b16 v[20:21], v3 offset:0
    ds_read_b64_tr_b16 v[22:23], v3 offset:1024
    v_mfma_f32_16x16x32_bf16 v[32:35], v[24:27], v[172:175], v[32:35]
    s_add_u32 s49, s49, s50
    buffer_load_dwordx4 v6, s[32:35], s49 offen offset:1024 lds
    v_mfma_f32_16x16x32_bf16 v[48:51], v[24:27], v[252:255], v[48:51]
    s_waitcnt lgkmcnt(4)
    ds_read_b64_tr_b16 v[24:25], v2 offset:4096
    ds_read_b64_tr_b16 v[26:27], v2 offset:5120
    v_mfma_f32_16x16x32_bf16 v[52:55], v[28:31], v[252:255], v[52:55]
    v_mfma_f32_16x16x32_bf16 v[36:39], v[28:31], v[172:175], v[36:39]
    s_waitcnt lgkmcnt(4)
    ds_read_b64_tr_b16 v[28:29], v3 offset:4096
    ds_read_b64_tr_b16 v[30:31], v3 offset:5120
    s_setprio 2
    s_cmp_eq_u32 s45, 5
    s_cbranch_scc1 g1_hend
    s_nop 1
    v_pk_mul_f32 v[64:65], v[32:33], v[32:33] op_sel:[0,0] op_sel_hi:[1,1]
    v_pk_mul_f32 v[66:67], v[34:35], v[34:35] op_sel:[0,0] op_sel_hi:[1,1]
    v_pk_mul_f32 v[68:69], v[36:37], v[36:37] op_sel:[0,0] op_sel_hi:[1,1]
    v_pk_mul_f32 v[70:71], v[38:39], v[38:39] op_sel:[0,0] op_sel_hi:[1,1]
    v_pk_fma_f32 v[64:65], v[64:65], v[12:13], v[10:11] op_sel:[0,0,0] op_sel_hi:[1,0,0]
    v_pk_fma_f32 v[66:67], v[66:67], v[12:13], v[10:11] op_sel:[0,0,0] op_sel_hi:[1,0,0]
    v_pk_fma_f32 v[68:69], v[68:69], v[12:13], v[10:11] op_sel:[0,0,0] op_sel_hi:[1,0,0]
    v_pk_fma_f32 v[70:71], v[70:71], v[12:13], v[10:11] op_sel:[0,0,0] op_sel_hi:[1,0,0]
    v_pk_mul_f32 v[64:65], v[64:65], v[32:33] op_sel:[0,0] op_sel_hi:[1,1]
    v_pk_mul_f32 v[66:67], v[66:67], v[34:35] op_sel:[0,0] op_sel_hi:[1,1]
    v_pk_mul_f32 v[68:69], v[68:69], v[36:37] op_sel:[0,0] op_sel_hi:[1,1]
    v_pk_mul_f32 v[70:71], v[70:71], v[38:39] op_sel:[0,0] op_sel_hi:[1,1]
    v_exp_f32 v64, v64
    v_exp_f32 v65, v65
    v_exp_f32 v66, v66
    v_exp_f32 v67, v67
    v_exp_f32 v68, v68
    v_exp_f32 v69, v69
    v_exp_f32 v70, v70
    v_exp_f32 v71, v71
    v_pk_fma_f32 v[64:65], v[64:65], v[12:13], v[12:13] op_sel:[0,1,1] op_sel_hi:[1,1,1]
    v_pk_fma_f32 v[66:67], v[66:67], v[12:13], v[12:13] op_sel:[0,1,1] op_sel_hi:[1,1,1]
    v_pk_fma_f32 v[68:69], v[68:69], v[12:13], v[12:13] op_sel:[0,1,1] op_sel_hi:[1,1,1]
    v_pk_fma_f32 v[70:71], v[70:71], v[12:13], v[12:13] op_sel:[0,1,1] op_sel_hi:[1,1,1]
    v_rcp_f32 v64, v64
    v_rcp_f32 v65, v65
    v_rcp_f32 v66, v66
    v_rcp_f32 v67, v67
    v_rcp_f32 v68, v68
    v_rcp_f32 v69, v69
    v_rcp_f32 v70, v70
    v_rcp_f32 v71, v71
    v_pk_mul_f32 v[64:65], v[64:65], v[32:33] op_sel:[0,0] op_sel_hi:[1,1]
    v_pk_mul_f32 v[66:67], v[66:67], v[34:35] op_sel:[0,0] op_sel_hi:[1,1]
    v_pk_mul_f32 v[68:69], v[68:69], v[36:37] op_sel:[0,0] op_sel_hi:[1,1]
    v_pk_mul_f32 v[70:71], v[70:71], v[38:39] op_sel:[0,0] op_sel_hi:[1,1]
    v_pk_mul_f32 v[80:81], v[48:49], v[48:49] op_sel:[0,0] op_sel_hi:[1,1]
    v_pk_mul_f32 v[82:83], v[50:51], v[50:51] op_sel:[0,0] op_sel_hi:[1,1]
    v_pk_mul_f32 v[84:85], v[52:53], v[52:53] op_sel:[0,0] op_sel_hi:[1,1]
    v_pk_mul_f32 v[86:87], v[54:55], v[54:55] op_sel:[0,0] op_sel_hi:[1,1]
    v_pk_fma_f32 v[80:81], v[80:81], v[14:15], v[14:15] op_sel:[0,1,0] op_sel_hi:[1,1,0]
    v_pk_fma_f32 v[82:83], v[82:83], v[14:15], v[14:15] op_sel:[0,1,0] op_sel_hi:[1,1,0]
    v_pk_fma_f32 v[84:85], v[84:85], v[14:15], v[14:15] op_sel:[0,1,0] op_sel_hi:[1,1,0]
    v_pk_fma_f32 v[86:87], v[86:87], v[14:15], v[14:15] op_sel:[0,1,0] op_sel_hi:[1,1,0]
    v_pk_mul_f32 v[80:81], v[80:81], v[48:49] op_sel:[0,0] op_sel_hi:[1,1]
    v_pk_mul_f32 v[82:83], v[82:83], v[50:51] op_sel:[0,0] op_sel_hi:[1,1]
    v_pk_mul_f32 v[84:85], v[84:85], v[52:53] op_sel:[0,0] op_sel_hi:[1,1]
    v_pk_mul_f32 v[86:87], v[86:87], v[54:55] op_sel:[0,0] op_sel_hi:[1,1]
    v_exp_f32 v80, v80
    v_exp_f32 v81, v81
    v_exp_f32 v82, v82
    v_exp_f32 v83, v83
    v_exp_f32 v84, v84
    v_exp_f32 v85, v85
    v_exp_f32 v86, v86
    v_exp_f32 v87, v87
    v_pk_fma_f32 v[80:81], v[80:81], v[0:1], v[0:1] op_sel:[0,0,0] op_sel_hi:[1,0,0]
    v_pk_fma_f32 v[82:83], v[82:83], v[0:1], v[0:1] op_sel:[0,0,0] op_sel_hi:[1,0,0]
    v_pk_fma_f32 v[84:85], v[84:85], v[0:1], v[0:1] op_sel:[0,0,0] op_sel_hi:[1,0,0]
    v_pk_fma_f32 v[86:87], v[86:87], v[0:1], v[0:1] op_sel:[0,0,0] op_sel_hi:[1,0,0]
    v_rcp_f32 v80, v80
    v_rcp_f32 v81, v81
    v_rcp_f32 v82, v82
    v_rcp_f32 v83, v83
    v_rcp_f32 v84, v84
    v_rcp_f32 v85, v85
    v_rcp_f32 v86, v86
    v_rcp_f32 v87, v87
    v_pk_mul_f32 v[80:81], v[80:81], v[48:49] op_sel:[0,0] op_sel_hi:[1,1]
    v_pk_mul_f32 v[82:83], v[82:83], v[50:51] op_sel:[0,0] op_sel_hi:[1,1]
    v_pk_mul_f32 v[84:85], v[84:85], v[52:53] op_sel:[0,0] op_sel_hi:[1,1]
    v_pk_mul_f32 v[86:87], v[86:87], v[54:55] op_sel:[0,0] op_sel_hi:[1,1]
    s_mov_b32 s45, 5
    s_branch g1_hloop
g1_hpub:
    s_mov_b64 exec, 1
    buffer_store_dword v11, off, s[24:27], s100 sc1
    s_mov_b64 exec, -1
    s_branch g1_hpubr
g1_hchk:
    buffer_load_dword v8, v7, s[24:27], 0 offen sc1
    s_branch g1_hchkr
g1_hend:
    s_add_u32 s100, s100, 155648
    s_lshr_b32 s42, s2, 5
    s_and_b32 s55, s2, 7
    s_bfe_u32 s54, s2, 131075
    s_lshl2_add_u32 s41, s55, s54
    s_mul_i32 s44, s42, 378880
    s_mul_i32 s43, s40, 5120
    s_add_u32 s44, s44, s43
    s_add_u32 s44, s44, 17563648
    s_add_u32 s50, s44, 276480
    s_mul_i32 s45, s41, 221184
    s_lshl_b32 s54, s40, 10
    s_add_u32 s45, s45, s54
    s_add_u32 s45, s45, 7864320
    v_lshlrev_b32 v2, 4, v1
    v_add_u32 v4, 4096, v2
    s_add_u32 s54, s40, 0
    s_and_b32 s54, s54, 3
    s_mul_i32 s54, s54, 55296
    v_add_u32 v12, s54, v2
    s_add_u32 s54, s40, 1
    s_and_b32 s54, s54, 3
    s_mul_i32 s54, s54, 55296
    v_add_u32 v13, s54, v2
    s_add_u32 s54, s40, 2
    s_and_b32 s54, s54, 3
    s_mul_i32 s54, s54, 55296
    v_add_u32 v14, s54, v2
    s_add_u32 s54, s40, 3
    s_and_b32 s54, s54, 3
    s_mul_i32 s54, s54, 55296
    v_add_u32 v15, s54, v2
    s_mov_b32 s54, 0
    s_cmp_eq_u32 s40, 0
    s_cselect_b32 s49, 0, -1
    s_waitcnt vmcnt(0) lgkmcnt(0)
    s_cbranch_scc0 g2m_p4_ok
    v_cmp_ne_u32 vcc, v8, v11
    s_nop 1
    s_cbranch_vccz g2m_p4_ok
    s_mov_b32 s56, 0x20000
g2m_p4:
    buffer_load_dword v8, v7, s[24:27], s54 offen sc1
    s_waitcnt vmcnt(0)
    v_cmp_ne_u32 vcc, v8, v11
    s_sub_u32 s56, s56, 1
    s_cbranch_scc1 g2m_p4_ok
    s_cbranch_vccz g2m_p4_ok
    s_mov_b64 exec, vcc
    s_sleep 16
    s_branch g2m_p4
g2m_p4_ok:
    s_mov_b64 exec, -1
    s_barrier
    buffer_load_dwordx4 v[112:115], v2, s[24:27], s44 offen offset:0 sc1
    v_pk_mul_f32 v[32:33], v[32:33], v[64:65] op_sel:[0,0] op_sel_hi:[1,1]
    v_pk_mul_f32 v[34:35], v[34:35], v[66:67] op_sel:[0,0] op_sel_hi:[1,1]
    buffer_load_dwordx4 v[96:99], v12, s[24:27], s45 offen sc1
    v_pk_mul_f32 v[36:37], v[36:37], v[68:69] op_sel:[0,0] op_sel_hi:[1,1]
    v_pk_mul_f32 v[38:39], v[38:39], v[70:71] op_sel:[0,0] op_sel_hi:[1,1]
    buffer_load_dwordx4 v[116:119], v2, s[24:27], s44 offen offset:1024 sc1
    v_cvt_pk_bf16_f32 v64, v32, v33
    v_cvt_pk_bf16_f32 v65, v34, v35
    buffer_load_dwordx4 v[100:103], v13, s[24:27], s45 offen sc1
    v_cvt_pk_bf16_f32 v66, v36, v37
    v_cvt_pk_bf16_f32 v67, v38, v39
    buffer_load_dwordx4 v[120:123], v2, s[24:27], s44 offen offset:2048 sc1
    v_pk_mul_f32 v[48:49], v[48:49], v[80:81] op_sel:[0,0] op_sel_hi:[1,1]
    v_pk_mul_f32 v[50:51], v[50:51], v[82:83] op_sel:[0,0] op_sel_hi:[1,1]
    buffer_load_dwordx4 v[104:107], v14, s[24:27], s45 offen sc1
    v_pk_mul_f32 v[52:53], v[52:53], v[84:85] op_sel:[0,0] op_sel_hi:[1,1]
    v_pk_mul_f32 v[54:55], v[54:55], v[86:87] op_sel:[0,0] op_sel_hi:[1,1]
    buffer_load_dwordx4 v[124:127], v2, s[24:27], s44 offen offset:3072 sc1
    v_cvt_pk_bf16_f32 v80, v48, v49
    v_cvt_pk_bf16_f32 v81, v50, v51
    buffer_load_dwordx4 v[108:111], v15, s[24:27], s45 offen sc1
    v_cvt_pk_bf16_f32 v82, v52, v53
    v_cvt_pk_bf16_f32 v83, v54, v55
    buffer_load_dwordx4 v[128:131], v4, s[24:27], s44 offen offset:0 sc1
    s_add_u32 s44, s44, 20480
    s_add_u32 s45, s45, 4096
    buffer_store_dwordx4 v[64:67], v9, s[24:27], s58 offen offset:0 sc1
    buffer_store_dwordx4 v[80:83], v9, s[24:27], s57 offen offset:0 sc1
    buffer_load_dwordx4 v[148:151], v2, s[24:27], s44 offen offset:0 sc1
    v_add_u32 v3, 61440, v2
    v_and_b32 v8, 15, v1
    buffer_load_dwordx4 v[132:135], v12, s[24:27], s45 offen sc1
    v_mul_u32_u24 v5, 1280, v8
    v_lshrrev_b32 v8, 4, v1
    buffer_load_dwordx4 v[152:155], v2, s[24:27], s44 offen offset:1024 sc1
    v_mad_u32_u24 v5, v8, 40, v5
    v_and_b32 v0, 31, v1
    buffer_load_dwordx4 v[136:139], v13, s[24:27], s45 offen sc1
    v_lshlrev_b32 v0, 6, v0
    v_min_u32 v6, 11, v1
    buffer_load_dwordx4 v[156:159], v2, s[24:27], s44 offen offset:2048 sc1
    s_lshr_b32 s54, s41, 1
    s_lshl_b32 s54, s54, 10
    buffer_load_dwordx4 v[140:143], v14, s[24:27], s45 offen sc1
    s_add_u32 s54, s54, 20766720
    v_lshl_add_u32 v6, v6, 6, s54
    buffer_load_dwordx4 v[160:163], v2, s[24:27], s44 offen offset:3072 sc1
    s_lshr_b32 s54, s2, 7
    s_lshl_b32 s54, s54, 12
    buffer_load_dwordx4 v[144:147], v15, s[24:27], s45 offen sc1
    s_add_u32 s54, s54, 20758528
    s_mov_b32 exec_lo, 0
    v_lshl_add_u32 v6, v1, 6, s54
    s_mov_b32 exec_lo, -1
    buffer_load_dwordx4 v[164:167], v4, s[24:27], s44 offen offset:0 sc1
    s_add_u32 s44, s44, 20480
    s_add_u32 s45, s45, 4096
    s_waitcnt vmcnt(11)
    s_branch g1_g1end
g1_heavy:
    s_add_u32 s100, s100, 155648
    s_lshr_b32 s42, s2, 5
    s_and_b32 s55, s2, 7
    s_bfe_u32 s54, s2, 131075
    s_lshl2_add_u32 s41, s55, s54
    s_mul_i32 s44, s42, 378880
    s_mul_i32 s43, s40, 5120
    s_add_u32 s44, s44, s43
    s_add_u32 s44, s44, 17563648
    s_add_u32 s50, s44, 276480
    s_mul_i32 s45, s41, 221184
    s_lshl_b32 s54, s40, 10
    s_add_u32 s45, s45, s54
    s_add_u32 s45, s45, 7864320
    v_lshlrev_b32 v2, 4, v1
    v_add_u32 v4, 4096, v2
    s_add_u32 s54, s40, 0
    s_and_b32 s54, s54, 3
    s_mul_i32 s54, s54, 55296
    v_add_u32 v12, s54, v2
    s_add_u32 s54, s40, 1
    s_and_b32 s54, s54, 3
    s_mul_i32 s54, s54, 55296
    v_add_u32 v13, s54, v2
    s_add_u32 s54, s40, 2
    s_and_b32 s54, s54, 3
    s_mul_i32 s54, s54, 55296
    v_add_u32 v14, s54, v2
    s_add_u32 s54, s40, 3
    s_and_b32 s54, s54, 3
    s_mul_i32 s54, s54, 55296
    v_add_u32 v15, s54, v2
    s_mov_b32 s54, 0
    s_cmp_eq_u32 s40, 0
    s_cselect_b32 s49, 0, -1
    s_waitcnt vmcnt(0) lgkmcnt(0)
    s_cbranch_scc0 g2h_p4_ok
    v_cmp_ne_u32 vcc, v8, v11
    s_nop 1
    s_cbranch_vccz g2h_p4_ok
    s_mov_b32 s56, 0x20000
g2h_p4:
    buffer_load_dword v8, v7, s[24:27], s54 offen sc1
    s_waitcnt vmcnt(0)
    v_cmp_ne_u32 vcc, v8, v11
    s_sub_u32 s56, s56, 1
    s_cbranch_scc1 g2h_p4_ok
    s_cbranch_vccz g2h_p4_ok
    s_mov_b64 exec, vcc
    s_sleep 16
    s_branch g2h_p4
g2h_p4_ok:
    s_mov_b64 exec, -1
    s_barrier
    buffer_load_dwordx4 v[112:115], v2, s[24:27], s44 offen offset:0 sc1
    v_pk_mul_f32 v[32:33], v[32:33], v[64:65] op_sel:[0,0] op_sel_hi:[1,1]
    v_pk_mul_f32 v[34:35], v[34:35], v[66:67] op_sel:[0,0] op_sel_hi:[1,1]
    v_pk_mul_f32 v[36:37], v[36:37], v[68:69] op_sel:[0,0] op_sel_hi:[1,1]
    v_pk_mul_f32 v[38:39], v[38:39], v[70:71] op_sel:[0,0] op_sel_hi:[1,1]
    buffer_load_dwordx4 v[96:99], v12, s[24:27], s45 offen sc1
    v_cvt_pk_bf16_f32 v64, v32, v33
    v_cvt_pk_bf16_f32 v65, v34, v35
    v_cvt_pk_bf16_f32 v66, v36, v37
    v_cvt_pk_bf16_f32 v67, v38, v39
    buffer_load_dwordx4 v[116:119], v2, s[24:27], s44 offen offset:1024 sc1
    v_pk_mul_f32 v[40:41], v[40:41], v[72:73] op_sel:[0,0] op_sel_hi:[1,1]
    v_pk_mul_f32 v[42:43], v[42:43], v[74:75] op_sel:[0,0] op_sel_hi:[1,1]
    v_pk_mul_f32 v[44:45], v[44:45], v[76:77] op_sel:[0,0] op_sel_hi:[1,1]
    v_pk_mul_f32 v[46:47], v[46:47], v[78:79] op_sel:[0,0] op_sel_hi:[1,1]
    buffer_load_dwordx4 v[100:103], v13, s[24:27], s45 offen sc1
    v_cvt_pk_bf16_f32 v72, v40, v41
    v_cvt_pk_bf16_f32 v73, v42, v43
    v_cvt_pk_bf16_f32 v74, v44, v45
    v_cvt_pk_bf16_f32 v75, v46, v47
    buffer_load_dwordx4 v[120:123], v2, s[24:27], s44 offen offset:2048 sc1
    v_pk_mul_f32 v[48:49], v[48:49], v[80:81] op_sel:[0,0] op_sel_hi:[1,1]
    v_pk_mul_f32 v[50:51], v[50:51], v[82:83] op_sel:[0,0] op_sel_hi:[1,1]
    v_pk_mul_f32 v[52:53], v[52:53], v[84:85] op_sel:[0,0] op_sel_hi:[1,1]
    v_pk_mul_f32 v[54:55], v[54:55], v[86:87] op_sel:[0,0] op_sel_hi:[1,1]
    buffer_load_dwordx4 v[104:107], v14, s[24:27], s45 offen sc1
    v_cvt_pk_bf16_f32 v80, v48, v49
    v_cvt_pk_bf16_f32 v81, v50, v51
    v_cvt_pk_bf16_f32 v82, v52, v53
    v_cvt_pk_bf16_f32 v83, v54, v55
    buffer_load_dwordx4 v[124:127], v2, s[24:27], s44 offen offset:3072 sc1
    v_pk_mul_f32 v[56:57], v[56:57], v[88:89] op_sel:[0,0] op_sel_hi:[1,1]
    v_pk_mul_f32 v[58:59], v[58:59], v[90:91] op_sel:[0,0] op_sel_hi:[1,1]
    v_pk_mul_f32 v[60:61], v[60:61], v[92:93] op_sel:[0,0] op_sel_hi:[1,1]
    v_pk_mul_f32 v[62:63], v[62:63], v[94:95] op_sel:[0,0] op_sel_hi:[1,1]
    buffer_load_dwordx4 v[108:111], v15, s[24:27], s45 offen sc1
    v_cvt_pk_bf16_f32 v88, v56, v57
    v_cvt_pk_bf16_f32 v89, v58, v59
    v_cvt_pk_bf16_f32 v90, v60, v61
    v_cvt_pk_bf16_f32 v91, v62, v63
    buffer_load_dwordx4 v[128:131], v4, s[24:27], s44 offen offset:0 sc1
    s_add_u32 s44, s44, 20480
    s_add_u32 s45, s45, 4096
    buffer_store_dwordx4 v[64:67], v9, s[24:27], s58 offen offset:0 sc1
    buffer_store_dwordx4 v[72:75], v9, s[24:27], s58 offen offset:1024 sc1
    buffer_store_dwordx4 v[80:83], v9, s[24:27], s57 offen offset:0 sc1
    buffer_store_dwordx4 v[88:91], v9, s[24:27], s57 offen offset:1024 sc1
    buffer_load_dwordx4 v[148:151], v2, s[24:27], s44 offen offset:0 sc1
    v_add_u32 v3, 61440, v2
    v_and_b32 v8, 15, v1
    buffer_load_dwordx4 v[132:135], v12, s[24:27], s45 offen sc1
    v_mul_u32_u24 v5, 1280, v8
    v_lshrrev_b32 v8, 4, v1
    buffer_load_dwordx4 v[152:155], v2, s[24:27], s44 offen offset:1024 sc1
    v_mad_u32_u24 v5, v8, 40, v5
    v_and_b32 v0, 31, v1
    buffer_load_dwordx4 v[136:139], v13, s[24:27], s45 offen sc1
    v_lshlrev_b32 v0, 6, v0
    v_min_u32 v6, 11, v1
    buffer_load_dwordx4 v[156:159], v2, s[24:27], s44 offen offset:2048 sc1
    s_lshr_b32 s54, s41, 1
    s_lshl_b32 s54, s54, 10
    buffer_load_dwordx4 v[140:143], v14, s[24:27], s45 offen sc1
    s_add_u32 s54, s54, 20766720
    v_lshl_add_u32 v6, v6, 6, s54
    buffer_load_dwordx4 v[160:163], v2, s[24:27], s44 offen offset:3072 sc1
    s_lshr_b32 s54, s2, 7
    s_lshl_b32 s54, s54, 12
    buffer_load_dwordx4 v[144:147], v15, s[24:27], s45 offen sc1
    s_add_u32 s54, s54, 20758528
    s_mov_b32 exec_lo, 0
    v_lshl_add_u32 v6, v1, 6, s54
    s_mov_b32 exec_lo, -1
    buffer_load_dwordx4 v[164:167], v4, s[24:27], s44 offen offset:0 sc1
    s_add_u32 s44, s44, 20480
    s_add_u32 s45, s45, 4096
    s_waitcnt vmcnt(13)
g1_g1end:
    s_setprio 0
    v_mfma_f32_16x16x32_bf16 v[16:19], v[112:115], v[96:99], 0
    buffer_load_dwordx4 v[184:187], v2, s[24:27], s44 offen offset:0 sc1
    v_mfma_f32_16x16x32_bf16 v[20:23], v[116:119], v[96:99], 0
    v_mfma_f32_16x16x32_bf16 v[24:27], v[120:123], v[96:99], 0
    v_mfma_f32_16x16x32_bf16 v[28:31], v[124:127], v[96:99], 0
    buffer_load_dwordx4 v[168:171], v12, s[24:27], s45 offen sc1
    v_mfma_f32_16x16x32_bf16 v[32:35], v[128:131], v[96:99], 0
    v_mfma_f32_16x16x32_bf16 v[52:55], v[128:131], v[100:103], 0
    buffer_load_dwordx4 v[188:191], v2, s[24:27], s44 offen offset:1024 sc1
    v_mfma_f32_16x16x32_bf16 v[48:51], v[124:127], v[100:103], 0
    v_mfma_f32_16x16x32_bf16 v[44:47], v[120:123], v[100:103], 0
    buffer_load_dwordx4 v[172:175], v13, s[24:27], s45 offen sc1
    v_mfma_f32_16x16x32_bf16 v[40:43], v[116:119], v[100:103], 0
    v_mfma_f32_16x16x32_bf16 v[36:39], v[112:115], v[100:103], 0
    buffer_load_dwordx4 v[192:195], v2, s[24:27], s44 offen offset:2048 sc1
    v_mfma_f32_16x16x32_bf16 v[56:59], v[112:115], v[104:107], 0
    v_mfma_f32_16x16x32_bf16 v[60:63], v[116:119], v[104:107], 0
    v_mfma_f32_16x16x32_bf16 v[64:67], v[120:123], v[104:107], 0
    buffer_load_dwordx4 v[176:179], v14, s[24:27], s45 offen sc1
    v_mfma_f32_16x16x32_bf16 v[68:71], v[124:127], v[104:107], 0
    v_mfma_f32_16x16x32_bf16 v[72:75], v[128:131], v[104:107], 0
    buffer_load_dwordx4 v[196:199], v2, s[24:27], s44 offen offset:3072 sc1
    v_mfma_f32_16x16x32_bf16 v[92:95], v[128:131], v[108:111], 0
    v_mfma_f32_16x16x32_bf16 v[88:91], v[124:127], v[108:111], 0
    buffer_load_dwordx4 v[180:183], v15, s[24:27], s45 offen sc1
    v_mfma_f32_16x16x32_bf16 v[84:87], v[120:123], v[108:111], 0
    v_mfma_f32_16x16x32_bf16 v[80:83], v[116:119], v[108:111], 0
    buffer_load_dwordx4 v[200:203], v4, s[24:27], s44 offen offset:0 sc1
    s_add_u32 s44, s44, 20480
    s_add_u32 s45, s45, 4096
    v_mfma_f32_16x16x32_bf16 v[76:79], v[112:115], v[108:111], 0
    s_waitcnt vmcnt(9)
    s_barrier
    s_cmp_eq_u32 s49, 0
    s_cbranch_scc1 g2_pb
g2_pbr:
    v_mfma_f32_16x16x32_bf16 v[76:79], v[148:151], v[144:147], v[76:79]
    buffer_load_dwordx4 v[112:115], v2, s[24:27], s44 offen offset:0 sc1
    v_mfma_f32_16x16x32_bf16 v[80:83], v[152:155], v[144:147], v[80:83]
    v_mfma_f32_16x16x32_bf16 v[84:87], v[156:159], v[144:147], v[84:87]
    buffer_load_dwordx4 v[96:99], v12, s[24:27], s45 offen sc1
    v_mfma_f32_16x16x32_bf16 v[88:91], v[160:163], v[144:147], v[88:91]
    v_mfma_f32_16x16x32_bf16 v[92:95], v[164:167], v[144:147], v[92:95]
    buffer_load_dwordx4 v[116:119], v2, s[24:27], s44 offen offset:1024 sc1
    v_mfma_f32_16x16x32_bf16 v[72:75], v[164:167], v[140:143], v[72:75]
    v_mfma_f32_16x16x32_bf16 v[68:71], v[160:163], v[140:143], v[68:71]
    buffer_load_dwordx4 v[100:103], v13, s[24:27], s45 offen sc1
    v_mfma_f32_16x16x32_bf16 v[64:67], v[156:159], v[140:143], v[64:67]
    v_mfma_f32_16x16x32_bf16 v[60:63], v[152:155], v[140:143], v[60:63]
    buffer_load_dwordx4 v[120:123], v2, s[24:27], s44 offen offset:2048 sc1
    v_mfma_f32_16x16x32_bf16 v[56:59], v[148:151], v[140:143], v[56:59]
    v_mfma_f32_16x16x32_bf16 v[36:39], v[148:151], v[136:139], v[36:39]
    buffer_load_dwordx4 v[104:107], v14, s[24:27], s45 offen sc1
    v_mfma_f32_16x16x32_bf16 v[40:43], v[152:155], v[136:139], v[40:43]
    v_mfma_f32_16x16x32_bf16 v[44:47], v[156:159], v[136:139], v[44:47]
    buffer_load_dwordx4 v[124:127], v2, s[24:27], s44 offen offset:3072 sc1
    v_mfma_f32_16x16x32_bf16 v[48:51], v[160:163], v[136:139], v[48:51]
    v_mfma_f32_16x16x32_bf16 v[52:55], v[164:167], v[136:139], v[52:55]
    buffer_load_dwordx4 v[108:111], v15, s[24:27], s45 offen sc1
    v_mfma_f32_16x16x32_bf16 v[32:35], v[164:167], v[132:135], v[32:35]
    v_mfma_f32_16x16x32_bf16 v[28:31], v[160:163], v[132:135], v[28:31]
    buffer_load_dwordx4 v[128:131], v4, s[24:27], s44 offen offset:0 sc1
    s_add_u32 s44, s44, 20480
    s_add_u32 s45, s45, 4096
    v_mfma_f32_16x16x32_bf16 v[24:27], v[156:159], v[132:135], v[24:27]
    v_mfma_f32_16x16x32_bf16 v[20:23], v[152:155], v[132:135], v[20:23]
    s_mov_b32 s48, 0
    s_mov_b32 s28, s4
    s_mov_b32 s29, s5
    s_mov_b32 s30, 2621440
    s_mov_b32 s31, 0x00020000
    s_mov_b32 s32, s18
    s_mov_b32 s33, s19
    s_mov_b32 s34, 2621440
    s_mov_b32 s35, 0x00020000
    v_mfma_f32_16x16x32_bf16 v[16:19], v[148:151], v[132:135], v[16:19]
    s_waitcnt vmcnt(9)
    v_mfma_f32_16x16x32_bf16 v[16:19], v[184:187], v[168:171], v[16:19]
    buffer_load_dwordx4 v[148:151], v2, s[24:27], s44 offen offset:0 sc1
    v_mfma_f32_16x16x32_bf16 v[20:23], v[188:191], v[168:171], v[20:23]
    v_mfma_f32_16x16x32_bf16 v[24:27], v[192:195], v[168:171], v[24:27]
    buffer_load_dwordx4 v[132:135], v12, s[24:27], s45 offen sc1
    v_mfma_f32_16x16x32_bf16 v[28:31], v[196:199], v[168:171], v[28:31]
    v_mfma_f32_16x16x32_bf16 v[32:35], v[200:203], v[168:171], v[32:35]
    buffer_load_dwordx4 v[152:155], v2, s[24:27], s44 offen offset:1024 sc1
    v_mfma_f32_16x16x32_bf16 v[52:55], v[200:203], v[172:175], v[52:55]
    v_mfma_f32_16x16x32_bf16 v[48:51], v[196:199], v[172:175], v[48:51]
    buffer_load_dwordx4 v[136:139], v13, s[24:27], s45 offen sc1
    v_mfma_f32_16x16x32_bf16 v[44:47], v[192:195], v[172:175], v[44:47]
    v_mfma_f32_16x16x32_bf16 v[40:43], v[188:191], v[172:175], v[40:43]
    buffer_load_dwordx4 v[156:159], v2, s[24:27], s44 offen offset:2048 sc1
    v_mfma_f32_16x16x32_bf16 v[36:39], v[184:187], v[172:175], v[36:39]
    v_mfma_f32_16x16x32_bf16 v[56:59], v[184:187], v[176:179], v[56:59]
    buffer_load_dwordx4 v[140:143], v14, s[24:27], s45 offen sc1
    v_mfma_f32_16x16x32_bf16 v[60:63], v[188:191], v[176:179], v[60:63]
    v_mfma_f32_16x16x32_bf16 v[64:67], v[192:195], v[176:179], v[64:67]
    buffer_load_dwordx4 v[160:163], v2, s[24:27], s44 offen offset:3072 sc1
    v_mfma_f32_16x16x32_bf16 v[68:71], v[196:199], v[176:179], v[68:71]
    v_mfma_f32_16x16x32_bf16 v[72:75], v[200:203], v[176:179], v[72:75]
    buffer_load_dwordx4 v[144:147], v15, s[24:27], s45 offen sc1
    v_mfma_f32_16x16x32_bf16 v[92:95], v[200:203], v[180:183], v[92:95]
    v_mfma_f32_16x16x32_bf16 v[88:91], v[196:199], v[180:183], v[88:91]
    buffer_load_dwordx4 v[164:167], v4, s[24:27], s44 offen offset:0 sc1
    s_add_u32 s44, s44, 20480
    s_add_u32 s45, s45, 4096
    v_mfma_f32_16x16x32_bf16 v[84:87], v[192:195], v[180:183], v[84:87]
    v_mfma_f32_16x16x32_bf16 v[80:83], v[188:191], v[180:183], v[80:83]
    s_lshl_b32 s46, s41, 14
    s_and_b32 s54, s40, 1
    s_lshl_b32 s54, s54, 8
    s_add_u32 s46, s46, s54
    s_lshr_b32 s54, s40, 1
    s_lshl_b32 s54, s54, 3
    s_add_u32 s46, s46, s54
    s_lshl_b32 s47, s41, 11
    s_add_u32 s47, s47, 20627456
    s_lshl2_add_u32 s41, s41, s40
    s_lshl_b32 s54, s41, 14
    s_add_u32 s58, s54, 14942208
    s_add_u32 s59, s54, 14946304
    s_add_u32 s60, s54, 14950400
    s_add_u32 s61, s54, 14954496
    s_add_u32 s96, s46, 17039360
    s_add_u32 s97, s46, 17043456
    s_add_u32 s98, s46, 17047552
    s_add_u32 s99, s46, 17051648
    s_mul_i32 s57, s41, 20480
    s_mul_i32 s55, s42, 160
    s_add_u32 s57, s57, s55
    v_mfma_f32_16x16x32_bf16 v[76:79], v[184:187], v[180:183], v[76:79]
    s_waitcnt vmcnt(9)
    v_mfma_f32_16x16x32_bf16 v[76:79], v[112:115], v[108:111], v[76:79]
    buffer_load_dwordx4 v[184:187], v2, s[24:27], s44 offen offset:0 sc1
    v_mfma_f32_16x16x32_bf16 v[80:83], v[116:119], v[108:111], v[80:83]
    v_mfma_f32_16x16x32_bf16 v[84:87], v[120:123], v[108:111], v[84:87]
    v_mfma_f32_16x16x32_bf16 v[88:91], v[124:127], v[108:111], v[88:91]
    buffer_load_dwordx4 v[168:171], v12, s[24:27], s45 offen sc1
    v_mfma_f32_16x16x32_bf16 v[92:95], v[128:131], v[108:111], v[92:95]
    v_mfma_f32_16x16x32_bf16 v[72:75], v[128:131], v[104:107], v[72:75]
    buffer_load_dwordx4 v[188:191], v2, s[24:27], s44 offen offset:1024 sc1
    v_mfma_f32_16x16x32_bf16 v[68:71], v[124:127], v[104:107], v[68:71]
    v_mfma_f32_16x16x32_bf16 v[64:67], v[120:123], v[104:107], v[64:67]
    buffer_load_dwordx4 v[172:175], v13, s[24:27], s45 offen sc1
    v_mfma_f32_16x16x32_bf16 v[60:63], v[116:119], v[104:107], v[60:63]
    v_mfma_f32_16x16x32_bf16 v[56:59], v[112:115], v[104:107], v[56:59]
    buffer_load_dwordx4 v[192:195], v2, s[24:27], s44 offen offset:2048 sc1
    v_mfma_f32_16x16x32_bf16 v[36:39], v[112:115], v[100:103], v[36:39]
    v_mfma_f32_16x16x32_bf16 v[40:43], v[116:119], v[100:103], v[40:43]
    v_mfma_f32_16x16x32_bf16 v[44:47], v[120:123], v[100:103], v[44:47]
    buffer_load_dwordx4 v[176:179], v14, s[24:27], s45 offen sc1
    v_mfma_f32_16x16x32_bf16 v[48:51], v[124:127], v[100:103], v[48:51]
    v_mfma_f32_16x16x32_bf16 v[52:55], v[128:131], v[100:103], v[52:55]
    buffer_load_dwordx4 v[196:199], v2, s[24:27], s44 offen offset:3072 sc1
    v_mfma_f32_16x16x32_bf16 v[32:35], v[128:131], v[96:99], v[32:35]
    v_mfma_f32_16x16x32_bf16 v[28:31], v[124:127], v[96:99], v[28:31]
    buffer_load_dwordx4 v[180:183], v15, s[24:27], s45 offen sc1
    v_mfma_f32_16x16x32_bf16 v[24:27], v[120:123], v[96:99], v[24:27]
    v_mfma_f32_16x16x32_bf16 v[20:23], v[116:119], v[96:99], v[20:23]
    buffer_load_dwordx4 v[200:203], v4, s[24:27], s44 offen offset:0 sc1
    s_add_u32 s44, s44, 20480
    s_add_u32 s45, s45, 4096
    v_mfma_f32_16x16x32_bf16 v[16:19], v[112:115], v[96:99], v[16:19]
    s_waitcnt vmcnt(9)
    v_mfma_f32_16x16x32_bf16 v[16:19], v[148:151], v[132:135], v[16:19]
    buffer_load_dwordx4 v[112:115], v2, s[24:27], s44 offen offset:0 sc1
    v_mfma_f32_16x16x32_bf16 v[20:23], v[152:155], v[132:135], v[20:23]
    v_mfma_f32_16x16x32_bf16 v[24:27], v[156:159], v[132:135], v[24:27]
    v_mfma_f32_16x16x32_bf16 v[28:31], v[160:163], v[132:135], v[28:31]
    buffer_load_dwordx4 v[96:99], v12, s[24:27], s45 offen sc1
    v_mfma_f32_16x16x32_bf16 v[32:35], v[164:167], v[132:135], v[32:35]
    v_mfma_f32_16x16x32_bf16 v[52:55], v[164:167], v[136:139], v[52:55]
    buffer_load_dwordx4 v[116:119], v2, s[24:27], s44 offen offset:1024 sc1
    v_mfma_f32_16x16x32_bf16 v[48:51], v[160:163], v[136:139], v[48:51]
    v_mfma_f32_16x16x32_bf16 v[44:47], v[156:159], v[136:139], v[44:47]
    buffer_load_dwordx4 v[100:103], v13, s[24:27], s45 offen sc1
    v_mfma_f32_16x16x32_bf16 v[40:43], v[152:155], v[136:139], v[40:43]
    v_mfma_f32_16x16x32_bf16 v[36:39], v[148:151], v[136:139], v[36:39]
    buffer_load_dwordx4 v[120:123], v2, s[24:27], s44 offen offset:2048 sc1
    v_mfma_f32_16x16x32_bf16 v[56:59], v[148:151], v[140:143], v[56:59]
    v_mfma_f32_16x16x32_bf16 v[60:63], v[152:155], v[140:143], v[60:63]
    v_mfma_f32_16x16x32_bf16 v[64:67], v[156:159], v[140:143], v[64:67]
    buffer_load_dwordx4 v[104:107], v14, s[24:27], s45 offen sc1
    v_mfma_f32_16x16x32_bf16 v[68:71], v[160:163], v[140:143], v[68:71]
    v_mfma_f32_16x16x32_bf16 v[72:75], v[164:167], v[140:143], v[72:75]
    buffer_load_dwordx4 v[124:127], v2, s[24:27], s44 offen offset:3072 sc1
    v_mfma_f32_16x16x32_bf16 v[92:95], v[164:167], v[144:147], v[92:95]
    v_mfma_f32_16x16x32_bf16 v[88:91], v[160:163], v[144:147], v[88:91]
    buffer_load_dwordx4 v[108:111], v15, s[24:27], s45 offen sc1
    v_mfma_f32_16x16x32_bf16 v[84:87], v[156:159], v[144:147], v[84:87]
    v_mfma_f32_16x16x32_bf16 v[80:83], v[152:155], v[144:147], v[80:83]
    buffer_load_dwordx4 v[128:131], v4, s[24:27], s44 offen offset:0 sc1
    s_add_u32 s44, s44, 20480
    s_add_u32 s45, s45, 4096
    v_mfma_f32_16x16x32_bf16 v[76:79], v[148:151], v[144:147], v[76:79]
    s_waitcnt vmcnt(9)
    v_mfma_f32_16x16x32_bf16 v[76:79], v[184:187], v[180:183], v[76:79]
    s_cmp_eq_u32 s40, 0
    s_cbranch_scc1 g2_q2
g2_q2r:
    v_mfma_f32_16x16x32_bf16 v[80:83], v[188:191], v[180:183], v[80:83]
    v_mfma_f32_16x16x32_bf16 v[84:87], v[192:195], v[180:183], v[84:87]
    buffer_load_dwordx4 v[148:151], v2, s[24:27], s44 offen offset:0 sc1
    v_mfma_f32_16x16x32_bf16 v[88:91], v[196:199], v[180:183], v[88:91]
    v_mfma_f32_16x16x32_bf16 v[92:95], v[200:203], v[180:183], v[92:95]
    buffer_load_dwordx4 v[132:135], v12, s[24:27], s45 offen sc1
    v_mfma_f32_16x16x32_bf16 v[72:75], v[200:203], v[176:179], v[72:75]
    v_mfma_f32_16x16x32_bf16 v[68:71], v[196:199], v[176:179], v[68:71]
    buffer_load_dwordx4 v[152:155], v2, s[24:27], s44 offen offset:1024 sc1
    v_mfma_f32_16x16x32_bf16 v[64:67], v[192:195], v[176:179], v[64:67]
    v_mfma_f32_16x16x32_bf16 v[60:63], v[188:191], v[176:179], v[60:63]
    buffer_load_dwordx4 v[136:139], v13, s[24:27], s45 offen sc1
    v_mfma_f32_16x16x32_bf16 v[56:59], v[184:187], v[176:179], v[56:59]
    v_mfma_f32_16x16x32_bf16 v[36:39], v[184:187], v[172:175], v[36:39]
    buffer_load_dwordx4 v[156:159], v2, s[24:27], s44 offen offset:2048 sc1
    v_mfma_f32_16x16x32_bf16 v[40:43], v[188:191], v[172:175], v[40:43]
    v_mfma_f32_16x16x32_bf16 v[44:47], v[192:195], v[172:175], v[44:47]
    buffer_load_dwordx4 v[140:143], v14, s[24:27], s45 offen sc1
    v_mfma_f32_16x16x32_bf16 v[48:51], v[196:199], v[172:175], v[48:51]
    v_mfma_f32_16x16x32_bf16 v[52:55], v[200:203], v[172:175], v[52:55]
    buffer_load_dwordx4 v[160:163], v2, s[24:27], s44 offen offset:3072 sc1
    v_mfma_f32_16x16x32_bf16 v[32:35], v[200:203], v[168:171], v[32:35]
    v_mfma_f32_16x16x32_bf16 v[28:31], v[196:199], v[168:171], v[28:31]
    buffer_load_dwordx4 v[144:147], v15, s[24:27], s45 offen sc1
    v_mfma_f32_16x16x32_bf16 v[24:27], v[192:195], v[168:171], v[24:27]
    v_mfma_f32_16x16x32_bf16 v[20:23], v[188:191], v[168:171], v[20:23]
    buffer_load_dwordx4 v[164:167], v4, s[24:27], s44 offen offset:0 sc1
    s_add_u32 s44, s44, 20480
    s_add_u32 s45, s45, 4096
    v_mfma_f32_16x16x32_bf16 v[16:19], v[184:187], v[168:171], v[16:19]
    s_waitcnt vmcnt(9)
    s_cmp_eq_u32 s40, 0
    s_cbranch_scc1 g2_c2
g2_c2r:
    s_barrier
    v_mfma_f32_16x16x32_bf16 v[16:19], v[112:115], v[96:99], v[16:19]
    buffer_load_dwordx4 v[184:187], v2, s[24:27], s44 offen offset:0 sc1
    v_mfma_f32_16x16x32_bf16 v[20:23], v[116:119], v[96:99], v[20:23]
    v_mfma_f32_16x16x32_bf16 v[24:27], v[120:123], v[96:99], v[24:27]
    v_mfma_f32_16x16x32_bf16 v[28:31], v[124:127], v[96:99], v[28:31]
    buffer_load_dwordx4 v[168:171], v12, s[24:27], s45 offen sc1
    v_mfma_f32_16x16x32_bf16 v[32:35], v[128:131], v[96:99], v[32:35]
    v_mfma_f32_16x16x32_bf16 v[52:55], v[128:131], v[100:103], v[52:55]
    buffer_load_dwordx4 v[188:191], v2, s[24:27], s44 offen offset:1024 sc1
    v_mfma_f32_16x16x32_bf16 v[48:51], v[124:127], v[100:103], v[48:51]
    v_mfma_f32_16x16x32_bf16 v[44:47], v[120:123], v[100:103], v[44:47]
    buffer_load_dwordx4 v[172:175], v13, s[24:27], s45 offen sc1
    v_mfma_f32_16x16x32_bf16 v[40:43], v[116:119], v[100:103], v[40:43]
    v_mfma_f32_16x16x32_bf16 v[36:39], v[112:115], v[100:103], v[36:39]
    buffer_load_dwordx4 v[192:195], v2, s[24:27], s44 offen offset:2048 sc1
    v_mfma_f32_16x16x32_bf16 v[56:59], v[112:115], v[104:107], v[56:59]
    v_mfma_f32_16x16x32_bf16 v[60:63], v[116:119], v[104:107], v[60:63]
    v_mfma_f32_16x16x32_bf16 v[64:67], v[120:123], v[104:107], v[64:67]
    buffer_load_dwordx4 v[176:179], v14, s[24:27], s45 offen sc1
    v_mfma_f32_16x16x32_bf16 v[68:71], v[124:127], v[104:107], v[68:71]
    v_mfma_f32_16x16x32_bf16 v[72:75], v[128:131], v[104:107], v[72:75]
    buffer_load_dwordx4 v[196:199], v2, s[24:27], s44 offen offset:3072 sc1
    v_mfma_f32_16x16x32_bf16 v[92:95], v[128:131], v[108:111], v[92:95]
    v_mfma_f32_16x16x32_bf16 v[88:91], v[124:127], v[108:111], v[88:91]
    buffer_load_dwordx4 v[180:183], v15, s[24:27], s45 offen sc1
    v_mfma_f32_16x16x32_bf16 v[84:87], v[120:123], v[108:111], v[84:87]
    v_mfma_f32_16x16x32_bf16 v[80:83], v[116:119], v[108:111], v[80:83]
    buffer_load_dwordx4 v[200:203], v4, s[24:27], s44 offen offset:0 sc1
    s_add_u32 s44, s44, 20480
    s_add_u32 s45, s45, 4096
    v_mfma_f32_16x16x32_bf16 v[76:79], v[112:115], v[108:111], v[76:79]
    s_waitcnt vmcnt(9)
    v_mfma_f32_16x16x32_bf16 v[76:79], v[148:151], v[144:147], v[76:79]
    buffer_load_dwordx4 v[112:115], v2, s[24:27], s44 offen offset:0 sc1
    v_mfma_f32_16x16x32_bf16 v[80:83], v[152:155], v[144:147], v[80:83]
    v_mfma_f32_16x16x32_bf16 v[84:87], v[156:159], v[144:147], v[84:87]
    v_mfma_f32_16x16x32_bf16 v[88:91], v[160:163], v[144:147], v[88:91]
    buffer_load_dwordx4 v[96:99], v12, s[24:27], s45 offen sc1
    v_mfma_f32_16x16x32_bf16 v[92:95], v[164:167], v[144:147], v[92:95]
    v_mfma_f32_16x16x32_bf16 v[72:75], v[164:167], v[140:143], v[72:75]
    buffer_load_dwordx4 v[116:119], v2, s[24:27], s44 offen offset:1024 sc1
    v_mfma_f32_16x16x32_bf16 v[68:71], v[160:163], v[140:143], v[68:71]
    v_mfma_f32_16x16x32_bf16 v[64:67], v[156:159], v[140:143], v[64:67]
    buffer_load_dwordx4 v[100:103], v13, s[24:27], s45 offen sc1
    v_mfma_f32_16x16x32_bf16 v[60:63], v[152:155], v[140:143], v[60:63]
    v_mfma_f32_16x16x32_bf16 v[56:59], v[148:151], v[140:143], v[56:59]
    buffer_load_dwordx4 v[120:123], v2, s[24:27], s44 offen offset:2048 sc1
    v_mfma_f32_16x16x32_bf16 v[36:39], v[148:151], v[136:139], v[36:39]
    v_mfma_f32_16x16x32_bf16 v[40:43], v[152:155], v[136:139], v[40:43]
    v_mfma_f32_16x16x32_bf16 v[44:47], v[156:159], v[136:139], v[44:47]
    buffer_load_dwordx4 v[104:107], v14, s[24:27], s45 offen sc1
    v_mfma_f32_16x16x32_bf16 v[48:51], v[160:163], v[136:139], v[48:51]
    v_mfma_f32_16x16x32_bf16 v[52:55], v[164:167], v[136:139], v[52:55]
    buffer_load_dwordx4 v[124:127], v2, s[24:27], s44 offen offset:3072 sc1
    v_mfma_f32_16x16x32_bf16 v[32:35], v[164:167], v[132:135], v[32:35]
    v_mfma_f32_16x16x32_bf16 v[28:31], v[160:163], v[132:135], v[28:31]
    buffer_load_dwordx4 v[108:111], v15, s[24:27], s45 offen sc1
    v_mfma_f32_16x16x32_bf16 v[24:27], v[156:159], v[132:135], v[24:27]
    v_mfma_f32_16x16x32_bf16 v[20:23], v[152:155], v[132:135], v[20:23]
    buffer_load_dwordx4 v[128:131], v4, s[24:27], s44 offen offset:0 sc1
    s_add_u32 s44, s44, 20480
    s_add_u32 s45, s45, 4096
    v_mfma_f32_16x16x32_bf16 v[16:19], v[148:151], v[132:135], v[16:19]
    s_waitcnt vmcnt(9)
    v_mfma_f32_16x16x32_bf16 v[16:19], v[184:187], v[168:171], v[16:19]
    buffer_load_dwordx4 v[148:151], v2, s[24:27], s44 offen offset:0 sc1
    v_mfma_f32_16x16x32_bf16 v[20:23], v[188:191], v[168:171], v[20:23]
    v_mfma_f32_16x16x32_bf16 v[24:27], v[192:195], v[168:171], v[24:27]
    buffer_load_dwordx4 v[132:135], v12, s[24:27], s45 offen sc1
    v_mfma_f32_16x16x32_bf16 v[28:31], v[196:199], v[168:171], v[28:31]
    buffer_load_dwordx4 v[152:155], v2, s[24:27], s44 offen offset:1024 sc1
    v_mfma_f32_16x16x32_bf16 v[32:35], v[200:203], v[168:171], v[32:35]
    v_mfma_f32_16x16x32_bf16 v[52:55], v[200:203], v[172:175], v[52:55]
    buffer_load_dwordx4 v[136:139], v13, s[24:27], s45 offen sc1
    v_mfma_f32_16x16x32_bf16 v[48:51], v[196:199], v[172:175], v[48:51]
    buffer_load_dwordx4 v[156:159], v2, s[24:27], s44 offen offset:2048 sc1
    v_mfma_f32_16x16x32_bf16 v[44:47], v[192:195], v[172:175], v[44:47]
    v_mfma_f32_16x16x32_bf16 v[40:43], v[188:191], v[172:175], v[40:43]
    buffer_load_dwordx4 v[140:143], v14, s[24:27], s45 offen sc1
    v_mfma_f32_16x16x32_bf16 v[36:39], v[184:187], v[172:175], v[36:39]
    buffer_load_dwordx4 v[160:163], v2, s[24:27], s44 offen offset:3072 sc1
    v_mfma_f32_16x16x32_bf16 v[56:59], v[184:187], v[176:179], v[56:59]
    buffer_load_dwordx4 v[144:147], v15, s[24:27], s45 offen sc1
    v_mfma_f32_16x16x32_bf16 v[60:63], v[188:191], v[176:179], v[60:63]
    v_mfma_f32_16x16x32_bf16 v[64:67], v[192:195], v[176:179], v[64:67]
    buffer_load_dwordx4 v[164:167], v4, s[24:27], s44 offen offset:0 sc1
    s_add_u32 s44, s44, 20480
    s_add_u32 s45, s45, 4096
    v_mfma_f32_16x16x32_bf16 v[68:71], v[196:199], v[176:179], v[68:71]
    s_add_u32 m0, s43, 0
    s_nop 0
    buffer_load_dwordx4 v2, s[24:27], s50 offen offset:0 sc1 lds
    v_mfma_f32_16x16x32_bf16 v[72:75], v[200:203], v[176:179], v[72:75]
    v_mfma_f32_16x16x32_bf16 v[92:95], v[200:203], v[180:183], v[92:95]
    buffer_load_dwordx4 v2, s[24:27], s50 offen offset:1024 sc1 lds
    v_mfma_f32_16x16x32_bf16 v[88:91], v[196:199], v[180:183], v[88:91]
    buffer_load_dwordx4 v2, s[24:27], s50 offen offset:2048 sc1 lds
    v_mfma_f32_16x16x32_bf16 v[84:87], v[192:195], v[180:183], v[84:87]
    v_mfma_f32_16x16x32_bf16 v[80:83], v[188:191], v[180:183], v[80:83]
    buffer_load_dwordx4 v2, s[24:27], s50 offen offset:3072 sc1 lds
    v_mfma_f32_16x16x32_bf16 v[76:79], v[184:187], v[180:183], v[76:79]
    s_cmp_eq_u32 s40, 0
    s_cbranch_scc1 g2_tc
g2_tcr:
    s_waitcnt vmcnt(13)
    v_mfma_f32_16x16x32_bf16 v[76:79], v[112:115], v[108:111], v[76:79]
    buffer_load_dwordx4 v[184:187], v2, s[24:27], s44 offen offset:0 sc1
    v_mfma_f32_16x16x32_bf16 v[80:83], v[116:119], v[108:111], v[80:83]
    v_mfma_f32_16x16x32_bf16 v[84:87], v[120:123], v[108:111], v[84:87]
    buffer_load_dwordx4 v[168:171], v12, s[24:27], s45 offen sc1
    v_mfma_f32_16x16x32_bf16 v[88:91], v[124:127], v[108:111], v[88:91]
    v_mfma_f32_16x16x32_bf16 v[92:95], v[128:131], v[108:111], v[92:95]
    buffer_load_dwordx4 v[188:191], v2, s[24:27], s44 offen offset:1024 sc1
    v_mfma_f32_16x16x32_bf16 v[72:75], v[128:131], v[104:107], v[72:75]
    buffer_load_dwordx4 v[172:175], v13, s[24:27], s45 offen sc1
    v_mfma_f32_16x16x32_bf16 v[68:71], v[124:127], v[104:107], v[68:71]
    v_mfma_f32_16x16x32_bf16 v[64:67], v[120:123], v[104:107], v[64:67]
    buffer_load_dwordx4 v[192:195], v2, s[24:27], s44 offen offset:2048 sc1
    v_mfma_f32_16x16x32_bf16 v[60:63], v[116:119], v[104:107], v[60:63]
    buffer_load_dwordx4 v[176:179], v14, s[24:27], s45 offen sc1
    v_mfma_f32_16x16x32_bf16 v[56:59], v[112:115], v[104:107], v[56:59]
    v_mfma_f32_16x16x32_bf16 v[36:39], v[112:115], v[100:103], v[36:39]
    buffer_load_dwordx4 v[196:199], v2, s[24:27], s44 offen offset:3072 sc1
    v_mfma_f32_16x16x32_bf16 v[40:43], v[116:119], v[100:103], v[40:43]
    buffer_load_dwordx4 v[180:183], v15, s[24:27], s45 offen sc1
    v_mfma_f32_16x16x32_bf16 v[44:47], v[120:123], v[100:103], v[44:47]
    v_mfma_f32_16x16x32_bf16 v[48:51], v[124:127], v[100:103], v[48:51]
    buffer_load_dwordx4 v[200:203], v4, s[24:27], s44 offen offset:0 sc1
    s_add_u32 s44, s44, 20480
    s_add_u32 s45, s45, 4096
    v_mfma_f32_16x16x32_bf16 v[52:55], v[128:131], v[100:103], v[52:55]
    s_add_u32 m0, s43, 4096
    s_nop 0
    buffer_load_dwordx4 v4, s[24:27], s50 offen sc1 lds
    s_add_u32 s50, s50, 20480
    v_mfma_f32_16x16x32_bf16 v[32:35], v[128:131], v[96:99], v[32:35]
    v_mfma_f32_16x16x32_bf16 v[28:31], v[124:127], v[96:99], v[28:31]
    s_add_u32 m0, s43, 20480
    s_nop 0
    buffer_load_dwordx4 v2, s[24:27], s50 offen offset:0 sc1 lds
    v_mfma_f32_16x16x32_bf16 v[24:27], v[120:123], v[96:99], v[24:27]
    buffer_load_dwordx4 v2, s[24:27], s50 offen offset:1024 sc1 lds
    v_mfma_f32_16x16x32_bf16 v[20:23], v[116:119], v[96:99], v[20:23]
    v_mfma_f32_16x16x32_bf16 v[16:19], v[112:115], v[96:99], v[16:19]
    buffer_load_dwordx4 v2, s[24:27], s50 offen offset:2048 sc1 lds
    s_waitcnt vmcnt(17)
    v_mfma_f32_16x16x32_bf16 v[16:19], v[148:151], v[132:135], v[16:19]
    buffer_load_dwordx4 v[112:115], v2, s[24:27], s44 offen offset:0 sc1
    v_mfma_f32_16x16x32_bf16 v[20:23], v[152:155], v[132:135], v[20:23]
    v_mfma_f32_16x16x32_bf16 v[24:27], v[156:159], v[132:135], v[24:27]
    buffer_load_dwordx4 v[96:99], v12, s[24:27], s45 offen sc1
    v_mfma_f32_16x16x32_bf16 v[28:31], v[160:163], v[132:135], v[28:31]
    v_mfma_f32_16x16x32_bf16 v[32:35], v[164:167], v[132:135], v[32:35]
    buffer_load_dwordx4 v[116:119], v2, s[24:27], s44 offen offset:1024 sc1
    v_mfma_f32_16x16x32_bf16 v[52:55], v[164:167], v[136:139], v[52:55]
    buffer_load_dwordx4 v[100:103], v13, s[24:27], s45 offen sc1
    v_mfma_f32_16x16x32_bf16 v[48:51], v[160:163], v[136:139], v[48:51]
    v_mfma_f32_16x16x32_bf16 v[44:47], v[156:159], v[136:139], v[44:47]
    buffer_load_dwordx4 v[120:123], v2, s[24:27], s44 offen offset:2048 sc1
    v_mfma_f32_16x16x32_bf16 v[40:43], v[152:155], v[136:139], v[40:43]
    buffer_load_dwordx4 v[104:107], v14, s[24:27], s45 offen sc1
    v_mfma_f32_16x16x32_bf16 v[36:39], v[148:151], v[136:139], v[36:39]
    v_mfma_f32_16x16x32_bf16 v[56:59], v[148:151], v[140:143], v[56:59]
    buffer_load_dwordx4 v[124:127], v2, s[24:27], s44 offen offset:3072 sc1
    v_mfma_f32_16x16x32_bf16 v[60:63], v[152:155], v[140:143], v[60:63]
    buffer_load_dwordx4 v[108:111], v15, s[24:27], s45 offen sc1
    v_mfma_f32_16x16x32_bf16 v[64:67], v[156:159], v[140:143], v[64:67]
    v_mfma_f32_16x16x32_bf16 v[68:71], v[160:163], v[140:143], v[68:71]
    buffer_load_dwordx4 v[128:131], v4, s[24:27], s44 offen offset:0 sc1
    s_add_u32 s44, s44, 20480
    s_add_u32 s45, s45, 4096
    v_mfma_f32_16x16x32_bf16 v[72:75], v[164:167], v[140:143], v[72:75]
    buffer_load_dwordx4 v2, s[24:27], s50 offen offset:3072 sc1 lds
    v_mfma_f32_16x16x32_bf16 v[92:95], v[164:167], v[144:147], v[92:95]
    v_mfma_f32_16x16x32_bf16 v[88:91], v[160:163], v[144:147], v[88:91]
    s_add_u32 m0, s43, 24576
    s_nop 0
    buffer_load_dwordx4 v4, s[24:27], s50 offen sc1 lds
    s_add_u32 s50, s50, 20480
    v_mfma_f32_16x16x32_bf16 v[84:87], v[156:159], v[144:147], v[84:87]
    s_add_u32 m0, s43, 40960
    s_nop 0
    buffer_load_dwordx4 v2, s[24:27], s50 offen offset:0 sc1 lds
    v_mfma_f32_16x16x32_bf16 v[80:83], v[152:155], v[144:147], v[80:83]
    v_mfma_f32_16x16x32_bf16 v[76:79], v[148:151], v[144:147], v[76:79]
    buffer_load_dwordx4 v2, s[24:27], s50 offen offset:1024 sc1 lds
    s_waitcnt vmcnt(17)
    v_mfma_f32_16x16x32_bf16 v[76:79], v[184:187], v[180:183], v[76:79]
    s_and_b32 s54, s40, 2
    s_mul_i32 s55, s54, 5120
    s_sub_u32 s44, s44, s55
    s_lshl_b32 s54, s54, 10
    s_sub_u32 s45, s45, s54
    v_mfma_f32_16x16x32_bf16 v[80:83], v[188:191], v[180:183], v[80:83]
    v_mfma_f32_16x16x32_bf16 v[84:87], v[192:195], v[180:183], v[84:87]
    buffer_load_dwordx4 v[148:151], v2, s[24:27], s44 offen offset:0 sc1
    v_mfma_f32_16x16x32_bf16 v[88:91], v[196:199], v[180:183], v[88:91]
    buffer_load_dwordx4 v[140:143], v12, s[24:27], s45 offen sc1
    v_mfma_f32_16x16x32_bf16 v[92:95], v[200:203], v[180:183], v[92:95]
    v_mfma_f32_16x16x32_bf16 v[72:75], v[200:203], v[176:179], v[72:75]
    buffer_load_dwordx4 v[152:155], v2, s[24:27], s44 offen offset:1024 sc1
    v_mfma_f32_16x16x32_bf16 v[68:71], v[196:199], v[176:179], v[68:71]
    buffer_load_dwordx4 v[144:147], v13, s[24:27], s45 offen sc1
    v_mfma_f32_16x16x32_bf16 v[64:67], v[192:195], v[176:179], v[64:67]
    v_mfma_f32_16x16x32_bf16 v[60:63], v[188:191], v[176:179], v[60:63]
    buffer_load_dwordx4 v[156:159], v2, s[24:27], s44 offen offset:2048 sc1
    v_mfma_f32_16x16x32_bf16 v[56:59], v[184:187], v[176:179], v[56:59]
    buffer_load_dwordx4 v[160:163], v2, s[24:27], s44 offen offset:3072 sc1
    v_mfma_f32_16x16x32_bf16 v[36:39], v[184:187], v[172:175], v[36:39]
    buffer_load_dwordx4 v[164:167], v4, s[24:27], s44 offen offset:0 sc1
    s_add_u32 s44, s44, 20480
    s_add_u32 s45, s45, 4096
    v_mfma_f32_16x16x32_bf16 v[40:43], v[188:191], v[172:175], v[40:43]
    v_mfma_f32_16x16x32_bf16 v[44:47], v[192:195], v[172:175], v[44:47]
    buffer_load_dwordx4 v2, s[24:27], s50 offen offset:2048 sc1 lds
    v_mfma_f32_16x16x32_bf16 v[48:51], v[196:199], v[172:175], v[48:51]
    buffer_load_dwordx4 v2, s[24:27], s50 offen offset:3072 sc1 lds
    v_mfma_f32_16x16x32_bf16 v[52:55], v[200:203], v[172:175], v[52:55]
    v_mfma_f32_16x16x32_bf16 v[32:35], v[200:203], v[168:171], v[32:35]
    s_add_u32 m0, s43, 45056
    s_nop 0
    buffer_load_dwordx4 v4, s[24:27], s50 offen sc1 lds
    s_add_u32 s50, s50, 20480
    v_mfma_f32_16x16x32_bf16 v[28:31], v[196:199], v[168:171], v[28:31]
    buffer_load_dwordx4 v[240:243], v5, s[28:31], s57 offen offset:0
    v_mfma_f32_16x16x32_bf16 v[24:27], v[192:195], v[168:171], v[24:27]
    v_mfma_f32_16x16x32_bf16 v[20:23], v[188:191], v[168:171], v[20:23]
    buffer_load_dwordx4 v[244:247], v5, s[28:31], s57 offen offset:16
    v_mfma_f32_16x16x32_bf16 v[16:19], v[184:187], v[168:171], v[16:19]
    buffer_load_dwordx2 v[248:249], v5, s[28:31], s57 offen offset:32
g2_tc1:
    s_setprio 2
    v_add_u32 v250, s43, v3
    s_sub_u32 s54, s40, 1
    s_and_b32 s54, s54, 3
    s_mul_i32 s54, s54, 5120
    v_add_u32 v252, s54, v3
    s_sub_u32 s54, s40, 2
    s_and_b32 s54, s54, 3
    s_mul_i32 s54, s54, 5120
    v_add_u32 v253, s54, v3
    s_sub_u32 s54, s40, 3
    s_and_b32 s54, s54, 3
    s_mul_i32 s54, s54, 5120
    v_add_u32 v254, s54, v3
    s_setprio 0
    s_waitcnt vmcnt(17)
    v_mfma_f32_16x16x32_bf16 v[76:79], v[112:115], v[108:111], v[76:79]
    v_mfma_f32_16x16x32_bf16 v[80:83], v[116:119], v[108:111], v[80:83]
    v_mfma_f32_16x16x32_bf16 v[84:87], v[120:123], v[108:111], v[84:87]
    v_mfma_f32_16x16x32_bf16 v[88:91], v[124:127], v[108:111], v[88:91]
    v_mfma_f32_16x16x32_bf16 v[92:95], v[128:131], v[108:111], v[92:95]
    v_mfma_f32_16x16x32_bf16 v[56:59], v[112:115], v[104:107], v[56:59]
    v_mfma_f32_16x16x32_bf16 v[60:63], v[116:119], v[104:107], v[60:63]
    v_mfma_f32_16x16x32_bf16 v[64:67], v[120:123], v[104:107], v[64:67]
    v_mfma_f32_16x16x32_bf16 v[68:71], v[124:127], v[104:107], v[68:71]
    v_mfma_f32_16x16x32_bf16 v[72:75], v[128:131], v[104:107], v[72:75]
    v_mfma_f32_16x16x32_bf16 v[36:39], v[112:115], v[100:103], v[36:39]
    v_mfma_f32_16x16x32_bf16 v[40:43], v[116:119], v[100:103], v[40:43]
    v_mfma_f32_16x16x32_bf16 v[44:47], v[120:123], v[100:103], v[44:47]
    ds_write_b128 v250, v[76:79] offset:0
    ds_write_b128 v250, v[80:83] offset:1024
    v_mfma_f32_16x16x32_bf16 v[48:51], v[124:127], v[100:103], v[48:51]
    ds_write_b128 v250, v[84:87] offset:2048
    ds_write_b128 v250, v[88:91] offset:3072
    v_mfma_f32_16x16x32_bf16 v[52:55], v[128:131], v[100:103], v[52:55]
    ds_write_b128 v250, v[92:95] offset:4096
    v_mfma_f32_16x16x32_bf16 v[16:19], v[112:115], v[96:99], v[16:19]
    s_waitcnt vmcnt(3) lgkmcnt(0)
    s_barrier
    ds_read_b128 v[176:179], v254 offset:0
    ds_read_b128 v[180:183], v254 offset:1024
    ds_read_b128 v[184:187], v254 offset:2048
    ds_read_b128 v[188:191], v254 offset:3072
    ds_read_b128 v[192:195], v254 offset:4096
    ds_read_b128 v[76:79], v2 offset:0
    ds_read_b128 v[80:83], v2 offset:1024
    ds_read_b128 v[84:87], v2 offset:2048
    ds_read_b128 v[88:91], v2 offset:3072
    ds_read_b128 v[92:95], v2 offset:4096
    v_mfma_f32_16x16x32_bf16 v[20:23], v[116:119], v[96:99], v[20:23]
    v_mfma_f32_16x16x32_bf16 v[24:27], v[120:123], v[96:99], v[24:27]
    v_mfma_f32_16x16x32_bf16 v[28:31], v[124:127], v[96:99], v[28:31]
    s_waitcnt lgkmcnt(0)
    s_barrier
    ds_write_b128 v250, v[56:59] offset:0
    ds_write_b128 v250, v[60:63] offset:1024
    v_mfma_f32_16x16x32_bf16 v[32:35], v[128:131], v[96:99], v[32:35]
    ds_write_b128 v250, v[64:67] offset:2048
    ds_write_b128 v250, v[68:71] offset:3072
    s_waitcnt vmcnt(6)
    v_mfma_f32_16x16x32_bf16 v[36:39], v[148:151], v[144:147], v[36:39]
    ds_write_b128 v250, v[72:75] offset:4096
    v_mfma_f32_16x16x32_bf16 v[40:43], v[152:155], v[144:147], v[40:43]
    v_mfma_f32_16x16x32_bf16 v[44:47], v[156:159], v[144:147], v[44:47]
    s_waitcnt lgkmcnt(0)
    s_barrier
    ds_read_b128 v[196:199], v253 offset:0
    ds_read_b128 v[200:203], v253 offset:1024
    ds_read_b128 v[204:207], v253 offset:2048
    ds_read_b128 v[208:211], v253 offset:3072
    ds_read_b128 v[212:215], v253 offset:4096
    ds_read_b128 v[56:59], v2 offset:5120
    ds_read_b128 v[60:63], v2 offset:6144
    ds_read_b128 v[64:67], v2 offset:7168
    ds_read_b128 v[68:71], v2 offset:8192
    ds_read_b128 v[72:75], v2 offset:9216
    ds_read_b128 v[96:99], v2 offset:10240
    ds_read_b128 v[100:103], v2 offset:11264
    ds_read_b128 v[104:107], v2 offset:12288
    ds_read_b128 v[108:111], v2 offset:13312
    ds_read_b128 v[112:115], v2 offset:14336
    v_mfma_f32_16x16x32_bf16 v[48:51], v[160:163], v[144:147], v[48:51]
    v_mfma_f32_16x16x32_bf16 v[52:55], v[164:167], v[144:147], v[52:55]
    v_mfma_f32_16x16x32_bf16 v[16:19], v[148:151], v[140:143], v[16:19]
    v_mfma_f32_16x16x32_bf16 v[20:23], v[152:155], v[140:143], v[20:23]
    v_mfma_f32_16x16x32_bf16 v[24:27], v[156:159], v[140:143], v[24:27]
    s_waitcnt lgkmcnt(0)
    s_barrier
    ds_read_b128 v[116:119], v2 offset:15360
    ds_read_b128 v[120:123], v2 offset:16384
    ds_read_b128 v[124:127], v2 offset:17408
    ds_read_b128 v[128:131], v2 offset:18432
    ds_read_b128 v[132:135], v2 offset:19456
    v_mfma_f32_16x16x32_bf16 v[28:31], v[160:163], v[140:143], v[28:31]
    v_mfma_f32_16x16x32_bf16 v[32:35], v[164:167], v[140:143], v[32:35]
    s_setprio 2
    ds_write_b128 v250, v[36:39] offset:0
    ds_write_b128 v250, v[40:43] offset:1024
    ds_write_b128 v250, v[44:47] offset:2048
    ds_write_b128 v250, v[48:51] offset:3072
    ds_write_b128 v250, v[52:55] offset:4096
    ds_read_b128 v[136:139], v2 offset:20480
    ds_read_b128 v[140:143], v2 offset:21504
    ds_read_b128 v[144:147], v2 offset:22528
    ds_read_b128 v[148:151], v2 offset:23552
    ds_read_b128 v[152:155], v2 offset:24576
    s_cmp_eq_u32 s40, 0
    s_cbranch_scc1 g2_q3
g2_q3r:
    v_pk_add_f32 v[176:177], v[176:177], v[196:197]
    v_pk_add_f32 v[178:179], v[178:179], v[198:199]
    v_pk_add_f32 v[180:181], v[180:181], v[200:201]
    v_pk_add_f32 v[182:183], v[182:183], v[202:203]
    v_pk_add_f32 v[184:185], v[184:185], v[204:205]
    v_pk_add_f32 v[186:187], v[186:187], v[206:207]
    v_pk_add_f32 v[188:189], v[188:189], v[208:209]
    v_pk_add_f32 v[190:191], v[190:191], v[210:211]
    v_pk_add_f32 v[192:193], v[192:193], v[212:213]
    v_pk_add_f32 v[194:195], v[194:195], v[214:215]
    s_waitcnt lgkmcnt(0)
    s_barrier
    ds_read_b128 v[216:219], v252 offset:0
    ds_read_b128 v[220:223], v252 offset:1024
    ds_read_b128 v[224:227], v252 offset:2048
    ds_read_b128 v[228:231], v252 offset:3072
    ds_read_b128 v[232:235], v252 offset:4096
    s_add_u32 m0, s43, 0
    s_nop 0
    buffer_load_dwordx4 v2, s[24:27], s50 offen offset:0 sc1 lds
    v_pk_add_f32 v[16:17], v[16:17], v[176:177]
    v_pk_add_f32 v[18:19], v[18:19], v[178:179]
    buffer_load_dwordx4 v2, s[24:27], s50 offen offset:1024 sc1 lds
    v_pk_add_f32 v[20:21], v[20:21], v[180:181]
    v_pk_add_f32 v[22:23], v[22:23], v[182:183]
    buffer_load_dwordx4 v2, s[24:27], s50 offen offset:2048 sc1 lds
    v_pk_add_f32 v[24:25], v[24:25], v[184:185]
    v_pk_add_f32 v[26:27], v[26:27], v[186:187]
    buffer_load_dwordx4 v2, s[24:27], s50 offen offset:3072 sc1 lds
    v_pk_add_f32 v[28:29], v[28:29], v[188:189]
    v_pk_add_f32 v[30:31], v[30:31], v[190:191]
    s_add_u32 m0, s43, 4096
    s_nop 0
    buffer_load_dwordx4 v4, s[24:27], s50 offen sc1 lds
    s_add_u32 s50, s50, 20480
    v_pk_add_f32 v[32:33], v[32:33], v[192:193]
    v_pk_add_f32 v[34:35], v[34:35], v[194:195]
    v_lshrrev_b32 v251, 4, v1
    v_and_b32 v9, 0xff, v2
    v_lshl_add_u32 v9, v251, 10, v9
    s_waitcnt lgkmcnt(0)
    s_barrier
    s_add_u32 m0, s43, 61440
    s_nop 0
    buffer_load_dwordx4 v2, s[24:27], s50 offen offset:0 sc1 lds
    v_pk_add_f32 v[16:17], v[16:17], v[216:217]
    v_pk_add_f32 v[18:19], v[18:19], v[218:219]
    v_pk_add_f32 v[20:21], v[20:21], v[220:221]
    v_pk_add_f32 v[22:23], v[22:23], v[222:223]
    v_pk_add_f32 v[24:25], v[24:25], v[224:225]
    v_pk_add_f32 v[26:27], v[26:27], v[226:227]
    v_pk_add_f32 v[28:29], v[28:29], v[228:229]
    v_pk_add_f32 v[30:31], v[30:31], v[230:231]
    buffer_load_dwordx4 v2, s[24:27], s50 offen offset:1024 sc1 lds
    v_pk_add_f32 v[32:33], v[32:33], v[232:233]
    v_pk_add_f32 v[34:35], v[34:35], v[234:235]
    v_lshrrev_b32 v250, 4, v1
    v_and_b32 v251, 0xff, v2
    s_add_u32 s47, s47, 0
    s_mul_i32 s54, s40, 2560
    s_add_u32 s54, s54, 20480
    v_mul_u32_u24 v251, 10, v251
    buffer_load_dwordx4 v2, s[24:27], s50 offen offset:2048 sc1 lds
    v_mad_u32_u24 v250, v250, 40, v251
    v_add_u32 v250, s54, v250
    v_add_u32 v251, s54, v2
    s_movk_i32 s55, 1120
    v_add_u32 v252, 0, v1
    v_mul_u32_u24 v236, 6554, v252
    v_lshrrev_b32 v236, 16, v236
    v_lshlrev_b32 v252, 4, v252
    buffer_load_dwordx4 v2, s[24:27], s50 offen offset:3072 sc1 lds
    v_mad_u32_u24 v252, v236, s55, v252
    v_add_u32 v253, 64, v1
    v_mul_u32_u24 v236, 6554, v253
    v_lshrrev_b32 v236, 16, v236
    v_lshlrev_b32 v253, 4, v253
    v_mad_u32_u24 v253, v236, s55, v253
    v_add_u32 v254, 128, v1
    v_mul_u32_u24 v236, 6554, v254
    s_add_u32 m0, s43, 65536
    s_nop 0
    buffer_load_dwordx4 v4, s[24:27], s50 offen sc1 lds
    s_add_u32 s50, s50, 20480
    v_lshrrev_b32 v236, 16, v236
    v_lshlrev_b32 v254, 4, v254
    v_mad_u32_u24 v254, v236, s55, v254
    s_setprio 2
    s_cmp_eq_u32 s40, 0
    s_cbranch_scc1 g2_c3
g2_c3r:
    s_barrier
    buffer_load_dwordx4 v[156:159], v2, s[24:27], s58 offen offset:0 sc1
    buffer_load_dwordx4 v[160:163], v2, s[24:27], s58 offen offset:1024 sc1
    buffer_load_dwordx4 v[164:167], v2, s[24:27], s58 offen offset:2048 sc1
    v_mul_f32 v236, 0xbfb8aa3b, v16
    v_mul_f32 v237, 0xbfb8aa3b, v17
    v_mul_f32 v238, 0xbfb8aa3b, v18
    v_mul_f32 v239, 0xbfb8aa3b, v19
    v_exp_f32 v236, v236
    v_exp_f32 v237, v237
    v_exp_f32 v238, v238
    v_exp_f32 v239, v239
    buffer_load_dwordx4 v[168:171], v2, s[24:27], s58 offen offset:3072 sc1
    v_pk_add_f32 v[236:237], v[236:237], 1.0 op_sel_hi:[1,0]
    v_pk_add_f32 v[238:239], v[238:239], 1.0 op_sel_hi:[1,0]
    v_rcp_f32 v236, v236
    v_rcp_f32 v237, v237
    v_rcp_f32 v238, v238
    v_rcp_f32 v239, v239
    v_pk_mul_f32 v[16:17], v[16:17], v[236:237] op_sel:[0,0] op_sel_hi:[1,1]
    v_pk_mul_f32 v[18:19], v[18:19], v[238:239] op_sel:[0,0] op_sel_hi:[1,1]
    buffer_load_dwordx2 v[172:173], v9, s[24:27], s96 offen offset:0 sc1
    v_mul_f32 v236, 0xbfb8aa3b, v20
    v_mul_f32 v237, 0xbfb8aa3b, v21
    v_mul_f32 v238, 0xbfb8aa3b, v22
    v_mul_f32 v239, 0xbfb8aa3b, v23
    v_exp_f32 v236, v236
    v_exp_f32 v237, v237
    v_exp_f32 v238, v238
    v_exp_f32 v239, v239
    buffer_load_dwordx2 v[174:175], v9, s[24:27], s96 offen offset:512 sc1
    v_pk_add_f32 v[236:237], v[236:237], 1.0 op_sel_hi:[1,0]
    v_pk_add_f32 v[238:239], v[238:239], 1.0 op_sel_hi:[1,0]
    v_rcp_f32 v236, v236
    v_rcp_f32 v237, v237
    v_rcp_f32 v238, v238
    v_rcp_f32 v239, v239
    v_pk_mul_f32 v[20:21], v[20:21], v[236:237] op_sel:[0,0] op_sel_hi:[1,1]
    v_pk_mul_f32 v[22:23], v[22:23], v[238:239] op_sel:[0,0] op_sel_hi:[1,1]
    buffer_load_dwordx4 v[176:179], v2, s[24:27], s59 offen offset:0 sc1
    v_mul_f32 v236, 0xbfb8aa3b, v24
    v_mul_f32 v237, 0xbfb8aa3b, v25
    v_mul_f32 v238, 0xbfb8aa3b, v26
    v_mul_f32 v239, 0xbfb8aa3b, v27
    v_exp_f32 v236, v236
    v_exp_f32 v237, v237
    v_exp_f32 v238, v238
    v_exp_f32 v239, v239
    buffer_load_dwordx4 v[180:183], v2, s[24:27], s59 offen offset:1024 sc1
    v_pk_add_f32 v[236:237], v[236:237], 1.0 op_sel_hi:[1,0]
    v_pk_add_f32 v[238:239], v[238:239], 1.0 op_sel_hi:[1,0]
    v_rcp_f32 v236, v236
    v_rcp_f32 v237, v237
    v_rcp_f32 v238, v238
    v_rcp_f32 v239, v239
    v_pk_mul_f32 v[24:25], v[24:25], v[236:237] op_sel:[0,0] op_sel_hi:[1,1]
    v_pk_mul_f32 v[26:27], v[26:27], v[238:239] op_sel:[0,0] op_sel_hi:[1,1]
    buffer_load_dwordx4 v[184:187], v2, s[24:27], s59 offen offset:2048 sc1
    v_mul_f32 v236, 0xbfb8aa3b, v28
    v_mul_f32 v237, 0xbfb8aa3b, v29
    v_mul_f32 v238, 0xbfb8aa3b, v30
    v_mul_f32 v239, 0xbfb8aa3b, v31
    v_exp_f32 v236, v236
    v_exp_f32 v237, v237
    v_exp_f32 v238, v238
    v_exp_f32 v239, v239
    buffer_load_dwordx4 v[188:191], v2, s[24:27], s59 offen offset:3072 sc1
    v_pk_add_f32 v[236:237], v[236:237], 1.0 op_sel_hi:[1,0]
    v_pk_add_f32 v[238:239], v[238:239], 1.0 op_sel_hi:[1,0]
    v_rcp_f32 v236, v236
    v_rcp_f32 v237, v237
    v_rcp_f32 v238, v238
    v_rcp_f32 v239, v239
    v_pk_mul_f32 v[28:29], v[28:29], v[236:237] op_sel:[0,0] op_sel_hi:[1,1]
    v_pk_mul_f32 v[30:31], v[30:31], v[238:239] op_sel:[0,0] op_sel_hi:[1,1]
    buffer_load_dwordx2 v[192:193], v9, s[24:27], s97 offen offset:0 sc1
    v_mul_f32 v236, 0xbfb8aa3b, v32
    v_mul_f32 v237, 0xbfb8aa3b, v33
    v_mul_f32 v238, 0xbfb8aa3b, v34
    v_mul_f32 v239, 0xbfb8aa3b, v35
    v_exp_f32 v236, v236
    v_exp_f32 v237, v237
    v_exp_f32 v238, v238
    v_exp_f32 v239, v239
    buffer_load_dwordx2 v[194:195], v9, s[24:27], s97 offen offset:512 sc1
    v_pk_add_f32 v[236:237], v[236:237], 1.0 op_sel_hi:[1,0]
    v_pk_add_f32 v[238:239], v[238:239], 1.0 op_sel_hi:[1,0]
    v_rcp_f32 v236, v236
    v_rcp_f32 v237, v237
    v_rcp_f32 v238, v238
    v_rcp_f32 v239, v239
    v_pk_mul_f32 v[32:33], v[32:33], v[236:237] op_sel:[0,0] op_sel_hi:[1,1]
    v_pk_mul_f32 v[34:35], v[34:35], v[238:239] op_sel:[0,0] op_sel_hi:[1,1]
    s_waitcnt vmcnt(11)
    v_mfma_f32_16x16x32_bf16 v[36:39], v[76:79], v[156:159], 0
    ds_read_b128 v[76:79], v2 offset:25600
    buffer_load_dwordx4 v[196:199], v2, s[24:27], s60 offen offset:0 sc1
    v_mfma_f32_16x16x32_bf16 v[40:43], v[80:83], v[156:159], 0
    v_mfma_f32_16x16x32_bf16 v[44:47], v[84:87], v[156:159], 0
    ds_read_b128 v[80:83], v2 offset:26624
    v_mfma_f32_16x16x32_bf16 v[48:51], v[88:91], v[156:159], 0
    ds_read_b128 v[84:87], v2 offset:27648
    v_mfma_f32_16x16x32_bf16 v[52:55], v[92:95], v[156:159], 0
    s_waitcnt vmcnt(11)
    ds_read_b128 v[88:91], v2 offset:28672
    buffer_load_dwordx4 v[200:203], v2, s[24:27], s60 offen offset:1024 sc1
    v_mfma_f32_16x16x32_bf16 v[36:39], v[56:59], v[160:163], v[36:39]
    ds_read_b128 v[92:95], v2 offset:29696
    v_mfma_f32_16x16x32_bf16 v[40:43], v[60:63], v[160:163], v[40:43]
    ds_read_b128 v[56:59], v2 offset:30720
    v_mfma_f32_16x16x32_bf16 v[44:47], v[64:67], v[160:163], v[44:47]
    v_mfma_f32_16x16x32_bf16 v[48:51], v[68:71], v[160:163], v[48:51]
    ds_read_b128 v[60:63], v2 offset:31744
    buffer_load_dwordx4 v[204:207], v2, s[24:27], s60 offen offset:2048 sc1
    v_mfma_f32_16x16x32_bf16 v[52:55], v[72:75], v[160:163], v[52:55]
    s_waitcnt vmcnt(12)
    ds_read_b128 v[64:67], v2 offset:32768
    v_mfma_f32_16x16x32_bf16 v[36:39], v[96:99], v[164:167], v[36:39]
    ds_read_b128 v[68:71], v2 offset:33792
    v_mfma_f32_16x16x32_bf16 v[40:43], v[100:103], v[164:167], v[40:43]
    ds_read_b128 v[72:75], v2 offset:34816
    v_mfma_f32_16x16x32_bf16 v[44:47], v[104:107], v[164:167], v[44:47]
    ds_read_b128 v[96:99], v2 offset:35840
    buffer_load_dwordx4 v[208:211], v2, s[24:27], s60 offen offset:3072 sc1
    v_mfma_f32_16x16x32_bf16 v[48:51], v[108:111], v[164:167], v[48:51]
    v_mfma_f32_16x16x32_bf16 v[52:55], v[112:115], v[164:167], v[52:55]
    s_waitcnt vmcnt(12)
    ds_read_b128 v[100:103], v2 offset:36864
    v_mfma_f32_16x16x32_bf16 v[36:39], v[116:119], v[168:171], v[36:39]
    ds_read_b128 v[104:107], v2 offset:37888
    v_mfma_f32_16x16x32_bf16 v[40:43], v[120:123], v[168:171], v[40:43]
    ds_read_b128 v[108:111], v2 offset:38912
    buffer_load_dwordx2 v[212:213], v9, s[24:27], s98 offen offset:0 sc1
    v_mfma_f32_16x16x32_bf16 v[44:47], v[124:127], v[168:171], v[44:47]
    ds_read_b128 v[112:115], v2 offset:39936
    v_mfma_f32_16x16x32_bf16 v[48:51], v[128:131], v[168:171], v[48:51]
    ds_read_b128 v[116:119], v2 offset:40960
    v_mfma_f32_16x16x32_bf16 v[52:55], v[132:135], v[168:171], v[52:55]
    s_waitcnt vmcnt(11)
    v_mfma_f32_16x16x32_bf16 v[36:39], v[136:139], v[172:175], v[36:39]
    ds_read_b128 v[120:123], v2 offset:41984
    buffer_load_dwordx2 v[214:215], v9, s[24:27], s98 offen offset:512 sc1
    v_mfma_f32_16x16x32_bf16 v[40:43], v[140:143], v[172:175], v[40:43]
    ds_read_b128 v[124:127], v2 offset:43008
    v_mfma_f32_16x16x32_bf16 v[44:47], v[144:147], v[172:175], v[44:47]
    ds_read_b128 v[128:131], v2 offset:44032
    v_mfma_f32_16x16x32_bf16 v[48:51], v[148:151], v[172:175], v[48:51]
    ds_read_b128 v[132:135], v2 offset:45056
    v_mfma_f32_16x16x32_bf16 v[52:55], v[152:155], v[172:175], v[52:55]
    s_waitcnt vmcnt(11) lgkmcnt(14)
    ds_read_b128 v[136:139], v2 offset:46080
    buffer_load_dwordx4 v[216:219], v2, s[24:27], s61 offen offset:0 sc1
    v_mfma_f32_16x16x32_bf16 v[36:39], v[76:79], v[176:179], v[36:39]
    s_waitcnt lgkmcnt(14)
    v_mfma_f32_16x16x32_bf16 v[40:43], v[80:83], v[176:179], v[40:43]
    s_waitcnt lgkmcnt(14)
    ds_read_b128 v[140:143], v2 offset:47104
    v_lshlrev_b32 v156, 16, v240
    v_mfma_f32_16x16x32_bf16 v[44:47], v[84:87], v[176:179], v[44:47]
    s_waitcnt lgkmcnt(14)
    ds_read_b128 v[144:147], v2 offset:48128
    v_and_b32 v157, 0xffff0000, v240
    v_mfma_f32_16x16x32_bf16 v[48:51], v[88:91], v[176:179], v[48:51]
    s_waitcnt lgkmcnt(14)
    ds_read_b128 v[148:151], v2 offset:49152
    buffer_load_dwordx4 v[220:223], v2, s[24:27], s61 offen offset:1024 sc1
    v_mfma_f32_16x16x32_bf16 v[52:55], v[92:95], v[176:179], v[52:55]
    s_waitcnt vmcnt(12) lgkmcnt(14)
    ds_read_b128 v[152:155], v2 offset:50176
    v_lshlrev_b32 v158, 16, v241
    v_mfma_f32_16x16x32_bf16 v[36:39], v[56:59], v[180:183], v[36:39]
    s_waitcnt lgkmcnt(14)
    ds_read_b128 v[76:79], v2 offset:51200
    v_and_b32 v159, 0xffff0000, v241
    v_mfma_f32_16x16x32_bf16 v[40:43], v[60:63], v[180:183], v[40:43]
    s_waitcnt lgkmcnt(14)
    s_barrier
    v_lshlrev_b32 v160, 16, v242
    v_and_b32 v161, 0xffff0000, v242
    v_mfma_f32_16x16x32_bf16 v[44:47], v[64:67], v[180:183], v[44:47]
    s_waitcnt lgkmcnt(14)
    ds_read_b128 v[80:83], v2 offset:52224
    buffer_load_dwordx4 v[224:227], v2, s[24:27], s61 offen offset:2048 sc1
    v_mfma_f32_16x16x32_bf16 v[48:51], v[68:71], v[180:183], v[48:51]
    s_waitcnt lgkmcnt(14)
    ds_read_b128 v[84:87], v2 offset:53248
    v_lshlrev_b32 v162, 16, v243
    v_mfma_f32_16x16x32_bf16 v[52:55], v[72:75], v[180:183], v[52:55]
    s_waitcnt vmcnt(12) lgkmcnt(14)
    ds_read_b128 v[88:91], v2 offset:54272
    v_and_b32 v163, 0xffff0000, v243
    v_mfma_f32_16x16x32_bf16 v[36:39], v[96:99], v[184:187], v[36:39]
    s_waitcnt lgkmcnt(14)
    ds_read_b128 v[92:95], v2 offset:55296
    v_lshlrev_b32 v164, 16, v244
    v_mfma_f32_16x16x32_bf16 v[40:43], v[100:103], v[184:187], v[40:43]
    s_waitcnt lgkmcnt(14)
    ds_read_b128 v[56:59], v2 offset:56320
    buffer_load_dwordx4 v[228:231], v2, s[24:27], s61 offen offset:3072 sc1
    v_mfma_f32_16x16x32_bf16 v[44:47], v[104:107], v[184:187], v[44:47]
    s_waitcnt lgkmcnt(14)
    v_and_b32 v165, 0xffff0000, v244
    v_lshlrev_b32 v166, 16, v245
    v_mfma_f32_16x16x32_bf16 v[48:51], v[108:111], v[184:187], v[48:51]
    s_waitcnt lgkmcnt(14)
    ds_read_b128 v[60:63], v2 offset:57344
    v_and_b32 v167, 0xffff0000, v245
    v_mfma_f32_16x16x32_bf16 v[52:55], v[112:115], v[184:187], v[52:55]
    s_waitcnt vmcnt(12) lgkmcnt(14)
    ds_read_b128 v[64:67], v2 offset:58368
    v_lshlrev_b32 v168, 16, v246
    v_mfma_f32_16x16x32_bf16 v[36:39], v[116:119], v[188:191], v[36:39]
    s_waitcnt lgkmcnt(14)
    ds_read_b128 v[68:71], v2 offset:59392
    buffer_load_dwordx2 v[232:233], v9, s[24:27], s99 offen offset:0 sc1
    v_mfma_f32_16x16x32_bf16 v[40:43], v[120:123], v[188:191], v[40:43]
    s_waitcnt lgkmcnt(14)
    ds_read_b128 v[72:75], v2 offset:60416
    v_and_b32 v169, 0xffff0000, v246
    v_mfma_f32_16x16x32_bf16 v[44:47], v[124:127], v[188:191], v[44:47]
    s_waitcnt lgkmcnt(14)
    ds_read_b128 v[96:99], v2 offset:0
    v_lshlrev_b32 v170, 16, v247
    v_mfma_f32_16x16x32_bf16 v[48:51], v[128:131], v[188:191], v[48:51]
    s_waitcnt lgkmcnt(14)
    v_and_b32 v171, 0xffff0000, v247
    v_lshlrev_b32 v172, 16, v248
    v_mfma_f32_16x16x32_bf16 v[52:55], v[132:135], v[188:191], v[52:55]
    s_waitcnt vmcnt(11) lgkmcnt(14)
    ds_read_b128 v[100:103], v2 offset:1024
    buffer_load_dwordx2 v[234:235], v9, s[24:27], s99 offen offset:512 sc1
    v_mfma_f32_16x16x32_bf16 v[36:39], v[136:139], v[192:195], v[36:39]
    s_waitcnt lgkmcnt(14)
    ds_read_b128 v[104:107], v2 offset:2048
    v_and_b32 v173, 0xffff0000, v248
    v_mfma_f32_16x16x32_bf16 v[40:43], v[140:143], v[192:195], v[40:43]
    s_waitcnt lgkmcnt(14)
    ds_read_b128 v[108:111], v2 offset:3072
    v_lshlrev_b32 v174, 16, v249
    v_mfma_f32_16x16x32_bf16 v[44:47], v[144:147], v[192:195], v[44:47]
    s_waitcnt lgkmcnt(14)
    ds_read_b128 v[112:115], v2 offset:4096
    v_and_b32 v175, 0xffff0000, v249
    v_mfma_f32_16x16x32_bf16 v[48:51], v[148:151], v[192:195], v[48:51]
    s_waitcnt lgkmcnt(14)
    ds_read_b128 v[116:119], v2 offset:5120
    v_mfma_f32_16x16x32_bf16 v[52:55], v[152:155], v[192:195], v[52:55]
    s_waitcnt vmcnt(11) lgkmcnt(14)
    v_mfma_f32_16x16x32_bf16 v[36:39], v[76:79], v[196:199], v[36:39]
    s_waitcnt lgkmcnt(14)
    ds_read_b128 v[120:123], v2 offset:6144
    v_mfma_f32_16x16x32_bf16 v[40:43], v[80:83], v[196:199], v[40:43]
    s_waitcnt lgkmcnt(14)
    ds_read_b128 v[124:127], v2 offset:7168
    v_mfma_f32_16x16x32_bf16 v[44:47], v[84:87], v[196:199], v[44:47]
    s_waitcnt lgkmcnt(14)
    ds_read_b128 v[128:131], v2 offset:8192
    v_mfma_f32_16x16x32_bf16 v[48:51], v[88:91], v[196:199], v[48:51]
    s_waitcnt lgkmcnt(14)
    ds_read_b128 v[132:135], v2 offset:9216
    v_mfma_f32_16x16x32_bf16 v[52:55], v[92:95], v[196:199], v[52:55]
    s_waitcnt vmcnt(10) lgkmcnt(14)
    ds_read_b128 v[136:139], v2 offset:10240
    v_mfma_f32_16x16x32_bf16 v[36:39], v[56:59], v[200:203], v[36:39]
    s_waitcnt lgkmcnt(14)
    v_mfma_f32_16x16x32_bf16 v[40:43], v[60:63], v[200:203], v[40:43]
    s_waitcnt lgkmcnt(13)
    ds_read_b128 v[140:143], v2 offset:11264
    v_mfma_f32_16x16x32_bf16 v[44:47], v[64:67], v[200:203], v[44:47]
    s_waitcnt lgkmcnt(13)
    ds_read_b128 v[144:147], v2 offset:12288
    v_mfma_f32_16x16x32_bf16 v[48:51], v[68:71], v[200:203], v[48:51]
    s_waitcnt lgkmcnt(13)
    ds_read_b128 v[148:151], v2 offset:13312
    v_mfma_f32_16x16x32_bf16 v[52:55], v[72:75], v[200:203], v[52:55]
    s_waitcnt vmcnt(9) lgkmcnt(13)
    ds_read_b128 v[152:155], v2 offset:14336
    v_mfma_f32_16x16x32_bf16 v[36:39], v[96:99], v[204:207], v[36:39]
    s_waitcnt lgkmcnt(13)
    ds_read_b128 v[76:79], v2 offset:15360
    v_mfma_f32_16x16x32_bf16 v[40:43], v[100:103], v[204:207], v[40:43]
    s_waitcnt lgkmcnt(13)
    v_mfma_f32_16x16x32_bf16 v[44:47], v[104:107], v[204:207], v[44:47]
    s_waitcnt lgkmcnt(12)
    ds_read_b128 v[80:83], v2 offset:16384
    v_mfma_f32_16x16x32_bf16 v[48:51], v[108:111], v[204:207], v[48:51]
    s_waitcnt lgkmcnt(12)
    ds_read_b128 v[84:87], v2 offset:17408
    v_mfma_f32_16x16x32_bf16 v[52:55], v[112:115], v[204:207], v[52:55]
    s_waitcnt vmcnt(8) lgkmcnt(12)
    ds_read_b128 v[88:91], v2 offset:18432
    v_mfma_f32_16x16x32_bf16 v[36:39], v[116:119], v[208:211], v[36:39]
    s_waitcnt lgkmcnt(12)
    ds_read_b128 v[92:95], v2 offset:19456
    v_mfma_f32_16x16x32_bf16 v[40:43], v[120:123], v[208:211], v[40:43]
    s_waitcnt lgkmcnt(12)
    ds_read_b128 v[56:59], v3 offset:0
    v_mfma_f32_16x16x32_bf16 v[44:47], v[124:127], v[208:211], v[44:47]
    s_waitcnt lgkmcnt(12)
    v_mfma_f32_16x16x32_bf16 v[48:51], v[128:131], v[208:211], v[48:51]
    s_waitcnt lgkmcnt(11)
    ds_read_b128 v[60:63], v3 offset:1024
    v_mfma_f32_16x16x32_bf16 v[52:55], v[132:135], v[208:211], v[52:55]
    s_waitcnt vmcnt(6) lgkmcnt(11)
    ds_read_b128 v[64:67], v3 offset:2048
    v_mfma_f32_16x16x32_bf16 v[36:39], v[136:139], v[212:215], v[36:39]
    s_waitcnt lgkmcnt(11)
    ds_read_b128 v[68:71], v3 offset:3072
    v_mfma_f32_16x16x32_bf16 v[40:43], v[140:143], v[212:215], v[40:43]
    s_waitcnt lgkmcnt(11)
    ds_read_b128 v[72:75], v3 offset:4096
    v_mfma_f32_16x16x32_bf16 v[44:47], v[144:147], v[212:215], v[44:47]
    s_waitcnt lgkmcnt(11)
    ds_read_b128 v[96:99], v3 offset:5120
    v_mfma_f32_16x16x32_bf16 v[48:51], v[148:151], v[212:215], v[48:51]
    s_waitcnt lgkmcnt(11)
    v_mfma_f32_16x16x32_bf16 v[52:55], v[152:155], v[212:215], v[52:55]
    s_waitcnt vmcnt(5) lgkmcnt(10)
    ds_read_b128 v[100:103], v3 offset:6144
    v_mfma_f32_16x16x32_bf16 v[36:39], v[76:79], v[216:219], v[36:39]
    s_waitcnt lgkmcnt(10)
    ds_read_b128 v[104:107], v3 offset:7168
    v_mfma_f32_16x16x32_bf16 v[40:43], v[80:83], v[216:219], v[40:43]
    s_waitcnt lgkmcnt(10)
    ds_read_b128 v[108:111], v3 offset:8192
    v_mfma_f32_16x16x32_bf16 v[44:47], v[84:87], v[216:219], v[44:47]
    s_waitcnt lgkmcnt(10)
    ds_read_b128 v[112:115], v3 offset:9216
    v_mfma_f32_16x16x32_bf16 v[48:51], v[88:91], v[216:219], v[48:51]
    s_waitcnt lgkmcnt(10)
    ds_read_b128 v[116:119], v3 offset:10240
    v_mfma_f32_16x16x32_bf16 v[52:55], v[92:95], v[216:219], v[52:55]
    s_waitcnt vmcnt(4) lgkmcnt(10)
    v_mfma_f32_16x16x32_bf16 v[36:39], v[56:59], v[220:223], v[36:39]
    s_waitcnt lgkmcnt(9)
    ds_read_b128 v[136:139], v3 offset:15360
    v_mfma_f32_16x16x32_bf16 v[40:43], v[60:63], v[220:223], v[40:43]
    s_waitcnt lgkmcnt(9)
    ds_read_b128 v[120:123], v3 offset:11264
    v_mfma_f32_16x16x32_bf16 v[44:47], v[64:67], v[220:223], v[44:47]
    s_waitcnt lgkmcnt(9)
    ds_read_b128 v[140:143], v3 offset:16384
    v_mfma_f32_16x16x32_bf16 v[48:51], v[68:71], v[220:223], v[48:51]
    s_waitcnt lgkmcnt(9)
    ds_read_b128 v[124:127], v3 offset:12288
    v_mfma_f32_16x16x32_bf16 v[52:55], v[72:75], v[220:223], v[52:55]
    s_waitcnt vmcnt(3) lgkmcnt(9)
    ds_read_b128 v[144:147], v3 offset:17408
    v_mfma_f32_16x16x32_bf16 v[36:39], v[96:99], v[224:227], v[36:39]
    s_waitcnt lgkmcnt(9)
    v_mfma_f32_16x16x32_bf16 v[40:43], v[100:103], v[224:227], v[40:43]
    s_waitcnt lgkmcnt(8)
    ds_read_b128 v[128:131], v3 offset:13312
    v_mfma_f32_16x16x32_bf16 v[44:47], v[104:107], v[224:227], v[44:47]
    s_waitcnt lgkmcnt(8)
    ds_read_b128 v[148:151], v3 offset:18432
    v_mfma_f32_16x16x32_bf16 v[48:51], v[108:111], v[224:227], v[48:51]
    s_waitcnt lgkmcnt(8)
    ds_read_b128 v[132:135], v3 offset:14336
    v_mfma_f32_16x16x32_bf16 v[52:55], v[112:115], v[224:227], v[52:55]
    s_waitcnt vmcnt(2) lgkmcnt(8)
    ds_read_b128 v[152:155], v3 offset:19456
    v_mfma_f32_16x16x32_bf16 v[36:39], v[116:119], v[228:231], v[36:39]
    s_waitcnt vmcnt(0) lgkmcnt(8)
    v_mfma_f32_16x16x32_bf16 v[36:39], v[136:139], v[232:235], v[36:39]
    s_waitcnt lgkmcnt(7)
    v_mfma_f32_16x16x32_bf16 v[40:43], v[120:123], v[228:231], v[40:43]
    s_waitcnt lgkmcnt(6)
    v_mfma_f32_16x16x32_bf16 v[40:43], v[140:143], v[232:235], v[40:43]
    s_waitcnt lgkmcnt(5)
    v_mfma_f32_16x16x32_bf16 v[44:47], v[124:127], v[228:231], v[44:47]
    s_waitcnt lgkmcnt(4)
    v_mfma_f32_16x16x32_bf16 v[44:47], v[144:147], v[232:235], v[44:47]
    s_waitcnt lgkmcnt(3)
    v_fma_f32 v156, v36, v16, v156
    v_fma_f32 v157, v37, v17, v157
    v_mfma_f32_16x16x32_bf16 v[48:51], v[128:131], v[228:231], v[48:51]
    s_waitcnt lgkmcnt(2)
    v_fma_f32 v158, v38, v18, v158
    v_fma_f32 v159, v39, v19, v159
    v_mfma_f32_16x16x32_bf16 v[48:51], v[148:151], v[232:235], v[48:51]
    s_waitcnt lgkmcnt(1)
    v_cvt_pk_bf16_f32 v240, v156, v157
    v_cvt_pk_bf16_f32 v241, v158, v159
    v_mfma_f32_16x16x32_bf16 v[52:55], v[132:135], v[228:231], v[52:55]
    s_waitcnt lgkmcnt(0)
    ds_write_b64 v250, v[240:241] offset:0
    v_fma_f32 v160, v40, v20, v160
    v_mfma_f32_16x16x32_bf16 v[52:55], v[152:155], v[232:235], v[52:55]
    v_fma_f32 v161, v41, v21, v161
    v_fma_f32 v162, v42, v22, v162
    v_fma_f32 v163, v43, v23, v163
    v_cvt_pk_bf16_f32 v242, v160, v161
    v_cvt_pk_bf16_f32 v243, v162, v163
    ds_write_b64 v250, v[242:243] offset:8
    v_fma_f32 v164, v44, v24, v164
    v_fma_f32 v165, v45, v25, v165
    v_fma_f32 v166, v46, v26, v166
    v_fma_f32 v167, v47, v27, v167
    v_cvt_pk_bf16_f32 v244, v164, v165
    v_cvt_pk_bf16_f32 v245, v166, v167
    ds_write_b64 v250, v[244:245] offset:16
    v_fma_f32 v168, v48, v28, v168
    v_fma_f32 v169, v49, v29, v169
    v_fma_f32 v170, v50, v30, v170
    v_fma_f32 v171, v51, v31, v171
    v_cvt_pk_bf16_f32 v246, v168, v169
    v_cvt_pk_bf16_f32 v247, v170, v171
    ds_write_b64 v250, v[246:247] offset:24
    v_fma_f32 v172, v52, v32, v172
    v_fma_f32 v173, v53, v33, v173
    v_fma_f32 v174, v54, v34, v174
    v_fma_f32 v175, v55, v35, v175
    v_cvt_pk_bf16_f32 v248, v172, v173
    v_cvt_pk_bf16_f32 v249, v174, v175
    ds_write_b64 v250, v[248:249] offset:32
    ds_read_b128 v[156:159], v251 offset:0
    ds_read_b128 v[160:163], v251 offset:1024
    ds_read_b128 v[164:167], v251 offset:2048
    s_waitcnt lgkmcnt(2)
    buffer_store_dwordx4 v[156:159], v252, s[32:35], s57 offen
    s_waitcnt lgkmcnt(1)
    buffer_store_dwordx4 v[160:163], v253, s[32:35], s57 offen
    s_waitcnt lgkmcnt(0)
    s_mov_b32 exec_hi, 0
    buffer_store_dwordx4 v[164:167], v254, s[32:35], s57 offen
    s_branch g2_end
g2_pb:
    s_mov_b64 exec, 1
    buffer_store_dword v11, off, s[24:27], s100 sc1
    s_mov_b64 exec, -1
    s_branch g2_pbr
g2_q2:
    buffer_load_dword v10, v6, s[24:27], s48 offen sc1
    s_branch g2_q2r
g2_c2:
    s_setprio 2
    s_waitcnt vmcnt(9)
    v_cmp_ne_u32 vcc, v10, v11
    s_nop 1
    s_cbranch_vccz g2_p2_ok
    s_mov_b32 s56, 0x20000
g2_p2:
    buffer_load_dword v10, v6, s[24:27], s48 offen sc1
    s_waitcnt vmcnt(0)
    v_cmp_ne_u32 vcc, v10, v11
    s_sub_u32 s56, s56, 1
    s_cbranch_scc1 g2_p2_ok
    s_cbranch_vccz g2_p2_ok
    s_mov_b64 exec, vcc
    s_sleep 2
    s_branch g2_p2
g2_p2_ok:
    s_mov_b64 exec, -1
    s_setprio 0
    s_branch g2_c2r
g2_tc:
    s_setprio 2
    s_getpc_b64 s[52:53]
L_tc1:
    s_sub_u32 s52, s52, L_tc1-g2_tc1
    s_subb_u32 s53, s53, 0
    v_lshlrev_b32 v7, 7, v1
    v_min_u32 v7, g2_end-g2_tc1, v7
    global_load_dword v7, v7, s[52:53]
    s_setprio 0
    s_branch g2_tcr
g2_q3:
    buffer_load_dword v8, v0, s[24:27], s47 offen sc1
    s_branch g2_q3r
g2_c3:
    s_setprio 2
    s_waitcnt vmcnt(10)
    v_cmp_ne_u32 vcc, v8, v11
    s_nop 1
    s_cbranch_vccz g2_p3_ok
    s_mov_b32 s56, 0x20000
g2_p3:
    buffer_load_dword v8, v0, s[24:27], s47 offen sc1
    s_waitcnt vmcnt(0)
    v_cmp_ne_u32 vcc, v8, v11
    s_sub_u32 s56, s56, 1
    s_cbranch_scc1 g2_p3_ok
    s_cbranch_vccz g2_p3_ok
    s_mov_b64 exec, vcc
    s_sleep 1
    s_branch g2_p3
g2_p3_ok:
    s_mov_b64 exec, -1
    s_setprio 2
    s_branch g2_c3r
g2_end:
    s_endpgm
L_att:
    v_and_b32 v1, 63, v0
    v_lshrrev_b32 v6, 6, v0
    s_and_b32 s54, s2, 7
    v_readfirstlane_b32 s40, v6
    s_bfe_u32 s55, s2, 131078
    s_and_b32 s41, s55, 1
    s_lshl1_add_u32 s41, s54, s41
    s_lshr_b32 s56, s55, 1
    s_lshl4_add_u32 s41, s56, s41
    s_bfe_u32 s42, s2, 196611
    s_and_b32 s44, s40, 1
    s_lshr_b32 s43, s40, 1
    s_lshr_b32 s54, s41, 1
    s_mul_i32 s54, s54, 5
    s_and_b32 s55, s41, 1
    s_mul_i32 s56, s55, 3
    s_add_u32 s56, s56, s54
    s_lshl_b32 s50, s56, 15
    s_add_u32 s54, s54, 2
    s_lshl_b32 s51, s54, 15
    s_lshl_b32 s55, s55, 8
    s_add_u32 s51, s51, s55
    v_and_b32 v6, 31, v1
    v_lshrrev_b32 v7, 5, v1
    v_lshlrev_b32 v21, 4, v6
    v_lshl_add_u32 v20, v7, 15, v21
    v_and_b32 v3, 7, v6
    v_bfe_u32 v8, v6, 3, 1
    v_lshl_add_u32 v3, v8, 4, v3
    v_lshrrev_b32 v8, 4, v6
    v_lshl_add_u32 v3, v8, 3, v3
    v_lshlrev_b32 v3, 4, v3
    v_lshl_add_u32 v2, v7, 15, v3
    v_mul_u32_u24 v4, 320, v7
    v_add_u32 v4, v4, v21
    v_lshrrev_b32 v8, 8, v21
    v_and_b32 v21, 0xff, v21
    v_lshl_add_u32 v21, v8, 3, v21
    v_lshrrev_b32 v8, 8, v3
    v_and_b32 v3, 0xff, v3
    v_lshl_add_u32 v3, v8, 3, v3
    v_add_u32 v5, 640, v4
    s_mov_b32 s58, 0xfffff
    s_mov_b32 s59, 0xfffff
    v_cmp_eq_u32 vcc, 20, v6
    v_mov_b32 v8, 0x3f803f80
    s_nop 0
    v_cndmask_b32 v10, 0, v8, vcc
    v_mov_b32 v156, v10
    v_mov_b32 v157, v10
    v_mov_b32 v158, v10
    v_mov_b32 v159, v10
    v_mov_b32 v160, v10
    v_mov_b32 v161, v10
    v_mov_b32 v162, v10
    v_mov_b32 v163, v10
    v_mov_b32 v170, v10
    v_mov_b32 v171, v10
    v_mov_b32 v172, v10
    v_mov_b32 v173, v10
    v_mov_b32 v174, v10
    v_mov_b32 v175, v10
    v_mov_b32 v176, v10
    v_mov_b32 v177, v10
    v_mov_b32 v184, v10
    v_mov_b32 v185, v10
    v_mov_b32 v186, v10
    v_mov_b32 v187, v10
    v_mov_b32 v188, v10
    v_mov_b32 v189, v10
    v_mov_b32 v190, v10
    v_mov_b32 v191, v10
    v_mov_b32 v198, v10
    v_mov_b32 v199, v10
    v_mov_b32 v200, v10
    v_mov_b32 v201, v10
    v_mov_b32 v202, v10
    v_mov_b32 v203, v10
    v_mov_b32 v204, v10
    v_mov_b32 v205, v10
    v_mov_b32 v132, 0
    v_mov_b32 v133, 0
    v_mov_b32 v138, 0
    v_mov_b32 v139, 0
    v_mov_b32 v144, 0
    v_mov_b32 v145, 0
    v_mov_b32 v150, 0
    v_mov_b32 v151, 0
    v_mov_b32 v64, 0
    v_mov_b32 v65, 0
    v_mov_b32 v66, 0
    v_mov_b32 v67, 0
    v_mov_b32 v68, 0
    v_mov_b32 v69, 0
    v_mov_b32 v70, 0
    v_mov_b32 v71, 0
    v_mov_b32 v72, 0
    v_mov_b32 v73, 0
    v_mov_b32 v74, 0
    v_mov_b32 v75, 0
    v_mov_b32 v76, 0
    v_mov_b32 v77, 0
    v_mov_b32 v78, 0
    v_mov_b32 v79, 0
    v_mov_b32 v80, 0
    v_mov_b32 v81, 0
    v_mov_b32 v82, 0
    v_mov_b32 v83, 0
    v_mov_b32 v84, 0
    v_mov_b32 v85, 0
    v_mov_b32 v86, 0
    v_mov_b32 v87, 0
    v_mov_b32 v88, 0
    v_mov_b32 v89, 0
    v_mov_b32 v90, 0
    v_mov_b32 v91, 0
    v_mov_b32 v92, 0
    v_mov_b32 v93, 0
    v_mov_b32 v94, 0
    v_mov_b32 v95, 0
    v_mov_b32 v96, 0
    v_mov_b32 v97, 0
    v_mov_b32 v98, 0
    v_mov_b32 v99, 0
    v_mov_b32 v100, 0
    v_mov_b32 v101, 0
    v_mov_b32 v102, 0
    v_mov_b32 v103, 0
    v_mov_b32 v104, 0
    v_mov_b32 v105, 0
    v_mov_b32 v106, 0
    v_mov_b32 v107, 0
    v_mov_b32 v108, 0
    v_mov_b32 v109, 0
    v_mov_b32 v110, 0
    v_mov_b32 v111, 0
    v_mov_b32 v112, 0
    v_mov_b32 v113, 0
    v_mov_b32 v114, 0
    v_mov_b32 v115, 0
    v_mov_b32 v116, 0
    v_mov_b32 v117, 0
    v_mov_b32 v118, 0
    v_mov_b32 v119, 0
    v_mov_b32 v120, 0
    v_mov_b32 v121, 0
    v_mov_b32 v122, 0
    v_mov_b32 v123, 0
    v_mov_b32 v124, 0
    v_mov_b32 v125, 0
    v_mov_b32 v126, 0
    v_mov_b32 v127, 0
    v_mov_b32 v24, 0
    v_mov_b32 v25, 0
    v_mov_b32 v26, 0
    v_mov_b32 v27, 0
    v_mov_b32 v28, 0
    v_mov_b32 v29, 0
    v_mov_b32 v30, 0
    v_mov_b32 v31, 0
    s_waitcnt lgkmcnt(0)
    s_mov_b32 s24, s22
    s_mov_b32 s25, s23
    s_mov_b32 s26, 21970944
    s_mov_b32 s27, 0x00020000
    v_mov_b32 v11, 0
    s_nop 0
    s_mov_b32 s55, 0x20000
att_nc:
    v_readfirstlane_b32 s54, v11
    s_sub_u32 s55, s55, 1
    s_cbranch_scc1 att_nc_ok
    s_cmp_lg_u32 s54, 0
    s_cbranch_scc1 att_nc_ok
    s_sleep 2
    v_mov_b32 v12, 0
    global_load_dword v11, v12, s[20:21] sc1
    s_waitcnt vmcnt(0)
    s_branch att_nc
att_nc_ok:
    v_lshlrev_b32 v208, 4, v1
    s_lshl_b32 s54, s42, 12
    s_lshl_b32 s55, s44, 11
    s_add_u32 s54, s54, s55
    s_lshl_b32 s55, s43, 10
    s_add_u32 s57, s54, s55
    s_xor_b32 s56, s57, 1024
    s_add_u32 s96, s56, s50
    s_add_u32 s97, s57, s50
    s_add_u32 s98, s56, s51
    s_add_u32 s99, s57, s51
    s_lshl_b32 s54, s43, 14
    s_add_u32 s54, s54, 2621440
    s_add_u32 s50, s50, s54
    s_add_u32 s51, s51, s54
    s_mul_i32 s52, s41, 81920
    s_mul_i32 s54, s43, 40960
    s_add_u32 s52, s52, s54
    s_add_u32 s52, s52, 5242880
    s_and_b32 s48, s42, 4
    s_add_u32 s48, s48, s41
    s_and_b32 s48, s48, 7
    s_lshl_b32 s54, s48, 11
    s_add_u32 s45, s50, s54
    s_add_u32 s46, s51, s54
    s_mul_i32 s54, s48, 5120
    s_add_u32 s47, s52, s54
    s_mov_b32 s49, 4
    s_mul_i32 s54, s43, 10240
    s_mul_i32 s53, s44, 5120
    s_add_u32 s53, s53, s54
    v_lshlrev_b32 v208, 4, v1
    v_add_u32 v209, s54, v208
    s_add_u32 s55, s54, 2048
    v_add_u32 v211, s55, v4
    s_add_u32 s55, s54, 4608
    v_add_u32 v210, s55, v3
    s_lshl_b32 s54, s44, 10
    s_add_u32 s60, s50, s54
    s_add_u32 s54, s51, s54
    s_mul_i32 s55, s44, 2560
    s_add_u32 s61, s52, s55
    s_add_u32 s55, s61, 2048
    v_add_u32 v212, s55, v208
    v_mov_b32 v213, 5120
    v_bfe_u32 v8, v1, 4, 1
    v_and_b32 v9, 15, v1
    v_lshlrev_b32 v9, 4, v9
    v_lshl_add_u32 v8, v8, 9, v9
    s_mov_b32 exec_lo, 0
    v_add_u32 v212, s54, v8
    v_mov_b32 v213, 2048
    s_mov_b32 exec_lo, -1
    v_mov_b32 v219, v8
    v_mad_u32_u24 v214, v213, s48, v212
    s_mul_i32 s33, s40, 2560
    s_add_u32 s33, s33, 61440
    s_xor_b32 s54, s40, 2
    s_mul_i32 s54, s54, 2560
    s_add_u32 s54, s54, 61440
    v_add_u32 v240, s54, v208
    v_add_u32 v242, s54, v21
    v_add_u32 v241, s33, v208
    v_add_u32 v243, s33, v21
    s_lshl_b32 s34, s48, 11
    s_add_u32 s34, s34, s60
    s_mul_i32 s35, s48, 5120
    s_add_u32 s35, s35, s61
    s_lshl_b32 s54, s44, 4
    s_lshl_b32 s36, 0xffff, s54
    s_mov_b32 s37, 0
    s_cmp_eq_u32 s40, 0
    s_cselect_b32 s32, 4, -1
    s_cselect_b32 s101, 3, -1
    s_mul_i32 s54, s40, 6144
    s_xor_b32 s55, s40, 2
    s_mul_i32 s55, s55, 6144
    v_add_u32 v215, s54, v208
    v_add_u32 v216, s55, v208
    v_bfe_u32 v8, v1, 4, 1
    v_lshl_add_u32 v217, v8, 14, v9
    v_lshl_add_u32 v217, v7, 8, v217
    s_lshl_b32 s54, s42, 2
    s_lshl_b32 s55, s44, 1
    s_add_u32 s54, s54, s55
    s_add_u32 s54, s54, s43
    s_lshl_b32 s31, s54, 5
    s_add_u32 s31, s31, s41
    s_lshl_b32 s31, s31, 6
    s_add_u32 s31, s31, 20627456
    s_lshl_b32 s55, s41, 9
    s_lshl_b32 s56, s54, 16
    s_add_u32 s28, s55, s56
    s_add_u32 s28, s28, 14942208
    s_add_u32 s29, s28, 32768
    s_lshl_b32 s56, s54, 14
    s_add_u32 s30, s55, s56
    s_add_u32 s30, s30, 17039360
    s_and_b32 s54, s41, 15
    s_mul_i32 s54, s54, 20
    s_add_u32 s55, s54, 19
    s_lshr_b32 s54, s54, 6
    s_lshr_b32 s55, s55, 6
    s_sub_u32 s55, s55, s54
    v_bfe_u32 v12, v1, 3, 1
    v_mul_u32_u24 v12, s55, v12
    v_add_u32 v12, s54, v12
    v_bfe_u32 v13, v1, 4, 1
    v_mad_u32_u24 v13, v13, 5, 5
    s_lshl_b32 s56, s43, 3
    v_and_b32 v14, 7, v1
    v_add_u32 v14, s56, v14
    s_add_u32 s56, s56, s48
    v_mov_b32 v15, s56
    v_and_b32 v16, 1, v1
    v_lshl_add_u32 v15, v16, 3, v15
    s_lshl_b32 s56, s42, 1
    s_add_u32 s56, s56, s44
    s_mov_b32 exec_lo, 0
    v_mov_b32 v13, 0
    v_mov_b32 v14, s56
    v_add_u32 v15, s56, v16
    s_mov_b32 exec_lo, -1
    v_add_u32 v12, v12, v13
    v_lshl_add_u32 v15, v12, 4, v15
    v_lshl_add_u32 v12, v12, 4, v14
    v_mul_u32_u24 v12, 64, v12
    v_mul_u32_u24 v15, 64, v15
    s_mov_b32 s57, 20856832
    s_cmp_lt_u32 s41, 0
    s_cselect_b32 s57, 20799488, s57
    s_setprio 3
    s_cmp_lg_u32 s40, 0
    s_cbranch_scc1 att_p0_ok
    s_mov_b32 s54, 0x20000
att_p0:
    buffer_load_dword v16, v15, s[24:27], s57 offen sc1
    s_waitcnt vmcnt(0)
    v_cmp_ne_u32 vcc, v16, v11
    s_sub_u32 s54, s54, 1
    s_cbranch_scc1 att_p0_ok
    s_cbranch_vccz att_p0_ok
    s_mov_b64 exec, vcc
    s_sleep 16
    s_branch att_p0
att_p0_ok:
    s_mov_b64 exec, -1
    s_barrier
    s_setprio 1
    s_add_u32 m0, s53, 40960
    s_nop 0
    buffer_load_dwordx4 v2, s[24:27], s34 offen offset:0 sc1 lds
    s_add_u32 m0, s33, 0
    s_nop 0
    buffer_load_dwordx4 v20, s[24:27], s97 offen offset:0 sc1 lds
    s_add_u32 m0, s53, 41472
    s_nop 0
    buffer_load_dwordx4 v2, s[24:27], s34 offen offset:512 sc1 lds
    s_add_u32 m0, s33, 512
    s_nop 0
    buffer_load_dwordx4 v20, s[24:27], s97 offen offset:512 sc1 lds
    s_add_u32 m0, s53, 45056
    s_nop 0
    buffer_load_dwordx4 v214, s[24:27], 0 offen offset:0 sc1 lds
    s_add_u32 m0, s33, 2048
    s_nop 0
    s_mov_b32 exec_hi, 0
    buffer_load_dwordx4 v219, s[24:27], s99 offen offset:0 sc1 lds
    s_mov_b32 exec_hi, -1
    s_add_u32 m0, s53, 43008
    s_nop 0
    buffer_load_dwordx4 v208, s[24:27], s35 offen offset:0 sc1 lds
    buffer_load_dwordx4 v208, s[24:27], s35 offen offset:1024 sc1 lds
    s_mov_b64 exec, s[36:37]
    buffer_load_dword v13, v12, s[24:27], s57 offen sc1
    s_mov_b64 exec, -1
    s_waitcnt vmcnt(1)
    s_barrier
    ds_read_b128 v[128:131], v240 offset:0
    ds_read_b128 v[134:137], v240 offset:1024
    ds_read_b128 v[140:143], v241 offset:0
    ds_read_b128 v[146:149], v241 offset:1024
    s_mov_b32 exec_hi, 0
    ds_read_b64 v[132:133], v242 offset:2048
    ds_read_b64 v[138:139], v242 offset:2304
    ds_read_b64 v[144:145], v243 offset:2048
    ds_read_b64 v[150:151], v243 offset:2304
    s_mov_b32 exec_hi, -1
    ds_read_b128 v[152:155], v209 offset:40960
    ds_read_b64 v[164:165], v210 offset:40960
    s_mov_b64 exec, s[58:59]
    ds_read_b128 v[156:159], v211 offset:40960
    ds_read_b128 v[160:163], v211 offset:41600
    s_mov_b64 exec, -1
    s_waitcnt lgkmcnt(6)
    ds_read_b128 v[166:169], v209 offset:41984
    ds_read_b64 v[178:179], v210 offset:41216
    s_mov_b64 exec, s[58:59]
    ds_read_b128 v[170:173], v211 offset:42240
    ds_read_b128 v[174:177], v211 offset:42880
    s_mov_b64 exec, -1
    ds_read_b128 v[180:183], v209 offset:46080
    ds_read_b64 v[192:193], v210 offset:46080
    s_mov_b64 exec, s[58:59]
    ds_read_b128 v[184:187], v211 offset:46080
    ds_read_b128 v[188:191], v211 offset:46720
    s_mov_b64 exec, -1
    s_mov_b64 exec, s[36:37]
    s_waitcnt vmcnt(0)
    v_cmp_ne_u32 vcc, v13, v11
    s_nop 1
    s_cbranch_vccz att_p1_ok
    s_mov_b32 s54, 0x20000
att_p1:
    buffer_load_dword v13, v12, s[24:27], s57 offen sc1
    s_waitcnt vmcnt(0)
    v_cmp_ne_u32 vcc, v13, v11
    s_sub_u32 s54, s54, 1
    s_cbranch_scc1 att_p1_ok
    s_cbranch_vccz att_p1_ok
    s_mov_b64 exec, vcc
    s_sleep 4
    s_branch att_p1
att_p1_ok:
    s_mov_b64 exec, -1
    s_mov_b64 exec, -1
    s_waitcnt lgkmcnt(0)
    s_barrier
    s_setprio 1
    v_mfma_f32_32x32x16_bf16 v[32:47], v[152:155], v[128:131], 0
    v_mfma_f32_32x32x8_bf16 v[32:47], v[164:165], v[132:133], v[32:47]
    s_nop 11
.p2align 3
att_loopa:
    v_mfma_f32_32x32x16_bf16 v[48:63], v[152:155], v[134:137], 0
    buffer_load_dwordx4 v[194:197], v2, s[24:27], s45 offen offset:1536 sc1
    buffer_load_dwordx2 v[206:207], v3, s[24:27], s46 offen offset:1536 sc1
    v_exp_f32 v32, v32
    v_exp_f32 v33, v33
    v_exp_f32 v34, v34
    v_exp_f32 v35, v35
    v_mfma_f32_32x32x16_bf16 v[112:127], v[202:205], v[28:31], v[112:127]
    s_mov_b64 exec, s[58:59]
    buffer_load_dwordx4 v[198:201], v4, s[24:27], s47 offen offset:3840 sc1
    buffer_load_dwordx4 v[202:205], v5, s[24:27], s47 offen offset:3840 sc1
    s_mov_b64 exec, -1
    v_exp_f32 v36, v36
    v_exp_f32 v37, v37
    v_exp_f32 v38, v38
    v_exp_f32 v39, v39
    v_cvt_pk_bf16_f32 v24, v32, v33
    v_cvt_pk_bf16_f32 v25, v34, v35
    v_mfma_f32_32x32x8_bf16 v[48:63], v[164:165], v[138:139], v[48:63]
    v_exp_f32 v40, v40
    v_cvt_pk_bf16_f32 v26, v36, v37
    v_cvt_pk_bf16_f32 v27, v38, v39
    v_exp_f32 v41, v41
    v_exp_f32 v42, v42
    v_exp_f32 v43, v43
    v_mfma_f32_32x32x16_bf16 v[64:79], v[156:159], v[24:27], v[64:79]
    s_xor_b32 s100, s48, 4
    v_exp_f32 v44, v44
    v_exp_f32 v45, v45
    v_exp_f32 v46, v46
    v_exp_f32 v47, v47
    v_cvt_pk_bf16_f32 v28, v40, v41
    v_cvt_pk_bf16_f32 v29, v42, v43
    v_cvt_pk_bf16_f32 v30, v44, v45
    v_cvt_pk_bf16_f32 v31, v46, v47
    v_mfma_f32_32x32x16_bf16 v[32:47], v[152:155], v[140:143], 0
    s_add_u32 s48, s48, 1
    v_exp_f32 v48, v48
    v_exp_f32 v49, v49
    v_exp_f32 v50, v50
    v_exp_f32 v51, v51
    v_mfma_f32_32x32x16_bf16 v[64:79], v[160:163], v[28:31], v[64:79]
    s_and_b32 s48, s48, 7
    v_exp_f32 v52, v52
    v_exp_f32 v53, v53
    v_exp_f32 v54, v54
    v_exp_f32 v55, v55
    v_cvt_pk_bf16_f32 v24, v48, v49
    v_cvt_pk_bf16_f32 v25, v50, v51
    v_mfma_f32_32x32x8_bf16 v[32:47], v[164:165], v[144:145], v[32:47]
    v_exp_f32 v56, v56
    v_cvt_pk_bf16_f32 v26, v52, v53
    v_cvt_pk_bf16_f32 v27, v54, v55
    v_exp_f32 v57, v57
    v_exp_f32 v58, v58
    v_exp_f32 v59, v59
    v_mfma_f32_32x32x16_bf16 v[80:95], v[156:159], v[24:27], v[80:95]
    s_lshl_b32 s54, s48, 11
    v_exp_f32 v60, v60
    v_exp_f32 v61, v61
    v_exp_f32 v62, v62
    v_exp_f32 v63, v63
    v_cvt_pk_bf16_f32 v28, v56, v57
    v_cvt_pk_bf16_f32 v29, v58, v59
    v_cvt_pk_bf16_f32 v30, v60, v61
    v_cvt_pk_bf16_f32 v31, v62, v63
    v_mfma_f32_32x32x16_bf16 v[48:63], v[152:155], v[146:149], 0
    s_add_u32 s45, s50, s54
    v_exp_f32 v32, v32
    v_exp_f32 v33, v33
    v_exp_f32 v34, v34
    v_exp_f32 v35, v35
    v_mfma_f32_32x32x16_bf16 v[80:95], v[160:163], v[28:31], v[80:95]
    s_add_u32 s46, s51, s54
    v_exp_f32 v36, v36
    v_exp_f32 v37, v37
    v_exp_f32 v38, v38
    v_exp_f32 v39, v39
    v_cvt_pk_bf16_f32 v24, v32, v33
    v_cvt_pk_bf16_f32 v25, v34, v35
    v_mfma_f32_32x32x8_bf16 v[48:63], v[164:165], v[150:151], v[48:63]
    v_exp_f32 v40, v40
    v_cvt_pk_bf16_f32 v26, v36, v37
    v_cvt_pk_bf16_f32 v27, v38, v39
    v_exp_f32 v41, v41
    v_exp_f32 v42, v42
    v_exp_f32 v43, v43
    v_mfma_f32_32x32x16_bf16 v[96:111], v[156:159], v[24:27], v[96:111]
    s_waitcnt vmcnt(8)
    v_exp_f32 v44, v44
    v_exp_f32 v45, v45
    v_exp_f32 v46, v46
    v_exp_f32 v47, v47
    v_cvt_pk_bf16_f32 v28, v40, v41
    v_cvt_pk_bf16_f32 v29, v42, v43
    v_cvt_pk_bf16_f32 v30, v44, v45
    v_cvt_pk_bf16_f32 v31, v46, v47
    v_mfma_f32_32x32x16_bf16 v[32:47], v[166:169], v[128:131], 0
    s_mul_i32 s54, s48, 5120
    v_exp_f32 v48, v48
    v_exp_f32 v49, v49
    v_exp_f32 v50, v50
    v_exp_f32 v51, v51
    v_mfma_f32_32x32x16_bf16 v[96:111], v[160:163], v[28:31], v[96:111]
    s_add_u32 s47, s52, s54
    v_exp_f32 v52, v52
    v_exp_f32 v53, v53
    v_exp_f32 v54, v54
    v_exp_f32 v55, v55
    v_cvt_pk_bf16_f32 v24, v48, v49
    v_cvt_pk_bf16_f32 v25, v50, v51
    v_mfma_f32_32x32x8_bf16 v[32:47], v[178:179], v[132:133], v[32:47]
    v_exp_f32 v56, v56
    v_cvt_pk_bf16_f32 v26, v52, v53
    v_cvt_pk_bf16_f32 v27, v54, v55
    v_exp_f32 v57, v57
    v_exp_f32 v58, v58
    v_exp_f32 v59, v59
    v_mfma_f32_32x32x16_bf16 v[112:127], v[156:159], v[24:27], v[112:127]
    v_exp_f32 v60, v60
    v_exp_f32 v61, v61
    v_exp_f32 v62, v62
    v_exp_f32 v63, v63
    v_cvt_pk_bf16_f32 v28, v56, v57
    v_cvt_pk_bf16_f32 v29, v58, v59
    v_cvt_pk_bf16_f32 v30, v60, v61
    v_cvt_pk_bf16_f32 v31, v62, v63
    v_mfma_f32_32x32x16_bf16 v[48:63], v[166:169], v[134:137], 0
    buffer_load_dwordx4 v[152:155], v2, s[24:27], s45 offen offset:0 sc1
    buffer_load_dwordx2 v[164:165], v3, s[24:27], s46 offen offset:0 sc1
    v_exp_f32 v32, v32
    v_exp_f32 v33, v33
    v_exp_f32 v34, v34
    v_exp_f32 v35, v35
    v_mfma_f32_32x32x16_bf16 v[112:127], v[160:163], v[28:31], v[112:127]
    s_mov_b64 exec, s[58:59]
    buffer_load_dwordx4 v[156:159], v4, s[24:27], s47 offen offset:0 sc1
    buffer_load_dwordx4 v[160:163], v5, s[24:27], s47 offen offset:0 sc1
    s_mov_b64 exec, -1
    v_exp_f32 v36, v36
    v_exp_f32 v37, v37
    v_exp_f32 v38, v38
    v_exp_f32 v39, v39
    v_cvt_pk_bf16_f32 v24, v32, v33
    v_cvt_pk_bf16_f32 v25, v34, v35
    v_mfma_f32_32x32x8_bf16 v[48:63], v[178:179], v[138:139], v[48:63]
    v_exp_f32 v40, v40
    v_cvt_pk_bf16_f32 v26, v36, v37
    v_cvt_pk_bf16_f32 v27, v38, v39
    v_exp_f32 v41, v41
    v_exp_f32 v42, v42
    v_exp_f32 v43, v43
    v_mfma_f32_32x32x16_bf16 v[64:79], v[170:173], v[24:27], v[64:79]
    s_lshl_b32 s54, s100, 11
    v_exp_f32 v44, v44
    v_exp_f32 v45, v45
    v_exp_f32 v46, v46
    v_exp_f32 v47, v47
    v_cvt_pk_bf16_f32 v28, v40, v41
    v_cvt_pk_bf16_f32 v29, v42, v43
    v_cvt_pk_bf16_f32 v30, v44, v45
    v_cvt_pk_bf16_f32 v31, v46, v47
    v_mfma_f32_32x32x16_bf16 v[32:47], v[166:169], v[140:143], 0
    s_mov_b32 m0, s53
    v_exp_f32 v48, v48
    v_exp_f32 v49, v49
    v_exp_f32 v50, v50
    v_exp_f32 v51, v51
    v_mfma_f32_32x32x16_bf16 v[64:79], v[174:177], v[28:31], v[64:79]
    s_add_u32 s54, s54, s60
    buffer_load_dwordx4 v2, s[24:27], s54 offen offset:0 sc1 lds
    v_exp_f32 v52, v52
    v_exp_f32 v53, v53
    v_exp_f32 v54, v54
    v_exp_f32 v55, v55
    v_cvt_pk_bf16_f32 v24, v48, v49
    v_cvt_pk_bf16_f32 v25, v50, v51
    v_mfma_f32_32x32x8_bf16 v[32:47], v[178:179], v[144:145], v[32:47]
    v_exp_f32 v56, v56
    v_cvt_pk_bf16_f32 v26, v52, v53
    v_cvt_pk_bf16_f32 v27, v54, v55
    v_exp_f32 v57, v57
    v_exp_f32 v58, v58
    v_exp_f32 v59, v59
    v_mfma_f32_32x32x16_bf16 v[80:95], v[170:173], v[24:27], v[80:95]
    s_add_u32 m0, s53, 512
    v_exp_f32 v60, v60
    v_exp_f32 v61, v61
    v_exp_f32 v62, v62
    v_exp_f32 v63, v63
    v_cvt_pk_bf16_f32 v28, v56, v57
    v_cvt_pk_bf16_f32 v29, v58, v59
    v_cvt_pk_bf16_f32 v30, v60, v61
    v_cvt_pk_bf16_f32 v31, v62, v63
    v_mfma_f32_32x32x16_bf16 v[48:63], v[166:169], v[146:149], 0
    s_mul_i32 s55, s100, 5120
    buffer_load_dwordx4 v2, s[24:27], s54 offen offset:512 sc1 lds
    v_exp_f32 v32, v32
    v_exp_f32 v33, v33
    v_exp_f32 v34, v34
    v_exp_f32 v35, v35
    v_mfma_f32_32x32x16_bf16 v[80:95], v[174:177], v[28:31], v[80:95]
    s_add_u32 m0, s53, 2048
    v_exp_f32 v36, v36
    v_exp_f32 v37, v37
    v_exp_f32 v38, v38
    v_exp_f32 v39, v39
    v_cvt_pk_bf16_f32 v24, v32, v33
    v_cvt_pk_bf16_f32 v25, v34, v35
    v_mfma_f32_32x32x8_bf16 v[48:63], v[178:179], v[150:151], v[48:63]
    v_exp_f32 v40, v40
    v_cvt_pk_bf16_f32 v26, v36, v37
    v_cvt_pk_bf16_f32 v27, v38, v39
    v_exp_f32 v41, v41
    v_exp_f32 v42, v42
    v_exp_f32 v43, v43
    v_mfma_f32_32x32x16_bf16 v[96:111], v[170:173], v[24:27], v[96:111]
    s_waitcnt vmcnt(10)
    v_exp_f32 v44, v44
    v_exp_f32 v45, v45
    v_exp_f32 v46, v46
    v_exp_f32 v47, v47
    v_cvt_pk_bf16_f32 v28, v40, v41
    v_cvt_pk_bf16_f32 v29, v42, v43
    v_cvt_pk_bf16_f32 v30, v44, v45
    v_cvt_pk_bf16_f32 v31, v46, v47
    v_mfma_f32_32x32x16_bf16 v[32:47], v[180:183], v[128:131], 0
    v_exp_f32 v48, v48
    v_exp_f32 v49, v49
    v_exp_f32 v50, v50
    v_exp_f32 v51, v51
    v_mfma_f32_32x32x16_bf16 v[96:111], v[174:177], v[28:31], v[96:111]
    v_exp_f32 v52, v52
    v_exp_f32 v53, v53
    v_exp_f32 v54, v54
    v_exp_f32 v55, v55
    v_cvt_pk_bf16_f32 v24, v48, v49
    v_cvt_pk_bf16_f32 v25, v50, v51
    v_mfma_f32_32x32x8_bf16 v[32:47], v[192:193], v[132:133], v[32:47]
    v_exp_f32 v56, v56
    v_cvt_pk_bf16_f32 v26, v52, v53
    v_cvt_pk_bf16_f32 v27, v54, v55
    v_exp_f32 v57, v57
    v_exp_f32 v58, v58
    v_exp_f32 v59, v59
    v_mfma_f32_32x32x16_bf16 v[112:127], v[170:173], v[24:27], v[112:127]
    v_exp_f32 v60, v60
    v_exp_f32 v61, v61
    v_exp_f32 v62, v62
    v_exp_f32 v63, v63
    v_cvt_pk_bf16_f32 v28, v56, v57
    v_cvt_pk_bf16_f32 v29, v58, v59
    v_cvt_pk_bf16_f32 v30, v60, v61
    v_cvt_pk_bf16_f32 v31, v62, v63
    v_mfma_f32_32x32x16_bf16 v[48:63], v[180:183], v[134:137], 0
    buffer_load_dwordx4 v[166:169], v2, s[24:27], s45 offen offset:512 sc1
    buffer_load_dwordx2 v[178:179], v3, s[24:27], s46 offen offset:512 sc1
    v_exp_f32 v32, v32
    v_exp_f32 v33, v33
    v_exp_f32 v34, v34
    v_exp_f32 v35, v35
    v_mfma_f32_32x32x16_bf16 v[112:127], v[174:177], v[28:31], v[112:127]
    s_mov_b64 exec, s[58:59]
    buffer_load_dwordx4 v[170:173], v4, s[24:27], s47 offen offset:1280 sc1
    buffer_load_dwordx4 v[174:177], v5, s[24:27], s47 offen offset:1280 sc1
    s_mov_b64 exec, -1
    v_exp_f32 v36, v36
    v_exp_f32 v37, v37
    v_exp_f32 v38, v38
    v_exp_f32 v39, v39
    v_cvt_pk_bf16_f32 v24, v32, v33
    v_cvt_pk_bf16_f32 v25, v34, v35
    v_mfma_f32_32x32x8_bf16 v[48:63], v[192:193], v[138:139], v[48:63]
    v_exp_f32 v40, v40
    v_cvt_pk_bf16_f32 v26, v36, v37
    v_cvt_pk_bf16_f32 v27, v38, v39
    v_exp_f32 v41, v41
    v_exp_f32 v42, v42
    v_exp_f32 v43, v43
    v_mfma_f32_32x32x16_bf16 v[64:79], v[184:187], v[24:27], v[64:79]
    s_add_u32 s55, s55, s61
    buffer_load_dwordx4 v208, s[24:27], s55 offen offset:0 sc1 lds
    v_exp_f32 v44, v44
    v_exp_f32 v45, v45
    v_exp_f32 v46, v46
    v_exp_f32 v47, v47
    v_cvt_pk_bf16_f32 v28, v40, v41
    v_cvt_pk_bf16_f32 v29, v42, v43
    v_cvt_pk_bf16_f32 v30, v44, v45
    v_cvt_pk_bf16_f32 v31, v46, v47
    v_mfma_f32_32x32x16_bf16 v[32:47], v[180:183], v[140:143], 0
    v_mad_u32_u24 v214, v213, s100, v212
    v_exp_f32 v48, v48
    v_exp_f32 v49, v49
    v_exp_f32 v50, v50
    v_exp_f32 v51, v51
    v_mfma_f32_32x32x16_bf16 v[64:79], v[188:191], v[28:31], v[64:79]
    buffer_load_dwordx4 v208, s[24:27], s55 offen offset:1024 sc1 lds
    v_exp_f32 v52, v52
    v_exp_f32 v53, v53
    v_exp_f32 v54, v54
    v_exp_f32 v55, v55
    v_cvt_pk_bf16_f32 v24, v48, v49
    v_cvt_pk_bf16_f32 v25, v50, v51
    v_mfma_f32_32x32x8_bf16 v[32:47], v[192:193], v[144:145], v[32:47]
    v_exp_f32 v56, v56
    v_cvt_pk_bf16_f32 v26, v52, v53
    v_cvt_pk_bf16_f32 v27, v54, v55
    v_exp_f32 v57, v57
    v_exp_f32 v58, v58
    v_exp_f32 v59, v59
    v_mfma_f32_32x32x16_bf16 v[80:95], v[184:187], v[24:27], v[80:95]
    s_add_u32 m0, s53, 4096
    v_exp_f32 v60, v60
    v_exp_f32 v61, v61
    v_exp_f32 v62, v62
    v_exp_f32 v63, v63
    v_cvt_pk_bf16_f32 v28, v56, v57
    v_cvt_pk_bf16_f32 v29, v58, v59
    v_cvt_pk_bf16_f32 v30, v60, v61
    v_cvt_pk_bf16_f32 v31, v62, v63
    v_mfma_f32_32x32x16_bf16 v[48:63], v[180:183], v[146:149], 0
    s_add_u32 s53, s53, 20480
    buffer_load_dwordx4 v214, s[24:27], 0 offen offset:0 sc1 lds
    v_exp_f32 v32, v32
    v_exp_f32 v33, v33
    v_exp_f32 v34, v34
    v_exp_f32 v35, v35
    v_mfma_f32_32x32x16_bf16 v[80:95], v[188:191], v[28:31], v[80:95]
    v_exp_f32 v36, v36
    v_exp_f32 v37, v37
    v_exp_f32 v38, v38
    v_exp_f32 v39, v39
    v_cvt_pk_bf16_f32 v24, v32, v33
    v_cvt_pk_bf16_f32 v25, v34, v35
    v_mfma_f32_32x32x8_bf16 v[48:63], v[192:193], v[150:151], v[48:63]
    v_exp_f32 v40, v40
    v_cvt_pk_bf16_f32 v26, v36, v37
    v_cvt_pk_bf16_f32 v27, v38, v39
    v_exp_f32 v41, v41
    v_exp_f32 v42, v42
    v_exp_f32 v43, v43
    v_mfma_f32_32x32x16_bf16 v[96:111], v[184:187], v[24:27], v[96:111]
    s_waitcnt vmcnt(13)
    v_exp_f32 v44, v44
    v_exp_f32 v45, v45
    v_exp_f32 v46, v46
    v_exp_f32 v47, v47
    v_cvt_pk_bf16_f32 v28, v40, v41
    v_cvt_pk_bf16_f32 v29, v42, v43
    v_cvt_pk_bf16_f32 v30, v44, v45
    v_cvt_pk_bf16_f32 v31, v46, v47
    v_mfma_f32_32x32x16_bf16 v[32:47], v[194:197], v[128:131], 0
    v_exp_f32 v48, v48
    v_exp_f32 v49, v49
    v_exp_f32 v50, v50
    v_exp_f32 v51, v51
    v_mfma_f32_32x32x16_bf16 v[96:111], v[188:191], v[28:31], v[96:111]
    v_exp_f32 v52, v52
    v_exp_f32 v53, v53
    v_exp_f32 v54, v54
    v_exp_f32 v55, v55
    v_cvt_pk_bf16_f32 v24, v48, v49
    v_cvt_pk_bf16_f32 v25, v50, v51
    v_mfma_f32_32x32x8_bf16 v[32:47], v[206:207], v[132:133], v[32:47]
    v_exp_f32 v56, v56
    v_cvt_pk_bf16_f32 v26, v52, v53
    v_cvt_pk_bf16_f32 v27, v54, v55
    v_exp_f32 v57, v57
    v_exp_f32 v58, v58
    v_exp_f32 v59, v59
    v_mfma_f32_32x32x16_bf16 v[112:127], v[184:187], v[24:27], v[112:127]
    v_exp_f32 v60, v60
    v_exp_f32 v61, v61
    v_exp_f32 v62, v62
    v_exp_f32 v63, v63
    v_cvt_pk_bf16_f32 v28, v56, v57
    v_cvt_pk_bf16_f32 v29, v58, v59
    v_cvt_pk_bf16_f32 v30, v60, v61
    v_cvt_pk_bf16_f32 v31, v62, v63
    v_mfma_f32_32x32x16_bf16 v[48:63], v[194:197], v[134:137], 0
    buffer_load_dwordx4 v[180:183], v2, s[24:27], s45 offen offset:1024 sc1
    buffer_load_dwordx2 v[192:193], v3, s[24:27], s46 offen offset:1024 sc1
    v_exp_f32 v32, v32
    v_exp_f32 v33, v33
    v_exp_f32 v34, v34
    v_exp_f32 v35, v35
    v_mfma_f32_32x32x16_bf16 v[112:127], v[188:191], v[28:31], v[112:127]
    s_mov_b64 exec, s[58:59]
    buffer_load_dwordx4 v[184:187], v4, s[24:27], s47 offen offset:2560 sc1
    buffer_load_dwordx4 v[188:191], v5, s[24:27], s47 offen offset:2560 sc1
    s_mov_b64 exec, -1
    v_exp_f32 v36, v36
    v_exp_f32 v37, v37
    v_exp_f32 v38, v38
    v_exp_f32 v39, v39
    v_cvt_pk_bf16_f32 v24, v32, v33
    v_cvt_pk_bf16_f32 v25, v34, v35
    v_mfma_f32_32x32x8_bf16 v[48:63], v[206:207], v[138:139], v[48:63]
    v_exp_f32 v40, v40
    v_cvt_pk_bf16_f32 v26, v36, v37
    v_cvt_pk_bf16_f32 v27, v38, v39
    v_exp_f32 v41, v41
    v_exp_f32 v42, v42
    v_exp_f32 v43, v43
    v_mfma_f32_32x32x16_bf16 v[64:79], v[198:201], v[24:27], v[64:79]
    s_sub_u32 s49, s49, 1
    v_exp_f32 v44, v44
    v_exp_f32 v45, v45
    v_exp_f32 v46, v46
    v_exp_f32 v47, v47
    v_cvt_pk_bf16_f32 v28, v40, v41
    v_cvt_pk_bf16_f32 v29, v42, v43
    v_cvt_pk_bf16_f32 v30, v44, v45
    v_cvt_pk_bf16_f32 v31, v46, v47
    v_mfma_f32_32x32x16_bf16 v[32:47], v[194:197], v[140:143], 0
    s_cmp_lg_u32 s49, 0
    v_exp_f32 v48, v48
    v_exp_f32 v49, v49
    v_exp_f32 v50, v50
    v_exp_f32 v51, v51
    v_mfma_f32_32x32x16_bf16 v[64:79], v[202:205], v[28:31], v[64:79]
    v_exp_f32 v52, v52
    v_exp_f32 v53, v53
    v_exp_f32 v54, v54
    v_exp_f32 v55, v55
    v_cvt_pk_bf16_f32 v24, v48, v49
    v_cvt_pk_bf16_f32 v25, v50, v51
    v_mfma_f32_32x32x8_bf16 v[32:47], v[206:207], v[144:145], v[32:47]
    v_exp_f32 v56, v56
    v_cvt_pk_bf16_f32 v26, v52, v53
    v_cvt_pk_bf16_f32 v27, v54, v55
    v_exp_f32 v57, v57
    v_exp_f32 v58, v58
    v_exp_f32 v59, v59
    v_mfma_f32_32x32x16_bf16 v[80:95], v[198:201], v[24:27], v[80:95]
    v_exp_f32 v60, v60
    v_exp_f32 v61, v61
    v_exp_f32 v62, v62
    v_exp_f32 v63, v63
    v_cvt_pk_bf16_f32 v28, v56, v57
    v_cvt_pk_bf16_f32 v29, v58, v59
    v_cvt_pk_bf16_f32 v30, v60, v61
    v_cvt_pk_bf16_f32 v31, v62, v63
    v_mfma_f32_32x32x16_bf16 v[48:63], v[194:197], v[146:149], 0
    v_exp_f32 v32, v32
    v_exp_f32 v33, v33
    v_exp_f32 v34, v34
    v_exp_f32 v35, v35
    v_mfma_f32_32x32x16_bf16 v[80:95], v[202:205], v[28:31], v[80:95]
    v_exp_f32 v36, v36
    v_exp_f32 v37, v37
    v_exp_f32 v38, v38
    v_exp_f32 v39, v39
    v_cvt_pk_bf16_f32 v24, v32, v33
    v_cvt_pk_bf16_f32 v25, v34, v35
    v_mfma_f32_32x32x8_bf16 v[48:63], v[206:207], v[150:151], v[48:63]
    v_exp_f32 v40, v40
    v_cvt_pk_bf16_f32 v26, v36, v37
    v_cvt_pk_bf16_f32 v27, v38, v39
    v_exp_f32 v41, v41
    v_exp_f32 v42, v42
    v_exp_f32 v43, v43
    v_mfma_f32_32x32x16_bf16 v[96:111], v[198:201], v[24:27], v[96:111]
    s_waitcnt vmcnt(11)
    v_exp_f32 v44, v44
    v_exp_f32 v45, v45
    v_exp_f32 v46, v46
    v_exp_f32 v47, v47
    v_cvt_pk_bf16_f32 v28, v40, v41
    v_cvt_pk_bf16_f32 v29, v42, v43
    v_cvt_pk_bf16_f32 v30, v44, v45
    v_cvt_pk_bf16_f32 v31, v46, v47
    v_mfma_f32_32x32x16_bf16 v[32:47], v[152:155], v[128:131], 0
    v_exp_f32 v48, v48
    v_exp_f32 v49, v49
    v_exp_f32 v50, v50
    v_exp_f32 v51, v51
    v_mfma_f32_32x32x16_bf16 v[96:111], v[202:205], v[28:31], v[96:111]
    v_exp_f32 v52, v52
    v_exp_f32 v53, v53
    v_exp_f32 v54, v54
    v_exp_f32 v55, v55
    v_cvt_pk_bf16_f32 v24, v48, v49
    v_cvt_pk_bf16_f32 v25, v50, v51
    v_mfma_f32_32x32x8_bf16 v[32:47], v[164:165], v[132:133], v[32:47]
    v_exp_f32 v56, v56
    v_cvt_pk_bf16_f32 v26, v52, v53
    v_cvt_pk_bf16_f32 v27, v54, v55
    v_exp_f32 v57, v57
    v_exp_f32 v58, v58
    v_exp_f32 v59, v59
    v_mfma_f32_32x32x16_bf16 v[112:127], v[198:201], v[24:27], v[112:127]
    v_exp_f32 v60, v60
    v_exp_f32 v61, v61
    v_exp_f32 v62, v62
    v_exp_f32 v63, v63
    v_cvt_pk_bf16_f32 v28, v56, v57
    v_cvt_pk_bf16_f32 v29, v58, v59
    v_cvt_pk_bf16_f32 v30, v60, v61
    v_cvt_pk_bf16_f32 v31, v62, v63
    s_cbranch_scc1 att_loopa
    s_mov_b32 s49, 4
    s_waitcnt vmcnt(4)
    s_barrier
    s_branch att_loopb
att_ha:
    s_and_b32 s32, s2, 255
    s_lshl_b32 s32, s32, 6
    s_add_u32 s32, s32, 20783136
    s_mov_b64 exec, 1
    buffer_store_dword v11, off, s[24:27], s32 sc1
    s_mov_b64 exec, -1
    s_branch att_har
att_mb:
    s_barrier
    s_branch att_mbr
.p2align 3
att_loopb:
    v_mfma_f32_32x32x16_bf16 v[48:63], v[152:155], v[134:137], 0
    ds_read_b128 v[194:197], v209 offset:6144
    ds_read_b64 v[206:207], v210 offset:5376
    v_exp_f32 v32, v32
    v_exp_f32 v33, v33
    v_exp_f32 v34, v34
    v_exp_f32 v35, v35
    v_mfma_f32_32x32x16_bf16 v[112:127], v[202:205], v[28:31], v[112:127]
    s_mov_b64 exec, s[58:59]
    ds_read_b128 v[198:201], v211 offset:6400
    ds_read_b128 v[202:205], v211 offset:7040
    s_mov_b64 exec, -1
    v_exp_f32 v36, v36
    v_exp_f32 v37, v37
    v_exp_f32 v38, v38
    v_exp_f32 v39, v39
    v_cvt_pk_bf16_f32 v24, v32, v33
    v_cvt_pk_bf16_f32 v25, v34, v35
    v_mfma_f32_32x32x8_bf16 v[48:63], v[164:165], v[138:139], v[48:63]
    v_exp_f32 v40, v40
    v_cvt_pk_bf16_f32 v26, v36, v37
    v_cvt_pk_bf16_f32 v27, v38, v39
    v_exp_f32 v41, v41
    v_exp_f32 v42, v42
    v_exp_f32 v43, v43
    v_mfma_f32_32x32x16_bf16 v[64:79], v[156:159], v[24:27], v[64:79]
    v_exp_f32 v44, v44
    v_exp_f32 v45, v45
    v_exp_f32 v46, v46
    v_exp_f32 v47, v47
    v_cvt_pk_bf16_f32 v28, v40, v41
    v_cvt_pk_bf16_f32 v29, v42, v43
    v_cvt_pk_bf16_f32 v30, v44, v45
    v_cvt_pk_bf16_f32 v31, v46, v47
    v_mfma_f32_32x32x16_bf16 v[32:47], v[152:155], v[140:143], 0
    v_exp_f32 v48, v48
    v_exp_f32 v49, v49
    v_exp_f32 v50, v50
    v_exp_f32 v51, v51
    v_mfma_f32_32x32x16_bf16 v[64:79], v[160:163], v[28:31], v[64:79]
    v_exp_f32 v52, v52
    v_exp_f32 v53, v53
    v_exp_f32 v54, v54
    v_exp_f32 v55, v55
    v_cvt_pk_bf16_f32 v24, v48, v49
    v_cvt_pk_bf16_f32 v25, v50, v51
    v_mfma_f32_32x32x8_bf16 v[32:47], v[164:165], v[144:145], v[32:47]
    v_exp_f32 v56, v56
    v_cvt_pk_bf16_f32 v26, v52, v53
    v_cvt_pk_bf16_f32 v27, v54, v55
    v_exp_f32 v57, v57
    v_exp_f32 v58, v58
    v_exp_f32 v59, v59
    v_mfma_f32_32x32x16_bf16 v[80:95], v[156:159], v[24:27], v[80:95]
    v_exp_f32 v60, v60
    v_exp_f32 v61, v61
    v_exp_f32 v62, v62
    v_exp_f32 v63, v63
    v_cvt_pk_bf16_f32 v28, v56, v57
    v_cvt_pk_bf16_f32 v29, v58, v59
    v_cvt_pk_bf16_f32 v30, v60, v61
    v_cvt_pk_bf16_f32 v31, v62, v63
    v_mfma_f32_32x32x16_bf16 v[48:63], v[152:155], v[146:149], 0
    v_exp_f32 v32, v32
    v_exp_f32 v33, v33
    v_exp_f32 v34, v34
    v_exp_f32 v35, v35
    v_mfma_f32_32x32x16_bf16 v[80:95], v[160:163], v[28:31], v[80:95]
    v_exp_f32 v36, v36
    v_exp_f32 v37, v37
    v_exp_f32 v38, v38
    v_exp_f32 v39, v39
    v_cvt_pk_bf16_f32 v24, v32, v33
    v_cvt_pk_bf16_f32 v25, v34, v35
    v_mfma_f32_32x32x8_bf16 v[48:63], v[164:165], v[150:151], v[48:63]
    v_exp_f32 v40, v40
    v_cvt_pk_bf16_f32 v26, v36, v37
    v_cvt_pk_bf16_f32 v27, v38, v39
    v_exp_f32 v41, v41
    v_exp_f32 v42, v42
    v_exp_f32 v43, v43
    v_mfma_f32_32x32x16_bf16 v[96:111], v[156:159], v[24:27], v[96:111]
    s_waitcnt vmcnt(0) lgkmcnt(8)
    v_exp_f32 v44, v44
    v_exp_f32 v45, v45
    v_exp_f32 v46, v46
    v_exp_f32 v47, v47
    v_cvt_pk_bf16_f32 v28, v40, v41
    v_cvt_pk_bf16_f32 v29, v42, v43
    v_cvt_pk_bf16_f32 v30, v44, v45
    v_cvt_pk_bf16_f32 v31, v46, v47
    v_mfma_f32_32x32x16_bf16 v[32:47], v[166:169], v[128:131], 0
    v_exp_f32 v48, v48
    v_exp_f32 v49, v49
    v_exp_f32 v50, v50
    v_exp_f32 v51, v51
    v_mfma_f32_32x32x16_bf16 v[96:111], v[160:163], v[28:31], v[96:111]
    v_exp_f32 v52, v52
    v_exp_f32 v53, v53
    v_exp_f32 v54, v54
    v_exp_f32 v55, v55
    v_cvt_pk_bf16_f32 v24, v48, v49
    v_cvt_pk_bf16_f32 v25, v50, v51
    v_mfma_f32_32x32x8_bf16 v[32:47], v[178:179], v[132:133], v[32:47]
    v_exp_f32 v56, v56
    v_cvt_pk_bf16_f32 v26, v52, v53
    v_cvt_pk_bf16_f32 v27, v54, v55
    v_exp_f32 v57, v57
    v_exp_f32 v58, v58
    v_exp_f32 v59, v59
    v_mfma_f32_32x32x16_bf16 v[112:127], v[156:159], v[24:27], v[112:127]
    v_exp_f32 v60, v60
    v_exp_f32 v61, v61
    v_exp_f32 v62, v62
    v_exp_f32 v63, v63
    v_cvt_pk_bf16_f32 v28, v56, v57
    v_cvt_pk_bf16_f32 v29, v58, v59
    v_cvt_pk_bf16_f32 v30, v60, v61
    v_cvt_pk_bf16_f32 v31, v62, v63
    v_mfma_f32_32x32x16_bf16 v[48:63], v[166:169], v[134:137], 0
    ds_read_b128 v[152:155], v209 offset:20480
    ds_read_b64 v[164:165], v210 offset:20480
    v_exp_f32 v32, v32
    v_exp_f32 v33, v33
    v_exp_f32 v34, v34
    v_exp_f32 v35, v35
    v_mfma_f32_32x32x16_bf16 v[112:127], v[160:163], v[28:31], v[112:127]
    s_mov_b64 exec, s[58:59]
    ds_read_b128 v[156:159], v211 offset:20480
    ds_read_b128 v[160:163], v211 offset:21120
    s_mov_b64 exec, -1
    v_exp_f32 v36, v36
    v_exp_f32 v37, v37
    v_exp_f32 v38, v38
    v_exp_f32 v39, v39
    v_cvt_pk_bf16_f32 v24, v32, v33
    v_cvt_pk_bf16_f32 v25, v34, v35
    v_mfma_f32_32x32x8_bf16 v[48:63], v[178:179], v[138:139], v[48:63]
    v_exp_f32 v40, v40
    v_cvt_pk_bf16_f32 v26, v36, v37
    v_cvt_pk_bf16_f32 v27, v38, v39
    v_exp_f32 v41, v41
    v_exp_f32 v42, v42
    v_exp_f32 v43, v43
    v_mfma_f32_32x32x16_bf16 v[64:79], v[170:173], v[24:27], v[64:79]
    s_cmp_eq_u32 s49, 1
    v_exp_f32 v44, v44
    v_exp_f32 v45, v45
    v_exp_f32 v46, v46
    v_exp_f32 v47, v47
    v_cvt_pk_bf16_f32 v28, v40, v41
    v_cvt_pk_bf16_f32 v29, v42, v43
    v_cvt_pk_bf16_f32 v30, v44, v45
    v_cvt_pk_bf16_f32 v31, v46, v47
    v_mfma_f32_32x32x16_bf16 v[32:47], v[166:169], v[140:143], 0
    s_cbranch_scc1 att_mb
att_mbr:
    v_exp_f32 v48, v48
    v_exp_f32 v49, v49
    v_exp_f32 v50, v50
    v_exp_f32 v51, v51
    v_mfma_f32_32x32x16_bf16 v[64:79], v[174:177], v[28:31], v[64:79]
    v_exp_f32 v52, v52
    v_exp_f32 v53, v53
    v_exp_f32 v54, v54
    v_exp_f32 v55, v55
    v_cvt_pk_bf16_f32 v24, v48, v49
    v_cvt_pk_bf16_f32 v25, v50, v51
    v_mfma_f32_32x32x8_bf16 v[32:47], v[178:179], v[144:145], v[32:47]
    v_exp_f32 v56, v56
    v_cvt_pk_bf16_f32 v26, v52, v53
    v_cvt_pk_bf16_f32 v27, v54, v55
    v_exp_f32 v57, v57
    v_exp_f32 v58, v58
    v_exp_f32 v59, v59
    v_mfma_f32_32x32x16_bf16 v[80:95], v[170:173], v[24:27], v[80:95]
    v_exp_f32 v60, v60
    v_exp_f32 v61, v61
    v_exp_f32 v62, v62
    v_exp_f32 v63, v63
    v_cvt_pk_bf16_f32 v28, v56, v57
    v_cvt_pk_bf16_f32 v29, v58, v59
    v_cvt_pk_bf16_f32 v30, v60, v61
    v_cvt_pk_bf16_f32 v31, v62, v63
    v_mfma_f32_32x32x16_bf16 v[48:63], v[166:169], v[146:149], 0
    v_exp_f32 v32, v32
    v_exp_f32 v33, v33
    v_exp_f32 v34, v34
    v_exp_f32 v35, v35
    v_mfma_f32_32x32x16_bf16 v[80:95], v[174:177], v[28:31], v[80:95]
    v_exp_f32 v36, v36
    v_exp_f32 v37, v37
    v_exp_f32 v38, v38
    v_exp_f32 v39, v39
    v_cvt_pk_bf16_f32 v24, v32, v33
    v_cvt_pk_bf16_f32 v25, v34, v35
    v_mfma_f32_32x32x8_bf16 v[48:63], v[178:179], v[150:151], v[48:63]
    v_exp_f32 v40, v40
    v_cvt_pk_bf16_f32 v26, v36, v37
    v_cvt_pk_bf16_f32 v27, v38, v39
    v_exp_f32 v41, v41
    v_exp_f32 v42, v42
    v_exp_f32 v43, v43
    v_mfma_f32_32x32x16_bf16 v[96:111], v[170:173], v[24:27], v[96:111]
    s_waitcnt lgkmcnt(8)
    v_exp_f32 v44, v44
    v_exp_f32 v45, v45
    v_exp_f32 v46, v46
    v_exp_f32 v47, v47
    v_cvt_pk_bf16_f32 v28, v40, v41
    v_cvt_pk_bf16_f32 v29, v42, v43
    v_cvt_pk_bf16_f32 v30, v44, v45
    v_cvt_pk_bf16_f32 v31, v46, v47
    v_mfma_f32_32x32x16_bf16 v[32:47], v[180:183], v[128:131], 0
    v_exp_f32 v48, v48
    v_exp_f32 v49, v49
    v_exp_f32 v50, v50
    v_exp_f32 v51, v51
    v_mfma_f32_32x32x16_bf16 v[96:111], v[174:177], v[28:31], v[96:111]
    v_exp_f32 v52, v52
    v_exp_f32 v53, v53
    v_exp_f32 v54, v54
    v_exp_f32 v55, v55
    v_cvt_pk_bf16_f32 v24, v48, v49
    v_cvt_pk_bf16_f32 v25, v50, v51
    v_mfma_f32_32x32x8_bf16 v[32:47], v[192:193], v[132:133], v[32:47]
    v_exp_f32 v56, v56
    v_cvt_pk_bf16_f32 v26, v52, v53
    v_cvt_pk_bf16_f32 v27, v54, v55
    v_exp_f32 v57, v57
    v_exp_f32 v58, v58
    v_exp_f32 v59, v59
    v_mfma_f32_32x32x16_bf16 v[112:127], v[170:173], v[24:27], v[112:127]
    v_exp_f32 v60, v60
    v_exp_f32 v61, v61
    v_exp_f32 v62, v62
    v_exp_f32 v63, v63
    v_cvt_pk_bf16_f32 v28, v56, v57
    v_cvt_pk_bf16_f32 v29, v58, v59
    v_cvt_pk_bf16_f32 v30, v60, v61
    v_cvt_pk_bf16_f32 v31, v62, v63
    v_mfma_f32_32x32x16_bf16 v[48:63], v[180:183], v[134:137], 0
    ds_read_b128 v[166:169], v209 offset:21504
    ds_read_b64 v[178:179], v210 offset:20736
    v_exp_f32 v32, v32
    v_exp_f32 v33, v33
    v_exp_f32 v34, v34
    v_exp_f32 v35, v35
    v_mfma_f32_32x32x16_bf16 v[112:127], v[174:177], v[28:31], v[112:127]
    s_mov_b64 exec, s[58:59]
    ds_read_b128 v[170:173], v211 offset:21760
    ds_read_b128 v[174:177], v211 offset:22400
    s_mov_b64 exec, -1
    v_exp_f32 v36, v36
    v_exp_f32 v37, v37
    v_exp_f32 v38, v38
    v_exp_f32 v39, v39
    v_cvt_pk_bf16_f32 v24, v32, v33
    v_cvt_pk_bf16_f32 v25, v34, v35
    v_mfma_f32_32x32x8_bf16 v[48:63], v[192:193], v[138:139], v[48:63]
    v_exp_f32 v40, v40
    v_cvt_pk_bf16_f32 v26, v36, v37
    v_cvt_pk_bf16_f32 v27, v38, v39
    v_exp_f32 v41, v41
    v_exp_f32 v42, v42
    v_exp_f32 v43, v43
    v_mfma_f32_32x32x16_bf16 v[64:79], v[184:187], v[24:27], v[64:79]
    v_exp_f32 v44, v44
    v_exp_f32 v45, v45
    v_exp_f32 v46, v46
    v_exp_f32 v47, v47
    v_cvt_pk_bf16_f32 v28, v40, v41
    v_cvt_pk_bf16_f32 v29, v42, v43
    v_cvt_pk_bf16_f32 v30, v44, v45
    v_cvt_pk_bf16_f32 v31, v46, v47
    v_mfma_f32_32x32x16_bf16 v[32:47], v[180:183], v[140:143], 0
    v_exp_f32 v48, v48
    v_exp_f32 v49, v49
    v_exp_f32 v50, v50
    v_exp_f32 v51, v51
    v_mfma_f32_32x32x16_bf16 v[64:79], v[188:191], v[28:31], v[64:79]
    v_exp_f32 v52, v52
    v_exp_f32 v53, v53
    v_exp_f32 v54, v54
    v_exp_f32 v55, v55
    v_cvt_pk_bf16_f32 v24, v48, v49
    v_cvt_pk_bf16_f32 v25, v50, v51
    v_mfma_f32_32x32x8_bf16 v[32:47], v[192:193], v[144:145], v[32:47]
    v_exp_f32 v56, v56
    v_cvt_pk_bf16_f32 v26, v52, v53
    v_cvt_pk_bf16_f32 v27, v54, v55
    v_exp_f32 v57, v57
    v_exp_f32 v58, v58
    v_exp_f32 v59, v59
    v_mfma_f32_32x32x16_bf16 v[80:95], v[184:187], v[24:27], v[80:95]
    v_exp_f32 v60, v60
    v_exp_f32 v61, v61
    v_exp_f32 v62, v62
    v_exp_f32 v63, v63
    v_cvt_pk_bf16_f32 v28, v56, v57
    v_cvt_pk_bf16_f32 v29, v58, v59
    v_cvt_pk_bf16_f32 v30, v60, v61
    v_cvt_pk_bf16_f32 v31, v62, v63
    v_mfma_f32_32x32x16_bf16 v[48:63], v[180:183], v[146:149], 0
    v_exp_f32 v32, v32
    v_exp_f32 v33, v33
    v_exp_f32 v34, v34
    v_exp_f32 v35, v35
    v_mfma_f32_32x32x16_bf16 v[80:95], v[188:191], v[28:31], v[80:95]
    v_exp_f32 v36, v36
    v_exp_f32 v37, v37
    v_exp_f32 v38, v38
    v_exp_f32 v39, v39
    v_cvt_pk_bf16_f32 v24, v32, v33
    v_cvt_pk_bf16_f32 v25, v34, v35
    v_mfma_f32_32x32x8_bf16 v[48:63], v[192:193], v[150:151], v[48:63]
    v_exp_f32 v40, v40
    v_cvt_pk_bf16_f32 v26, v36, v37
    v_cvt_pk_bf16_f32 v27, v38, v39
    v_exp_f32 v41, v41
    v_exp_f32 v42, v42
    v_exp_f32 v43, v43
    v_mfma_f32_32x32x16_bf16 v[96:111], v[184:187], v[24:27], v[96:111]
    s_waitcnt lgkmcnt(8)
    v_exp_f32 v44, v44
    v_exp_f32 v45, v45
    v_exp_f32 v46, v46
    v_exp_f32 v47, v47
    v_cvt_pk_bf16_f32 v28, v40, v41
    v_cvt_pk_bf16_f32 v29, v42, v43
    v_cvt_pk_bf16_f32 v30, v44, v45
    v_cvt_pk_bf16_f32 v31, v46, v47
    v_mfma_f32_32x32x16_bf16 v[32:47], v[194:197], v[128:131], 0
    v_exp_f32 v48, v48
    v_exp_f32 v49, v49
    v_exp_f32 v50, v50
    v_exp_f32 v51, v51
    v_mfma_f32_32x32x16_bf16 v[96:111], v[188:191], v[28:31], v[96:111]
    v_exp_f32 v52, v52
    v_exp_f32 v53, v53
    v_exp_f32 v54, v54
    v_exp_f32 v55, v55
    v_cvt_pk_bf16_f32 v24, v48, v49
    v_cvt_pk_bf16_f32 v25, v50, v51
    v_mfma_f32_32x32x8_bf16 v[32:47], v[206:207], v[132:133], v[32:47]
    v_exp_f32 v56, v56
    v_cvt_pk_bf16_f32 v26, v52, v53
    v_cvt_pk_bf16_f32 v27, v54, v55
    v_exp_f32 v57, v57
    v_exp_f32 v58, v58
    v_exp_f32 v59, v59
    v_mfma_f32_32x32x16_bf16 v[112:127], v[184:187], v[24:27], v[112:127]
    v_exp_f32 v60, v60
    v_exp_f32 v61, v61
    v_exp_f32 v62, v62
    v_exp_f32 v63, v63
    v_cvt_pk_bf16_f32 v28, v56, v57
    v_cvt_pk_bf16_f32 v29, v58, v59
    v_cvt_pk_bf16_f32 v30, v60, v61
    v_cvt_pk_bf16_f32 v31, v62, v63
    v_mfma_f32_32x32x16_bf16 v[48:63], v[194:197], v[134:137], 0
    ds_read_b128 v[180:183], v209 offset:25600
    ds_read_b64 v[192:193], v210 offset:25600
    v_exp_f32 v32, v32
    v_exp_f32 v33, v33
    v_exp_f32 v34, v34
    v_exp_f32 v35, v35
    v_mfma_f32_32x32x16_bf16 v[112:127], v[188:191], v[28:31], v[112:127]
    s_mov_b64 exec, s[58:59]
    ds_read_b128 v[184:187], v211 offset:25600
    ds_read_b128 v[188:191], v211 offset:26240
    s_mov_b64 exec, -1
    v_exp_f32 v36, v36
    v_exp_f32 v37, v37
    v_exp_f32 v38, v38
    v_exp_f32 v39, v39
    v_cvt_pk_bf16_f32 v24, v32, v33
    v_cvt_pk_bf16_f32 v25, v34, v35
    v_mfma_f32_32x32x8_bf16 v[48:63], v[206:207], v[138:139], v[48:63]
    v_exp_f32 v40, v40
    v_cvt_pk_bf16_f32 v26, v36, v37
    v_cvt_pk_bf16_f32 v27, v38, v39
    v_exp_f32 v41, v41
    v_exp_f32 v42, v42
    v_exp_f32 v43, v43
    v_mfma_f32_32x32x16_bf16 v[64:79], v[198:201], v[24:27], v[64:79]
    s_cmp_eq_u32 s49, s32
    v_exp_f32 v44, v44
    v_exp_f32 v45, v45
    v_exp_f32 v46, v46
    v_exp_f32 v47, v47
    v_cvt_pk_bf16_f32 v28, v40, v41
    v_cvt_pk_bf16_f32 v29, v42, v43
    v_cvt_pk_bf16_f32 v30, v44, v45
    v_cvt_pk_bf16_f32 v31, v46, v47
    v_mfma_f32_32x32x16_bf16 v[32:47], v[194:197], v[140:143], 0
    s_cbranch_scc1 att_ha
att_har:
    v_exp_f32 v48, v48
    v_exp_f32 v49, v49
    v_exp_f32 v50, v50
    v_exp_f32 v51, v51
    v_mfma_f32_32x32x16_bf16 v[64:79], v[202:205], v[28:31], v[64:79]
    s_sub_u32 s49, s49, 1
    v_exp_f32 v52, v52
    v_exp_f32 v53, v53
    v_exp_f32 v54, v54
    v_exp_f32 v55, v55
    v_cvt_pk_bf16_f32 v24, v48, v49
    v_cvt_pk_bf16_f32 v25, v50, v51
    v_mfma_f32_32x32x8_bf16 v[32:47], v[206:207], v[144:145], v[32:47]
    v_exp_f32 v56, v56
    v_cvt_pk_bf16_f32 v26, v52, v53
    v_cvt_pk_bf16_f32 v27, v54, v55
    v_exp_f32 v57, v57
    v_exp_f32 v58, v58
    v_exp_f32 v59, v59
    v_mfma_f32_32x32x16_bf16 v[80:95], v[198:201], v[24:27], v[80:95]
    s_cmp_lg_u32 s49, 0
    v_exp_f32 v60, v60
    v_exp_f32 v61, v61
    v_exp_f32 v62, v62
    v_exp_f32 v63, v63
    v_cvt_pk_bf16_f32 v28, v56, v57
    v_cvt_pk_bf16_f32 v29, v58, v59
    v_cvt_pk_bf16_f32 v30, v60, v61
    v_cvt_pk_bf16_f32 v31, v62, v63
    v_mfma_f32_32x32x16_bf16 v[48:63], v[194:197], v[146:149], 0
    v_add_u32 v209, 0x5000, v209
    v_exp_f32 v32, v32
    v_exp_f32 v33, v33
    v_exp_f32 v34, v34
    v_exp_f32 v35, v35
    v_mfma_f32_32x32x16_bf16 v[80:95], v[202:205], v[28:31], v[80:95]
    v_add_u32 v210, 0x5000, v210
    v_exp_f32 v36, v36
    v_exp_f32 v37, v37
    v_exp_f32 v38, v38
    v_exp_f32 v39, v39
    v_cvt_pk_bf16_f32 v24, v32, v33
    v_cvt_pk_bf16_f32 v25, v34, v35
    v_mfma_f32_32x32x8_bf16 v[48:63], v[206:207], v[150:151], v[48:63]
    v_exp_f32 v40, v40
    v_cvt_pk_bf16_f32 v26, v36, v37
    v_cvt_pk_bf16_f32 v27, v38, v39
    v_exp_f32 v41, v41
    v_exp_f32 v42, v42
    v_exp_f32 v43, v43
    v_mfma_f32_32x32x16_bf16 v[96:111], v[198:201], v[24:27], v[96:111]
    s_waitcnt lgkmcnt(8)
    v_exp_f32 v44, v44
    v_exp_f32 v45, v45
    v_exp_f32 v46, v46
    v_exp_f32 v47, v47
    v_cvt_pk_bf16_f32 v28, v40, v41
    v_cvt_pk_bf16_f32 v29, v42, v43
    v_cvt_pk_bf16_f32 v30, v44, v45
    v_cvt_pk_bf16_f32 v31, v46, v47
    v_mfma_f32_32x32x16_bf16 v[32:47], v[152:155], v[128:131], 0
    v_add_u32 v211, 0x5000, v211
    v_exp_f32 v48, v48
    v_exp_f32 v49, v49
    v_exp_f32 v50, v50
    v_exp_f32 v51, v51
    v_mfma_f32_32x32x16_bf16 v[96:111], v[202:205], v[28:31], v[96:111]
    v_exp_f32 v52, v52
    v_exp_f32 v53, v53
    v_exp_f32 v54, v54
    v_exp_f32 v55, v55
    v_cvt_pk_bf16_f32 v24, v48, v49
    v_cvt_pk_bf16_f32 v25, v50, v51
    v_mfma_f32_32x32x8_bf16 v[32:47], v[164:165], v[132:133], v[32:47]
    v_exp_f32 v56, v56
    v_cvt_pk_bf16_f32 v26, v52, v53
    v_cvt_pk_bf16_f32 v27, v54, v55
    v_exp_f32 v57, v57
    v_exp_f32 v58, v58
    v_exp_f32 v59, v59
    v_mfma_f32_32x32x16_bf16 v[112:127], v[198:201], v[24:27], v[112:127]
    v_exp_f32 v60, v60
    v_exp_f32 v61, v61
    v_exp_f32 v62, v62
    v_exp_f32 v63, v63
    v_cvt_pk_bf16_f32 v28, v56, v57
    v_cvt_pk_bf16_f32 v29, v58, v59
    v_cvt_pk_bf16_f32 v30, v60, v61
    v_cvt_pk_bf16_f32 v31, v62, v63
    s_cbranch_scc1 att_loopb
att_epi:
    s_setprio 3
    ds_write_b128 v215, v[64:67] offset:0
    ds_write_b128 v215, v[68:71] offset:1024
    v_mfma_f32_32x32x16_bf16 v[112:127], v[202:205], v[28:31], v[112:127]
    ds_write_b128 v215, v[72:75] offset:2048
    ds_write_b128 v215, v[80:83] offset:3072
    ds_write_b128 v215, v[84:87] offset:4096
    ds_write_b128 v215, v[88:91] offset:5120
    s_waitcnt lgkmcnt(0)
    s_barrier
    ds_read_b128 v[40:43], v216 offset:2048
    ds_read_b128 v[32:35], v216 offset:0
    ds_read_b128 v[36:39], v216 offset:1024
    ds_read_b128 v[56:59], v216 offset:5120
    ds_read_b128 v[48:51], v216 offset:3072
    ds_read_b128 v[52:55], v216 offset:4096
att_fin:
    s_waitcnt lgkmcnt(5)
    v_add_f32 v12, v104, v40
    v_add_f32 v22, v104, v40
    v_pk_add_f32 v[104:105], v[104:105], v[40:41]
    v_pk_add_f32 v[106:107], v[106:107], v[42:43]
    v_permlane32_swap_b32 v12, v22
    s_waitcnt lgkmcnt(3)
    v_rcp_f32 v12, v22
    v_pk_add_f32 v[96:97], v[96:97], v[32:33]
    v_pk_add_f32 v[98:99], v[98:99], v[34:35]
    v_pk_add_f32 v[100:101], v[100:101], v[36:37]
    v_pk_add_f32 v[102:103], v[102:103], v[38:39]
    v_pk_mul_f32 v[96:97], v[96:97], v[12:13] op_sel_hi:[1,0]
    v_pk_mul_f32 v[98:99], v[98:99], v[12:13] op_sel_hi:[1,0]
    v_pk_mul_f32 v[100:101], v[100:101], v[12:13] op_sel_hi:[1,0]
    v_pk_mul_f32 v[102:103], v[102:103], v[12:13] op_sel_hi:[1,0]
    v_pk_mul_f32 v[104:105], v[104:105], v[12:13] op_sel_hi:[1,0]
    v_pk_mul_f32 v[106:107], v[106:107], v[12:13] op_sel_hi:[1,0]
    v_cvt_pk_bf16_f32 v14, v96, v97
    v_cvt_pk_bf16_f32 v15, v98, v99
    v_cvt_pk_bf16_f32 v16, v100, v101
    v_cvt_pk_bf16_f32 v17, v102, v103
    v_cvt_pk_bf16_f32 v18, v104, v105
    v_cvt_pk_bf16_f32 v19, v106, v107
    buffer_store_dwordx4 v[14:17], v217, s[24:27], s28 offen sc1
    s_waitcnt lgkmcnt(2)
    v_add_f32 v12, v120, v56
    v_add_f32 v23, v120, v56
    v_pk_add_f32 v[120:121], v[120:121], v[56:57]
    v_pk_add_f32 v[122:123], v[122:123], v[58:59]
    v_permlane32_swap_b32 v12, v23
    s_waitcnt lgkmcnt(0)
    v_rcp_f32 v12, v23
    v_pk_add_f32 v[112:113], v[112:113], v[48:49]
    v_pk_add_f32 v[114:115], v[114:115], v[50:51]
    v_pk_add_f32 v[116:117], v[116:117], v[52:53]
    v_pk_add_f32 v[118:119], v[118:119], v[54:55]
    v_pk_mul_f32 v[112:113], v[112:113], v[12:13] op_sel_hi:[1,0]
    v_pk_mul_f32 v[114:115], v[114:115], v[12:13] op_sel_hi:[1,0]
    v_pk_mul_f32 v[116:117], v[116:117], v[12:13] op_sel_hi:[1,0]
    v_pk_mul_f32 v[118:119], v[118:119], v[12:13] op_sel_hi:[1,0]
    v_pk_mul_f32 v[120:121], v[120:121], v[12:13] op_sel_hi:[1,0]
    v_pk_mul_f32 v[122:123], v[122:123], v[12:13] op_sel_hi:[1,0]
    v_cvt_pk_bf16_f32 v24, v112, v113
    v_cvt_pk_bf16_f32 v25, v114, v115
    v_cvt_pk_bf16_f32 v26, v116, v117
    v_cvt_pk_bf16_f32 v27, v118, v119
    v_cvt_pk_bf16_f32 v20, v120, v121
    v_cvt_pk_bf16_f32 v21, v122, v123
    buffer_store_dwordx4 v[24:27], v217, s[24:27], s29 offen sc1
    s_mov_b32 exec_hi, 0
    buffer_store_dwordx4 v[18:21], v208, s[24:27], s30 offen sc1
    s_mov_b32 exec_hi, -1
    s_cmp_lg_u32 s49, 0
    s_cbranch_scc1 att_ok
    v_subrev_u32 v22, 864026624, v22
    v_subrev_u32 v23, 864026624, v23
    v_max_u32 v22, v22, v23
    v_cmp_lt_u32 vcc, 603979776, v22
    v_add_f32 v12, v96, v112
    v_fma_f32 v12, v97, 0, v12
    v_fma_f32 v12, v113, 0, v12
    v_fma_f32 v12, v98, 0, v12
    v_fma_f32 v12, v114, 0, v12
    v_fma_f32 v12, v99, 0, v12
    v_fma_f32 v12, v115, 0, v12
    v_fma_f32 v12, v100, 0, v12
    v_fma_f32 v12, v116, 0, v12
    v_fma_f32 v12, v101, 0, v12
    v_fma_f32 v12, v117, 0, v12
    v_fma_f32 v12, v102, 0, v12
    v_fma_f32 v12, v118, 0, v12
    v_fma_f32 v12, v103, 0, v12
    v_fma_f32 v12, v119, 0, v12
    v_fma_f32 v12, v104, 0, v12
    v_fma_f32 v12, v120, 0, v12
    v_fma_f32 v12, v105, 0, v12
    v_fma_f32 v12, v121, 0, v12
    v_fma_f32 v12, v106, 0, v12
    v_fma_f32 v12, v122, 0, v12
    v_fma_f32 v12, v107, 0, v12
    v_fma_f32 v12, v123, 0, v12
    s_movk_i32 s54, 0x207
    v_cmp_class_f32 s[56:57], v12, s54
    s_nop 0
    s_or_b64 vcc, vcc, s[56:57]
    s_cbranch_scc1 att_fb
att_ok:
    s_waitcnt vmcnt(0)
    s_mov_b64 exec, 1
    buffer_store_dword v11, off, s[24:27], s31 sc1
    s_mov_b64 exec, -1
    s_branch att_done
att_fb:
    s_lshl_b32 s54, s43, 14
    s_sub_u32 s45, s50, s54
    s_sub_u32 s46, s51, s54
    s_mul_i32 s54, s43, 40960
    s_sub_u32 s47, s52, s54
    s_mov_b32 s49, 0
    v_mov_b32 v22, 0xff800000
    v_mov_b32 v23, 0xff800000
att_fb1:
    buffer_load_dwordx4 v[152:155], v2, s[24:27], s45 offen offset:0 sc1
    buffer_load_dwordx2 v[164:165], v3, s[24:27], s46 offen offset:0 sc1
    s_waitcnt vmcnt(0)
    v_mfma_f32_32x32x16_bf16 v[32:47], v[152:155], v[140:143], 0
    v_mfma_f32_32x32x16_bf16 v[48:63], v[152:155], v[146:149], 0
    v_mfma_f32_32x32x8_bf16 v[32:47], v[164:165], v[144:145], v[32:47]
    v_mfma_f32_32x32x8_bf16 v[48:63], v[164:165], v[150:151], v[48:63]
    s_nop 11
    v_max3_f32 v22, v32, v33, v22
    v_max3_f32 v22, v34, v35, v22
    v_max3_f32 v22, v36, v37, v22
    v_max3_f32 v22, v38, v39, v22
    v_max3_f32 v22, v40, v41, v22
    v_max3_f32 v22, v42, v43, v22
    v_max3_f32 v22, v44, v45, v22
    v_max3_f32 v22, v46, v47, v22
    v_max3_f32 v23, v48, v49, v23
    v_max3_f32 v23, v50, v51, v23
    v_max3_f32 v23, v52, v53, v23
    v_max3_f32 v23, v54, v55, v23
    v_max3_f32 v23, v56, v57, v23
    v_max3_f32 v23, v58, v59, v23
    v_max3_f32 v23, v60, v61, v23
    v_max3_f32 v23, v62, v63, v23
    s_add_u32 s45, s45, 512
    s_add_u32 s46, s46, 512
    s_add_u32 s47, s47, 1280
    s_add_u32 s49, s49, 1
    s_cmp_lt_u32 s49, 64
    s_cbranch_scc1 att_fb1
    s_lshl_b32 s54, s43, 14
    s_sub_u32 s45, s50, s54
    s_sub_u32 s46, s51, s54
    s_mul_i32 s54, s43, 40960
    s_sub_u32 s47, s52, s54
    s_mov_b32 s49, 0
    v_mov_b32 v12, v22
    s_nop 1
    v_permlane32_swap_b32 v12, v22
    v_max_f32 v12, v12, v22
    v_xor_b32 v64, 0x80000000, v12
    v_mov_b32 v96, 0
    v_xor_b32 v65, 0x80000000, v12
    v_mov_b32 v97, 0
    v_xor_b32 v66, 0x80000000, v12
    v_mov_b32 v98, 0
    v_xor_b32 v67, 0x80000000, v12
    v_mov_b32 v99, 0
    v_xor_b32 v68, 0x80000000, v12
    v_mov_b32 v100, 0
    v_xor_b32 v69, 0x80000000, v12
    v_mov_b32 v101, 0
    v_xor_b32 v70, 0x80000000, v12
    v_mov_b32 v102, 0
    v_xor_b32 v71, 0x80000000, v12
    v_mov_b32 v103, 0
    v_xor_b32 v72, 0x80000000, v12
    v_mov_b32 v104, 0
    v_xor_b32 v73, 0x80000000, v12
    v_mov_b32 v105, 0
    v_xor_b32 v74, 0x80000000, v12
    v_mov_b32 v106, 0
    v_xor_b32 v75, 0x80000000, v12
    v_mov_b32 v107, 0
    v_xor_b32 v76, 0x80000000, v12
    v_mov_b32 v108, 0
    v_xor_b32 v77, 0x80000000, v12
    v_mov_b32 v109, 0
    v_xor_b32 v78, 0x80000000, v12
    v_mov_b32 v110, 0
    v_xor_b32 v79, 0x80000000, v12
    v_mov_b32 v111, 0
    v_mov_b32 v12, v23
    s_nop 1
    v_permlane32_swap_b32 v12, v23
    v_max_f32 v12, v12, v23
    v_xor_b32 v80, 0x80000000, v12
    v_mov_b32 v112, 0
    v_xor_b32 v81, 0x80000000, v12
    v_mov_b32 v113, 0
    v_xor_b32 v82, 0x80000000, v12
    v_mov_b32 v114, 0
    v_xor_b32 v83, 0x80000000, v12
    v_mov_b32 v115, 0
    v_xor_b32 v84, 0x80000000, v12
    v_mov_b32 v116, 0
    v_xor_b32 v85, 0x80000000, v12
    v_mov_b32 v117, 0
    v_xor_b32 v86, 0x80000000, v12
    v_mov_b32 v118, 0
    v_xor_b32 v87, 0x80000000, v12
    v_mov_b32 v119, 0
    v_xor_b32 v88, 0x80000000, v12
    v_mov_b32 v120, 0
    v_xor_b32 v89, 0x80000000, v12
    v_mov_b32 v121, 0
    v_xor_b32 v90, 0x80000000, v12
    v_mov_b32 v122, 0
    v_xor_b32 v91, 0x80000000, v12
    v_mov_b32 v123, 0
    v_xor_b32 v92, 0x80000000, v12
    v_mov_b32 v124, 0
    v_xor_b32 v93, 0x80000000, v12
    v_mov_b32 v125, 0
    v_xor_b32 v94, 0x80000000, v12
    v_mov_b32 v126, 0
    v_xor_b32 v95, 0x80000000, v12
    v_mov_b32 v127, 0
att_fb2:
    buffer_load_dwordx4 v[152:155], v2, s[24:27], s45 offen offset:0 sc1
    buffer_load_dwordx2 v[164:165], v3, s[24:27], s46 offen offset:0 sc1
    s_mov_b64 exec, s[58:59]
    buffer_load_dwordx4 v[156:159], v4, s[24:27], s47 offen offset:0 sc1
    buffer_load_dwordx4 v[160:163], v5, s[24:27], s47 offen offset:0 sc1
    s_mov_b64 exec, -1
    s_waitcnt vmcnt(0)
    v_mfma_f32_32x32x16_bf16 v[32:47], v[152:155], v[140:143], v[64:79]
    v_mfma_f32_32x32x16_bf16 v[48:63], v[152:155], v[146:149], v[80:95]
    v_mfma_f32_32x32x8_bf16 v[32:47], v[164:165], v[144:145], v[32:47]
    v_mfma_f32_32x32x8_bf16 v[48:63], v[164:165], v[150:151], v[48:63]
    s_nop 11
    v_exp_f32 v32, v32
    v_exp_f32 v33, v33
    v_exp_f32 v34, v34
    v_exp_f32 v35, v35
    v_exp_f32 v36, v36
    v_exp_f32 v37, v37
    v_exp_f32 v38, v38
    v_exp_f32 v39, v39
    v_exp_f32 v40, v40
    v_exp_f32 v41, v41
    v_exp_f32 v42, v42
    v_exp_f32 v43, v43
    v_exp_f32 v44, v44
    v_exp_f32 v45, v45
    v_exp_f32 v46, v46
    v_exp_f32 v47, v47
    v_cvt_pk_bf16_f32 v24, v32, v33
    v_cvt_pk_bf16_f32 v25, v34, v35
    v_cvt_pk_bf16_f32 v26, v36, v37
    v_cvt_pk_bf16_f32 v27, v38, v39
    v_cvt_pk_bf16_f32 v28, v40, v41
    v_cvt_pk_bf16_f32 v29, v42, v43
    v_cvt_pk_bf16_f32 v30, v44, v45
    v_cvt_pk_bf16_f32 v31, v46, v47
    s_nop 1
    v_mfma_f32_32x32x16_bf16 v[96:111], v[156:159], v[24:27], v[96:111]
    v_mfma_f32_32x32x16_bf16 v[96:111], v[160:163], v[28:31], v[96:111]
    v_exp_f32 v48, v48
    v_exp_f32 v49, v49
    v_exp_f32 v50, v50
    v_exp_f32 v51, v51
    v_exp_f32 v52, v52
    v_exp_f32 v53, v53
    v_exp_f32 v54, v54
    v_exp_f32 v55, v55
    v_exp_f32 v56, v56
    v_exp_f32 v57, v57
    v_exp_f32 v58, v58
    v_exp_f32 v59, v59
    v_exp_f32 v60, v60
    v_exp_f32 v61, v61
    v_exp_f32 v62, v62
    v_exp_f32 v63, v63
    v_cvt_pk_bf16_f32 v24, v48, v49
    v_cvt_pk_bf16_f32 v25, v50, v51
    v_cvt_pk_bf16_f32 v26, v52, v53
    v_cvt_pk_bf16_f32 v27, v54, v55
    v_cvt_pk_bf16_f32 v28, v56, v57
    v_cvt_pk_bf16_f32 v29, v58, v59
    v_cvt_pk_bf16_f32 v30, v60, v61
    v_cvt_pk_bf16_f32 v31, v62, v63
    s_nop 1
    v_mfma_f32_32x32x16_bf16 v[112:127], v[156:159], v[24:27], v[112:127]
    v_mfma_f32_32x32x16_bf16 v[112:127], v[160:163], v[28:31], v[112:127]
    s_add_u32 s45, s45, 512
    s_add_u32 s46, s46, 512
    s_add_u32 s47, s47, 1280
    s_add_u32 s49, s49, 1
    s_cmp_lt_u32 s49, 64
    s_cbranch_scc1 att_fb2
    v_mov_b32 v32, 0
    v_mov_b32 v33, 0
    v_mov_b32 v34, 0
    v_mov_b32 v35, 0
    v_mov_b32 v36, 0
    v_mov_b32 v37, 0
    v_mov_b32 v38, 0
    v_mov_b32 v39, 0
    v_mov_b32 v40, 0
    v_mov_b32 v41, 0
    v_mov_b32 v42, 0
    v_mov_b32 v43, 0
    v_mov_b32 v44, 0
    v_mov_b32 v45, 0
    v_mov_b32 v46, 0
    v_mov_b32 v47, 0
    v_mov_b32 v48, 0
    v_mov_b32 v49, 0
    v_mov_b32 v50, 0
    v_mov_b32 v51, 0
    v_mov_b32 v52, 0
    v_mov_b32 v53, 0
    v_mov_b32 v54, 0
    v_mov_b32 v55, 0
    v_mov_b32 v56, 0
    v_mov_b32 v57, 0
    v_mov_b32 v58, 0
    v_mov_b32 v59, 0
    v_mov_b32 v60, 0
    v_mov_b32 v61, 0
    v_mov_b32 v62, 0
    v_mov_b32 v63, 0
    s_branch att_fin
att_done:
recurrent_scan__softmax_full_mha__geglu_ffn__prompt_kernel_end:
    s_endpgm
.section .rodata,"a"
.p2align 6
.amdhsa_kernel recurrent_scan__softmax_full_mha__geglu_ffn__prompt_kernel
  .amdhsa_next_free_vgpr 256
  .amdhsa_next_free_sgpr 102
  .amdhsa_accum_offset 256
  .amdhsa_group_segment_fixed_size 0
  .amdhsa_kernarg_size 80
  .amdhsa_user_sgpr_count 2
  .amdhsa_user_sgpr_kernarg_segment_ptr 1
  .amdhsa_system_sgpr_workgroup_id_x 1
  .amdhsa_float_denorm_mode_32 3
.end_amdhsa_kernel
```
